```python
import torch

def _softmax(x, axis=-1):
    return torch.softmax(x, dim=axis)
def _gelu(x):
    return torch.nn.functional.gelu(x, approximate="tanh")
def _silu(x):
    return torch.nn.functional.silu(x)
def _sigmoid(x):
    return torch.sigmoid(x)
def _layernorm(x, axis=-1, eps=1e-5):
    m = x.mean(dim=axis, keepdim=True)
    v = x.var(dim=axis, keepdim=True, unbiased=False)
    return (x - m) / torch.sqrt(v + eps)
def _scatter_add(tgt, idx, src, axis=0):
    return tgt.clone().index_add_(axis, idx, src)
def _segment_sum(src, seg, n):
    out = torch.zeros((n,) + src.shape[1:], dtype=src.dtype)
    return out.index_add_(0, seg, src)
def _pad(x, pw):
    flat = tuple(v for pair in reversed(pw) for v in pair)
    return torch.nn.functional.pad(x, flat)

kernel_name = 'gated_mix__linear_attn_block__dense_activation_gelu__prompt'

def setup_inputs():

    _w = (lambda a: (lambda t: t.to(torch.bfloat16) if t.is_floating_point() else t)(torch.as_tensor(a)))
    def _A_setup():
        B, S, D = 1, 2048, 1024
        return {
            "x": _w((lambda *s: torch.randn(*s, dtype=torch.bfloat16) * 0.05)(B, S, D)),
            "wqkv": _w((lambda *s: torch.randn(*s, dtype=torch.bfloat16) * 1.6)(D, 3 * D)),
            "wo": _w((lambda *s: torch.randn(*s, dtype=torch.bfloat16) * 0.05)(D, D)),
        }
    _A_in = _A_setup()

    def _B_setup():
        B, S, D, F = 1, 2048, 1024, 3584
        return {
            "x": _w((lambda *s: torch.randn(*s, dtype=torch.bfloat16) * 0.05)(B, S, D)),
            "w1": _w((lambda *s: torch.randn(*s, dtype=torch.bfloat16) * 3.2)(D, F) * (D ** -0.5)),
            "b1": _w((lambda *s: torch.randn(*s, dtype=torch.bfloat16) * 3.2)(F) * 0.01),
            "w2": _w((lambda *s: torch.randn(*s, dtype=torch.bfloat16) * 1.6)(F, D) * (F ** -0.5)),
            "b2": _w((lambda *s: torch.randn(*s, dtype=torch.bfloat16) * 3.2)(D) * 0.01),
        }
    _B_in = _B_setup()

    return {
        "A_x": _A_in["x"],
        "A_wqkv": _A_in["wqkv"],
        "A_wo": _A_in["wo"],
        "B_x": _B_in["x"],
        "B_w1": _B_in["w1"],
        "B_b1": _B_in["b1"],
        "B_w2": _B_in["w2"],
        "B_b2": _B_in["b2"],
        "gate_w": _w((lambda *s: torch.randn(*s, dtype=torch.bfloat16) * 0.05)(1024) * 16.0),
    }

def reference(A_x, A_wqkv, A_wo, B_x, B_w1, B_b1, B_w2, B_b2, gate_w):
    def _A_ref(x, wqkv, wo):
        B, S, D = x.shape
        H = 32; Dh = D // H
        qkv = (lambda x, *d: x.permute(*d))((x @ wqkv).reshape(B, S, 3, H, Dh), 2, 0, 3, 1, 4)
        q, k, v = qkv[0], qkv[1], qkv[2]
        phi = lambda t: torch.where(t > 0, t + 1, torch.exp(t)) + 1e-6
        pq, pk = phi(q), phi(k)
        kv = torch.einsum("bhsd,bhse->bhde", pk, v)
        z = torch.einsum("bhsd->bhd", pk)
        num = torch.einsum("bhqd,bhde->bhqe", pq, kv)
        den = torch.einsum("bhqd,bhd->bhq", pq, z)[..., None] + 1e-6
        o = num / den
        return (lambda x, *d: x.permute(*d))(o, 0, 2, 1, 3).reshape(B, S, D) @ wo

    def _B_ref(x, w1, b1, w2, b2):
        h = torch.einsum("bsd,df->bsf", x, w1) + b1
        h = _gelu(h)
        return torch.einsum("bsf,fd->bsd", h, w2) + b2

    x = A_x
    g = _sigmoid((x * gate_w).sum(-1, keepdims=True))
    a = _A_ref(x, A_wqkv, A_wo)
    b = _B_ref(x, B_w1, B_b1, B_w2, B_b2)
    return g * a + (1 - g) * b
```

```asm
; @launch grid=(256,1,1) block=(256,1,1) lds=163840
.amdgcn_target "amdgcn-amd-amdhsa--gfx950"
.text
.globl gated_mix__linear_attn_block__dense_activation_gelu__prompt_kernel
.p2align 8
.type gated_mix__linear_attn_block__dense_activation_gelu__prompt_kernel,@function
gated_mix__linear_attn_block__dense_activation_gelu__prompt_kernel:
s_load_dwordx16 s[48:63], s[0:1], 0
s_load_dwordx8 s[64:71], s[0:1], 64
s_cmp_ge_u32 s2, 256
s_cbranch_scc1 Lend
v_lshrrev_b32 v1, 6, v0
v_and_b32 v0, 63, v0
v_readfirstlane_b32 s72, v1
v_lshlrev_b32 v1, 4, v0
s_and_b32 s93, s2, 7
s_lshr_b32 s94, s2, 3
s_lshr_b32 s95, s93, 1
s_and_b32 s76, s95, 1
s_lshl_b32 s96, s94, 2
s_add_u32 s101, s96, s72
v_lshlrev_b32 v40, 7, v0
v_mov_b32 v47, 0x40000000
s_getpc_b64 s[84:85]
Lpc:
s_mov_b32 s86, Lcode_end-Lpc
s_mov_b32 s87, 0x20000
s_mul_i32 s96, s101, 640
v_cmp_gt_u32 vcc, 5, v0
s_nop 1
v_cndmask_b32 v41, v47, v40, vcc
buffer_load_dword a255, v41, s[84:87], s96 offen
s_and_b32 s96, s93, 1
s_lshr_b32 s97, s101, 1
s_lshl_b32 s98, s96, 6
s_add_u32 s97, s97, s98
s_and_b32 s98, s101, 1
s_lshl_b32 s96, s96, 2
s_add_u32 s96, s96, s95
s_lshl_b32 s96, s96, 7
s_add_u32 s96, s96, s101
s_lshl_b32 s92, s96, 12
v_and_b32 v41, 1, v0
v_lshlrev_b32 v41, 11, v41
v_lshrrev_b32 v42, 1, v0
v_lshl_add_u32 v41, v42, 7, v41
v_add_u32 v37, s92, v41
s_mul_i32 s96, s97, 7168
s_lshl_b32 s92, s95, 1
s_add_u32 s92, s92, s98
s_mul_i32 s92, s92, 896
s_add_u32 s96, s96, s92
v_mul_u32_u24 v41, 37, v0
v_lshrrev_b32 v41, 8, v41
s_mov_b32 s92, 916608
v_mad_u32_u24 v41, v41, s92, v40
v_add_u32 v39, s96, v41
s_mul_i32 s96, s97, 6144
s_lshl_b32 s92, s95, 9
s_add_u32 s96, s96, s92
s_mul_i32 s98, s98, 6
v_mul_u32_u24 v41, 43, v0
v_lshrrev_b32 v41, 8, v41
v_mul_u32_u24 v42, 6, v41
v_sub_u32 v42, v0, v42
v_add_u32 v42, s98, v42
s_mov_b32 s92, 786432
v_mul_lo_u32 v41, v41, s92
v_lshrrev_b32 v43, 2, v42
v_lshl_add_u32 v41, v43, 11, v41
v_and_b32 v42, 3, v42
v_lshl_add_u32 v41, v42, 7, v41
v_add_u32 v38, s96, v41
v_cmp_gt_u32 vcc, 8, v0
s_nop 1
v_cndmask_b32 v44, v47, v37, vcc
v_cmp_gt_u32 vcc, 12, v0
s_nop 1
v_cndmask_b32 v45, v47, v38, vcc
v_cmp_gt_u32 vcc, 14, v0
s_nop 1
v_cndmask_b32 v46, v47, v39, vcc
s_waitcnt lgkmcnt(0)
s_mov_b32 s4, s48
s_mov_b32 s5, s49
s_mov_b32 s6, 4194304
s_mov_b32 s7, 0x20000
s_mov_b32 s12, s56
s_mov_b32 s13, s57
s_mov_b32 s14, 7340032
s_mov_b32 s15, 0x20000
s_mov_b32 s3, 0
buffer_load_dword a255, v44, s[4:7], s3 offen
s_mov_b32 s3, 0
buffer_load_dword a255, v46, s[12:15], s3 offen
s_lshr_b32 s97, s94, 2
s_and_b32 s98, s94, 3
s_and_b32 s96, s93, 1
s_lshl_b32 s74, s96, 3
s_add_u32 s74, s74, s97
s_lshl_b32 s75, s95, 2
s_add_u32 s75, s75, s98
s_lshr_b32 s96, s93, 2
s_lshl_b32 s78, s96, 2
s_add_u32 s78, s78, s98
s_lshl_b32 s98, s98, 1
s_add_u32 s97, s97, s98
s_and_b32 s99, s97, 7
s_and_b32 s80, s72, 1
s_lshr_b32 s79, s72, 1
s_lshl_b32 s73, s72, 10
s_mul_i32 s81, s72, 3072
s_lshl_b32 s96, s74, 7
s_lshl_b32 s97, s72, 3
s_add_u32 s96, s96, s97
s_lshl_b32 s98, s80, 2
v_lshrrev_b32 v33, 4, v0
v_lshrrev_b32 v32, 3, v0
v_add_u32 v32, s96, v32
v_lshlrev_b32 v32, 11, v32
v_add_u32 v34, s98, v33
v_and_b32 v35, 7, v0
v_xor_b32 v34, v34, v35
v_lshl_add_u32 v2, v34, 4, v32
s_lshl_b32 s96, s79, 2
s_add_u32 s96, s96, s80
s_lshl_b32 s82, s96, 10
s_mul_i32 s96, s96, 14336
s_mul_i32 s92, s75, 448
s_add_u32 s96, s96, s92
s_lshl_b32 s97, s80, 1
s_lshl_b32 s98, s79, 2
s_or_b32 s97, s97, s98
v_lshrrev_b32 v34, 5, v0
v_or_b32 v35, s97, v34
v_bfe_u32 v36, v0, 1, 4
v_xor_b32 v35, v35, v36
v_cmp_gt_u32 vcc, 14, v35
v_lshlrev_b32 v35, 5, v35
v_and_b32 v36, 1, v0
v_lshl_add_u32 v35, v36, 4, v35
v_mul_u32_u24 v34, 7168, v34
v_add3_u32 v35, v35, v34, s96
v_cndmask_b32 v6, v47, v35, vcc
v_and_b32 v34, 15, v0
s_lshl_b32 s96, s80, 3
s_add_u32 s97, s80, 6
v_add_u32 v35, s96, v34
v_mov_b32 v36, s97
v_cmp_gt_u32 vcc, 6, v34
s_nop 0
v_lshlrev_b32 v32, 3, v33
v_cndmask_b32 v35, v36, v35, vcc
v_lshl_add_u32 v35, v35, 5, v32
s_mov_b32 s8, s50
s_mov_b32 s9, s51
s_mov_b32 s10, 6291456
s_mov_b32 s11, 0x20000
s_mov_b32 s36, s58
s_mov_b32 s37, s59
s_mov_b32 s38, 7168
s_mov_b32 s39, 0x20000
buffer_load_dwordx2 v[240:241], v35, s[36:39], s92 offen
s_add_u32 m0, s73, 0
s_mov_b32 s93, 0
buffer_load_dwordx4 v2, s[4:7], s93 offen  lds
s_add_u32 m0, s73, 4096
s_mov_b32 s94, 65536
buffer_load_dwordx4 v2, s[4:7], s94 offen  lds
s_add_u32 m0, s73, 8192
s_mov_b32 s95, 131072
buffer_load_dwordx4 v2, s[4:7], s95 offen  lds
s_add_u32 m0, s73, 12288
s_mov_b32 s96, 196608
buffer_load_dwordx4 v2, s[4:7], s96 offen  lds
s_add_u32 m0, s82, 49152
s_mov_b32 s97, 0
buffer_load_dwordx4 v6, s[12:15], s97 offen  lds
s_add_u32 m0, s82, 51200
s_mov_b32 s93, 28672
buffer_load_dwordx4 v6, s[12:15], s93 offen  lds
s_add_u32 m0, s82, 57344
s_mov_b32 s94, 114688
buffer_load_dwordx4 v6, s[12:15], s94 offen  lds
s_add_u32 m0, s82, 59392
s_mov_b32 s95, 143360
buffer_load_dwordx4 v6, s[12:15], s95 offen  lds
s_mov_b32 s16, s60
s_mov_b32 s17, s61
s_mov_b32 s18, 7340032
s_mov_b32 s19, 0x20000
s_mov_b32 s40, s62
s_mov_b32 s41, s63
s_mov_b32 s42, 2048
s_mov_b32 s43, 0x20000
s_mov_b32 s20, s52
s_mov_b32 s21, s53
s_mov_b32 s22, 2097152
s_mov_b32 s23, 0x20000
s_mov_b32 s44, s64
s_mov_b32 s45, s65
s_mov_b32 s46, 2048
s_mov_b32 s47, 0x20000
s_mov_b32 s28, s66
s_mov_b32 s29, s67
s_mov_b32 s30, 4194304
s_mov_b32 s31, 0x20000
s_mov_b32 s32, s68
s_mov_b32 s33, s69
s_mov_b32 s34, 256
s_mov_b32 s35, 0x20000
s_mov_b32 s24, s70
s_mov_b32 s25, s71
s_mov_b32 s26, 33554432
s_mov_b32 s27, 0x20000
s_mov_b32 s100, 0x40000000
s_mov_b32 s77, s74
s_lshl_b32 s96, s74, 4
s_add_u32 s96, s96, s75
s_lshl_b32 s96, s96, 2
s_add_u32 s96, s96, s72
s_lshl_b32 s48, s96, 12
s_add_u32 s49, s48, 2048
s_lshl_b32 s96, s96, 1
s_and_b32 s97, s96, 15
s_lshl_b32 s97, s97, 4
s_bfe_u32 s98, s96, 0x20004
s_lshl_b32 s98, s98, 2
s_andn2_b32 s96, s96, 63
s_lshl_b32 s96, s96, 2
s_add_u32 s96, s96, s97
s_add_u32 s96, s96, s98
s_add_u32 s50, s96, 31727616
v_mov_b32 v28, 0
v_mov_b32 v29, 1
v_cmp_eq_u32 vcc, 0, v0
s_lshl_b32 s83, s75, 1
s_add_u32 s83, s83, s80
s_lshl_b32 s84, s74, 1
s_add_u32 s84, s84, s79
v_cndmask_b32 v27, v47, v28, vcc
s_lshl_b32 s96, s72, 2
v_mov_b32 v44, v47
s_lshl_b32 s97, s74, 11
s_lshl_b32 s98, s75, 7
s_add_u32 s97, s97, s98
s_add_u32 s97, s97, s96
s_add_u32 s85, s97, 32505856
v_writelane_b32 v44, s85, 0
s_lshl_b32 s97, s75, 11
s_lshl_b32 s98, s74, 7
s_add_u32 s97, s97, s98
s_add_u32 s97, s97, s96
s_add_u32 s86, s97, 32636928
v_writelane_b32 v44, s86, 1
s_lshl_b32 s97, s75, 11
s_lshl_b32 s98, s74, 7
s_add_u32 s97, s97, s98
s_add_u32 s97, s97, s96
s_add_u32 s87, s97, 32768000
v_writelane_b32 v44, s87, 2
s_lshl_b32 s97, s74, 11
s_lshl_b32 s98, s75, 7
s_add_u32 s97, s97, s98
s_add_u32 s97, s97, s96
s_add_u32 s88, s97, 32899072
v_writelane_b32 v44, s88, 3
s_lshl_b32 s97, s74, 11
s_lshl_b32 s98, s75, 7
s_add_u32 s97, s97, s98
s_add_u32 s97, s97, s96
s_add_u32 s89, s97, 33030144
v_writelane_b32 v44, s89, 4
s_lshl_b32 s96, s77, 3
s_add_u32 s96, s96, s78
s_lshl_b32 s96, s96, 1
s_add_u32 s96, s96, s76
s_lshl_b32 s58, s96, 15
s_xor_b32 s96, s96, 1
s_lshl_b32 s59, s96, 15
s_lshl_b32 s96, s72, 12
s_add_u32 s96, s96, 18874368
s_add_u32 s58, s58, s96
s_add_u32 s59, s59, s96
v_mov_b32 v20, -1
v_mov_b32 v21, -1
v_mov_b32 v22, -1
v_mov_b32 v23, -1
s_mov_b32 s90, 0x3fb8aa3b
s_mov_b32 s91, 0x358637bd
s_mul_i32 s96, s72, 49152
s_lshl_b32 s97, s75, 7
s_add_u32 s96, s96, s97
s_lshl_b32 s97, s80, 1
s_movk_i32 s3, 6144
v_add_u32 v34, 0, v0
v_mul_u32_u24 v35, 2731, v34
v_lshrrev_b32 v35, 16, v35
v_mul_u32_u24 v36, 24, v35
v_sub_u32 v34, v34, v36
v_bfe_u32 v36, v35, 1, 1
v_or_b32 v36, s97, v36
v_bfe_u32 v32, v34, 1, 2
v_xor_b32 v36, v36, v32
v_lshlrev_b32 v36, 5, v36
v_and_b32 v32, 1, v34
v_lshl_add_u32 v36, v32, 4, v36
v_lshrrev_b32 v32, 3, v34
v_lshl_add_u32 v36, v32, 11, v36
v_mad_u32_u24 v36, v35, s3, v36
v_add_u32 v3, s96, v36
v_add_u32 v34, 64, v0
v_mul_u32_u24 v35, 2731, v34
v_lshrrev_b32 v35, 16, v35
v_mul_u32_u24 v36, 24, v35
v_sub_u32 v34, v34, v36
v_bfe_u32 v36, v35, 1, 1
v_or_b32 v36, s97, v36
v_bfe_u32 v32, v34, 1, 2
v_xor_b32 v36, v36, v32
v_lshlrev_b32 v36, 5, v36
v_and_b32 v32, 1, v34
v_lshl_add_u32 v36, v32, 4, v36
v_lshrrev_b32 v32, 3, v34
v_lshl_add_u32 v36, v32, 11, v36
v_mad_u32_u24 v36, v35, s3, v36
v_add_u32 v4, s96, v36
v_add_u32 v34, 128, v0
v_mul_u32_u24 v35, 2731, v34
v_lshrrev_b32 v35, 16, v35
v_mul_u32_u24 v36, 24, v35
v_sub_u32 v34, v34, v36
v_bfe_u32 v36, v35, 1, 1
v_or_b32 v36, s97, v36
v_bfe_u32 v32, v34, 1, 2
v_xor_b32 v36, v36, v32
v_lshlrev_b32 v36, 5, v36
v_and_b32 v32, 1, v34
v_lshl_add_u32 v36, v32, 4, v36
v_lshrrev_b32 v32, 3, v34
v_lshl_add_u32 v36, v32, 11, v36
v_mad_u32_u24 v36, v35, s3, v36
v_add_u32 v5, s96, v36
v_and_b32 v34, 15, v0
s_lshl_b32 s96, s79, 13
v_lshlrev_b32 v35, 7, v34
v_add_u32 v35, s96, v35
v_lshrrev_b32 v36, 1, v34
v_xor_b32 v36, v36, v33
v_lshl_add_u32 v7, v36, 4, v35
v_xor_b32 v8, 64, v7
v_lshrrev_b32 v35, 2, v34
v_lshl_add_u32 v36, v33, 3, v35
v_and_b32 v32, 3, v34
v_lshlrev_b32 v32, 3, v32
v_add_u32 v32, 49152, v32
v_mul_u32_u24 v42, 384, v36
v_add_u32 v42, 65536, v42
v_add_u32 v42, v42, v32
v_lshrrev_b32 v43, 3, v34
v_and_b32 v40, 1, v33
v_lshl_or_b32 v43, v40, 1, v43
s_lshl_b32 s96, s80, 1
s_add_u32 s97, s96, 0
v_xor_b32 v41, s97, v43
v_lshl_add_u32 v9, v41, 5, v42
s_add_u32 s97, s96, 1
v_xor_b32 v41, s97, v43
v_lshl_add_u32 v10, v41, 5, v42
v_lshl_add_u32 v42, v36, 9, v32
v_lshl_or_b32 v43, v40, 2, v35
s_lshl_b32 s96, s80, 3
s_add_u32 s97, s96, 0
v_xor_b32 v41, s97, v43
v_lshl_add_u32 v13, v41, 5, v42
s_add_u32 s97, s96, 1
v_xor_b32 v41, s97, v43
v_lshl_add_u32 v14, v41, 5, v42
s_add_u32 s97, s96, 2
v_xor_b32 v41, s97, v43
v_lshl_add_u32 v15, v41, 5, v42
s_add_u32 s97, s96, 3
v_xor_b32 v41, s97, v43
v_lshl_add_u32 v16, v41, 5, v42
s_add_u32 s97, s96, 4
v_xor_b32 v41, s97, v43
v_lshl_add_u32 v17, v41, 5, v42
s_add_u32 s97, s96, 5
v_xor_b32 v41, s97, v43
v_lshl_add_u32 v18, v41, 5, v42
s_add_u32 s97, s80, 6
v_xor_b32 v41, s97, v43
v_lshl_add_u32 v19, v41, 5, v42
s_add_u32 m0, s73, 16384
s_mov_b32 s96, 128
buffer_load_dwordx4 v2, s[4:7], s96 offen  lds
s_add_u32 m0, s73, 20480
s_mov_b32 s97, 65664
buffer_load_dwordx4 v2, s[4:7], s97 offen  lds
s_add_u32 m0, s82, 65536
s_mov_b32 s93, 229376
buffer_load_dwordx4 v6, s[12:15], s93 offen  lds
s_add_u32 m0, s82, 67584
s_mov_b32 s94, 258048
buffer_load_dwordx4 v6, s[12:15], s94 offen  lds
s_add_u32 m0, s82, 73728
s_mov_b32 s95, 344064
buffer_load_dwordx4 v6, s[12:15], s95 offen  lds
s_add_u32 m0, s82, 75776
s_mov_b32 s96, 372736
buffer_load_dwordx4 v6, s[12:15], s96 offen  lds
s_add_u32 m0, s73, 24576
s_mov_b32 s97, 131200
buffer_load_dwordx4 v2, s[4:7], s97 offen  lds
s_add_u32 m0, s73, 28672
s_mov_b32 s93, 196736
buffer_load_dwordx4 v2, s[4:7], s93 offen  lds
s_add_u32 m0, s82, 81920
s_mov_b32 s94, 458752
buffer_load_dwordx4 v6, s[12:15], s94 offen  lds
s_add_u32 m0, s82, 83968
s_mov_b32 s95, 487424
buffer_load_dwordx4 v6, s[12:15], s95 offen  lds
s_add_u32 m0, s82, 90112
s_mov_b32 s96, 573440
buffer_load_dwordx4 v6, s[12:15], s96 offen  lds
s_add_u32 m0, s82, 92160
s_mov_b32 s97, 602112
buffer_load_dwordx4 v6, s[12:15], s97 offen  lds
v_mov_b32 v42, 0
v_mov_b32 v43, 0
v_lshrrev_b32 v40, 4, v0
v_lshlrev_b32 v40, 2, v40
ds_bpermute_b32 v41, v40, v44
v_and_b32 v40, 15, v0
v_lshlrev_b32 v40, 3, v40
s_cmp_eq_u32 s72, 0
s_cselect_b32 s96, 0, s100
s_add_u32 s97, s96, s89
s_waitcnt lgkmcnt(0)
v_add_u32 v41, v41, v40
v_cmp_gt_u32 vcc, 16, v0
s_nop 1
v_cndmask_b32 v40, v47, v40, vcc
buffer_store_dwordx2 v[42:43], v41, s[24:27], s96 offen sc1
buffer_store_dwordx2 v[42:43], v40, s[24:27], s97 offen sc1
s_mov_b32 s3, 0
buffer_load_dword a255, v45, s[8:11], s3 offen
v_cmp_gt_u32 vcc, 4, v0
s_nop 1
v_cndmask_b32 v44, v47, v37, vcc
v_cmp_gt_u32 vcc, 6, v0
s_nop 1
v_cndmask_b32 v45, v47, v38, vcc
v_cmp_gt_u32 vcc, 7, v0
s_nop 1
v_cndmask_b32 v46, v47, v39, vcc
s_mov_b32 s3, 512
buffer_load_dword a255, v44, s[4:7], s3 offen
s_mov_b32 s3, 1835008
buffer_load_dword a255, v46, s[12:15], s3 offen
s_mov_b32 s3, 1572864
buffer_load_dword a255, v45, s[8:11], s3 offen
s_waitcnt vmcnt(26)
v_mov_b32_dpp v49, v240 row_newbcast:0 row_mask:0xf bank_mask:0xf
v_mov_b32_dpp v51, v241 row_newbcast:0 row_mask:0xf bank_mask:0xf
v_mov_b32_dpp v53, v240 row_newbcast:1 row_mask:0xf bank_mask:0xf
v_mov_b32_dpp v55, v241 row_newbcast:1 row_mask:0xf bank_mask:0xf
v_mov_b32_dpp v57, v240 row_newbcast:2 row_mask:0xf bank_mask:0xf
v_mov_b32_dpp v59, v241 row_newbcast:2 row_mask:0xf bank_mask:0xf
v_mov_b32_dpp v61, v240 row_newbcast:3 row_mask:0xf bank_mask:0xf
v_mov_b32_dpp v63, v241 row_newbcast:3 row_mask:0xf bank_mask:0xf
v_mov_b32_dpp v65, v240 row_newbcast:4 row_mask:0xf bank_mask:0xf
v_mov_b32_dpp v67, v241 row_newbcast:4 row_mask:0xf bank_mask:0xf
v_mov_b32_dpp v69, v240 row_newbcast:5 row_mask:0xf bank_mask:0xf
v_mov_b32_dpp v71, v241 row_newbcast:5 row_mask:0xf bank_mask:0xf
v_mov_b32_dpp v73, v240 row_newbcast:6 row_mask:0xf bank_mask:0xf
v_mov_b32_dpp v75, v241 row_newbcast:6 row_mask:0xf bank_mask:0xf
v_lshlrev_b32 v48, 16, v49
v_and_b32 v49, 0xffff0000, v49
v_lshlrev_b32 v50, 16, v51
v_and_b32 v51, 0xffff0000, v51
v_lshlrev_b32 v52, 16, v53
v_and_b32 v53, 0xffff0000, v53
v_lshlrev_b32 v54, 16, v55
v_and_b32 v55, 0xffff0000, v55
v_lshlrev_b32 v56, 16, v57
v_and_b32 v57, 0xffff0000, v57
v_lshlrev_b32 v58, 16, v59
v_and_b32 v59, 0xffff0000, v59
v_lshlrev_b32 v60, 16, v61
v_and_b32 v61, 0xffff0000, v61
v_lshlrev_b32 v62, 16, v63
v_and_b32 v63, 0xffff0000, v63
v_lshlrev_b32 v64, 16, v65
v_and_b32 v65, 0xffff0000, v65
v_lshlrev_b32 v66, 16, v67
v_and_b32 v67, 0xffff0000, v67
v_lshlrev_b32 v68, 16, v69
v_and_b32 v69, 0xffff0000, v69
v_lshlrev_b32 v70, 16, v71
v_and_b32 v71, 0xffff0000, v71
v_lshlrev_b32 v72, 16, v73
v_and_b32 v73, 0xffff0000, v73
v_lshlrev_b32 v74, 16, v75
v_and_b32 v75, 0xffff0000, v75
s_waitcnt vmcnt(18)
s_barrier
ds_read_b128 a[104:107], v7 offset:0
ds_read_b64_tr_b16 a[0:1], v13 offset:0
ds_read_b64_tr_b16 a[2:3], v13 offset:2048
ds_read_b64_tr_b16 a[4:5], v14 offset:0
ds_read_b128 a[108:111], v7 offset:2048
ds_read_b64_tr_b16 a[6:7], v14 offset:2048
ds_read_b64_tr_b16 a[8:9], v15 offset:0
ds_read_b64_tr_b16 a[10:11], v15 offset:2048
ds_read_b128 a[112:115], v7 offset:4096
ds_read_b64_tr_b16 a[12:13], v16 offset:0
ds_read_b64_tr_b16 a[14:15], v16 offset:2048
ds_read_b64_tr_b16 a[16:17], v17 offset:0
ds_read_b128 a[116:119], v7 offset:6144
ds_read_b64_tr_b16 a[18:19], v17 offset:2048
ds_read_b64_tr_b16 a[20:21], v18 offset:0
ds_read_b64_tr_b16 a[22:23], v18 offset:2048
ds_read_b64_tr_b16 a[24:25], v19 offset:0
ds_read_b64_tr_b16 a[26:27], v19 offset:2048
s_waitcnt vmcnt(12) lgkmcnt(0)
s_barrier
s_branch Lmain

.p2align 12
Lmain:
Lpad0:
s_cbranch_execz Lpad4
s_nop 0
Lu0:
v_mfma_f32_16x16x32_bf16 v[76:79], a[0:3], a[108:111], v[48:51]
s_add_u32 m0, s73, 32768
ds_read_b128 a[120:123], v8 offset:0
s_mov_b32 s93, 256
v_mfma_f32_16x16x32_bf16 v[104:107], a[0:3], a[112:115], v[48:51]
buffer_load_dwordx4 v2, s[4:7], s93 offen  lds
v_mfma_f32_16x16x32_bf16 v[132:135], a[0:3], a[116:119], v[48:51]
s_add_u32 m0, s73, 36864
ds_read_b64_tr_b16 a[28:29], v13 offset:16384
ds_read_b64_tr_b16 a[30:31], v13 offset:18432
v_mfma_f32_16x16x32_bf16 v[48:51], a[0:3], a[104:107], v[48:51]
s_mov_b32 s94, 65792
ds_read_b64_tr_b16 a[32:33], v14 offset:16384
s_lshl_b32 s3, s76, 1
v_mfma_f32_16x16x32_bf16 v[80:83], a[4:7], a[108:111], v[52:55]
buffer_load_dwordx4 v2, s[4:7], s94 offen  lds
v_mfma_f32_16x16x32_bf16 v[108:111], a[4:7], a[112:115], v[52:55]
s_add_u32 m0, s82, 98304
ds_read_b128 a[124:127], v8 offset:2048
ds_read_b64_tr_b16 a[34:35], v14 offset:18432
v_mfma_f32_16x16x32_bf16 v[136:139], a[4:7], a[116:119], v[52:55]
s_mov_b32 s95, 688128
s_lshr_b32 s70, s74, 3
s_add_u32 s3, s3, s70
v_mfma_f32_16x16x32_bf16 v[52:55], a[4:7], a[104:107], v[52:55]
buffer_load_dwordx4 v6, s[12:15], s95 offen  lds
v_mfma_f32_16x16x32_bf16 v[84:87], a[8:11], a[108:111], v[56:59]
s_add_u32 m0, s82, 100352
ds_read_b64_tr_b16 a[36:37], v15 offset:16384
ds_read_b64_tr_b16 a[38:39], v15 offset:18432
v_mfma_f32_16x16x32_bf16 v[112:115], a[8:11], a[112:115], v[56:59]
s_mov_b32 s96, 716800
ds_read_b128 a[128:131], v8 offset:4096
s_lshl_b32 s3, s3, 7
v_mfma_f32_16x16x32_bf16 v[140:143], a[8:11], a[116:119], v[56:59]
buffer_load_dwordx4 v6, s[12:15], s96 offen  lds
v_mfma_f32_16x16x32_bf16 v[56:59], a[8:11], a[104:107], v[56:59]
s_add_u32 m0, s82, 106496
ds_read_b64_tr_b16 a[40:41], v16 offset:16384
ds_read_b64_tr_b16 a[42:43], v16 offset:18432
v_mfma_f32_16x16x32_bf16 v[88:91], a[12:15], a[108:111], v[60:63]
s_mov_b32 s97, 802816
ds_read_b64_tr_b16 a[44:45], v17 offset:16384
s_add_u32 s3, s3, s101
v_mfma_f32_16x16x32_bf16 v[116:119], a[12:15], a[112:115], v[60:63]
buffer_load_dwordx4 v6, s[12:15], s97 offen  lds
v_mfma_f32_16x16x32_bf16 v[144:147], a[12:15], a[116:119], v[60:63]
s_add_u32 m0, s82, 108544
ds_read_b128 a[132:135], v8 offset:6144
s_mov_b32 s93, 831488
v_mfma_f32_16x16x32_bf16 v[60:63], a[12:15], a[104:107], v[60:63]
s_mul_i32 s71, s3, 14336
ds_read_b64_tr_b16 a[46:47], v17 offset:18432
s_lshl_b32 s70, s3, 12
v_mfma_f32_16x16x32_bf16 v[92:95], a[16:19], a[108:111], v[64:67]
buffer_load_dwordx4 v6, s[12:15], s93 offen  lds
v_mfma_f32_16x16x32_bf16 v[120:123], a[16:19], a[112:115], v[64:67]
s_add_u32 m0, s73, 40960
ds_read_b64_tr_b16 a[48:49], v18 offset:16384
ds_read_b64_tr_b16 a[50:51], v18 offset:18432
v_mfma_f32_16x16x32_bf16 v[148:151], a[16:19], a[116:119], v[64:67]
s_mov_b32 s94, 131328
ds_read_b64_tr_b16 a[52:53], v19 offset:16384
s_lshr_b32 s3, s78, 2
v_mfma_f32_16x16x32_bf16 v[64:67], a[16:19], a[104:107], v[64:67]
buffer_load_dwordx4 v2, s[4:7], s94 offen  lds
v_mfma_f32_16x16x32_bf16 v[96:99], a[20:23], a[108:111], v[68:71]
s_add_u32 m0, s73, 45056
ds_read_b64_tr_b16 a[54:55], v19 offset:18432
s_mov_b32 s95, 196864
v_mfma_f32_16x16x32_bf16 v[124:127], a[20:23], a[112:115], v[68:71]
s_lshl_b32 s3, s3, 10
s_add_u32 s71, s71, s3
s_add_u32 s70, s70, s3
v_mfma_f32_16x16x32_bf16 v[152:155], a[20:23], a[116:119], v[68:71]
v_mfma_f32_16x16x32_bf16 v[68:71], a[20:23], a[104:107], v[68:71]
buffer_load_dwordx4 v2, s[4:7], s95 offen  lds
v_mfma_f32_16x16x32_bf16 v[100:103], a[24:27], a[108:111], v[72:75]
v_mfma_f32_16x16x32_bf16 v[128:131], a[24:27], a[112:115], v[72:75]
v_mfma_f32_16x16x32_bf16 v[156:159], a[24:27], a[116:119], v[72:75]
v_mfma_f32_16x16x32_bf16 v[72:75], a[24:27], a[104:107], v[72:75]
s_mov_b64 exec, 0
s_cmp_eq_u32 s72, 0
s_cbranch_scc1 Lpad1
s_cmp_eq_u32 s72, 1
s_cbranch_scc1 Lpad2
s_cmp_eq_u32 s72, 2
s_cbranch_scc1 Lpad3
s_branch Lpad4
Lpadback0:
s_mov_b64 exec, -1
s_waitcnt vmcnt(14) lgkmcnt(0)
s_barrier
v_mfma_f32_16x16x32_bf16 v[76:79], a[28:31], a[124:127], v[76:79]
s_add_u32 m0, s82, 49152
ds_read_b128 a[136:139], v7 offset:16384
s_mov_b32 s96, 917504
v_mfma_f32_16x16x32_bf16 v[104:107], a[28:31], a[128:131], v[104:107]
buffer_load_dwordx4 v6, s[12:15], s96 offen  lds
v_mfma_f32_16x16x32_bf16 v[132:135], a[28:31], a[132:135], v[132:135]
s_add_u32 m0, s82, 51200
ds_read_b64_tr_b16 a[0:1], v13 offset:32768
ds_read_b64_tr_b16 a[2:3], v13 offset:34816
v_mfma_f32_16x16x32_bf16 v[48:51], a[28:31], a[120:123], v[48:51]
s_mov_b32 s97, 946176
ds_read_b64_tr_b16 a[4:5], v14 offset:32768
v_cmp_gt_u32 vcc, 8, v0
v_mfma_f32_16x16x32_bf16 v[52:55], a[32:35], a[120:123], v[52:55]
buffer_load_dwordx4 v6, s[12:15], s97 offen  lds
v_mfma_f32_16x16x32_bf16 v[136:139], a[32:35], a[132:135], v[136:139]
s_add_u32 m0, s82, 57344
ds_read_b128 a[140:143], v7 offset:18432
ds_read_b64_tr_b16 a[6:7], v14 offset:34816
v_mfma_f32_16x16x32_bf16 v[108:111], a[32:35], a[128:131], v[108:111]
s_mov_b32 s93, 1032192
v_cndmask_b32 v44, v47, v37, vcc
v_cmp_gt_u32 vcc, 14, v0
v_mfma_f32_16x16x32_bf16 v[80:83], a[32:35], a[124:127], v[80:83]
buffer_load_dwordx4 v6, s[12:15], s93 offen  lds
v_mfma_f32_16x16x32_bf16 v[84:87], a[36:39], a[124:127], v[84:87]
s_add_u32 m0, s82, 59392
ds_read_b64_tr_b16 a[8:9], v15 offset:32768
ds_read_b64_tr_b16 a[10:11], v15 offset:34816
v_mfma_f32_16x16x32_bf16 v[112:115], a[36:39], a[128:131], v[112:115]
s_mov_b32 s94, 1060864
ds_read_b128 a[144:147], v7 offset:20480
v_cndmask_b32 v46, v47, v39, vcc
v_mfma_f32_16x16x32_bf16 v[140:143], a[36:39], a[132:135], v[140:143]
buffer_load_dwordx4 v6, s[12:15], s94 offen  lds
v_mfma_f32_16x16x32_bf16 v[56:59], a[36:39], a[120:123], v[56:59]
s_mov_b32 s95, 0
ds_read_b64_tr_b16 a[12:13], v16 offset:32768
ds_read_b64_tr_b16 a[14:15], v16 offset:34816
v_mfma_f32_16x16x32_bf16 v[60:63], a[40:43], a[120:123], v[60:63]
s_add_u32 m0, s81, 114688
ds_read_b64_tr_b16 a[16:17], v17 offset:32768
v_cmp_gt_u32 vcc, 12, v0
v_mfma_f32_16x16x32_bf16 v[144:147], a[40:43], a[132:135], v[144:147]
buffer_load_dwordx4 v3, s[8:11], s95 offen  lds
v_mfma_f32_16x16x32_bf16 v[116:119], a[40:43], a[128:131], v[116:119]
s_add_u32 m0, s81, 115712
ds_read_b128 a[148:151], v7 offset:22528
v_cndmask_b32 v45, v47, v38, vcc
v_mfma_f32_16x16x32_bf16 v[88:91], a[40:43], a[124:127], v[88:91]
s_and_b32 s92, s99, 3
ds_read_b64_tr_b16 a[18:19], v17 offset:34816
s_cmp_eq_u32 s92, 0
s_cselect_b32 s92, 0, s100
v_mfma_f32_16x16x32_bf16 v[92:95], a[44:47], a[124:127], v[92:95]
buffer_load_dwordx4 v4, s[8:11], s95 offen  lds
v_mfma_f32_16x16x32_bf16 v[120:123], a[44:47], a[128:131], v[120:123]
s_add_u32 m0, s81, 116736
ds_read_b64_tr_b16 a[20:21], v18 offset:32768
ds_read_b64_tr_b16 a[22:23], v18 offset:34816
v_mfma_f32_16x16x32_bf16 v[148:151], a[44:47], a[132:135], v[148:151]
s_add_u32 s3, s92, 768
ds_read_b64_tr_b16 a[24:25], v19 offset:32768
v_mfma_f32_16x16x32_bf16 v[64:67], a[44:47], a[120:123], v[64:67]
buffer_load_dwordx4 v5, s[8:11], s95 offen  lds
v_mfma_f32_16x16x32_bf16 v[68:71], a[48:51], a[120:123], v[68:71]
buffer_load_dword a255, v44, s[4:7], s3 offen
v_mfma_f32_16x16x32_bf16 v[152:155], a[48:51], a[132:135], v[152:155]
s_add_u32 m0, s73, 0
ds_read_b64_tr_b16 a[26:27], v19 offset:34816
s_mov_b32 s96, 384
v_mfma_f32_16x16x32_bf16 v[124:127], a[48:51], a[128:131], v[124:127]
s_add_u32 s3, s92, 2752512
v_mfma_f32_16x16x32_bf16 v[96:99], a[48:51], a[124:127], v[96:99]
buffer_load_dwordx4 v2, s[4:7], s96 offen  lds
v_mfma_f32_16x16x32_bf16 v[100:103], a[52:55], a[124:127], v[100:103]
buffer_load_dword a255, v46, s[12:15], s3 offen
v_mfma_f32_16x16x32_bf16 v[128:131], a[52:55], a[128:131], v[128:131]
s_add_u32 s3, s92, 2359296
v_mfma_f32_16x16x32_bf16 v[156:159], a[52:55], a[132:135], v[156:159]
buffer_load_dword a255, v45, s[8:11], s3 offen
v_mfma_f32_16x16x32_bf16 v[72:75], a[52:55], a[120:123], v[72:75]
s_mov_b64 exec, 0
s_cmp_eq_u32 s72, 0
s_cbranch_scc1 Lpad9
s_cmp_eq_u32 s72, 1
s_cbranch_scc1 Lpad10
s_cmp_eq_u32 s72, 2
s_cbranch_scc1 Lpad11
s_branch Lpad12
Lpadback1:
s_mov_b64 exec, -1
s_waitcnt vmcnt(13) lgkmcnt(0)
s_barrier
v_mfma_f32_16x16x32_bf16 v[76:79], a[0:3], a[140:143], v[76:79]
s_add_u32 m0, s73, 4096
ds_read_b128 a[152:155], v8 offset:16384
s_mov_b32 s97, 65920
v_mfma_f32_16x16x32_bf16 v[104:107], a[0:3], a[144:147], v[104:107]
buffer_load_dwordx4 v2, s[4:7], s97 offen  lds
v_mfma_f32_16x16x32_bf16 v[132:135], a[0:3], a[148:151], v[132:135]
s_add_u32 m0, s82, 65536
ds_read_b64_tr_b16 a[28:29], v13 offset:49152
ds_read_b64_tr_b16 a[30:31], v13 offset:51200
v_mfma_f32_16x16x32_bf16 v[48:51], a[0:3], a[136:139], v[48:51]
s_mov_b32 s93, 1146880
ds_read_b64_tr_b16 a[32:33], v14 offset:49152
s_and_b32 s92, s99, 3
v_mfma_f32_16x16x32_bf16 v[52:55], a[4:7], a[136:139], v[52:55]
buffer_load_dwordx4 v6, s[12:15], s93 offen  lds
v_mfma_f32_16x16x32_bf16 v[136:139], a[4:7], a[148:151], v[136:139]
s_add_u32 m0, s82, 67584
ds_read_b128 a[156:159], v8 offset:18432
ds_read_b64_tr_b16 a[34:35], v14 offset:51200
v_mfma_f32_16x16x32_bf16 v[108:111], a[4:7], a[144:147], v[108:111]
s_mov_b32 s94, 1175552
s_cmp_eq_u32 s92, 1
s_cselect_b32 s92, 0, s100
s_add_u32 s3, s92, 768
v_mfma_f32_16x16x32_bf16 v[80:83], a[4:7], a[140:143], v[80:83]
buffer_load_dwordx4 v6, s[12:15], s94 offen  lds
v_mfma_f32_16x16x32_bf16 v[84:87], a[8:11], a[140:143], v[84:87]
s_add_u32 m0, s82, 73728
ds_read_b64_tr_b16 a[36:37], v15 offset:49152
ds_read_b64_tr_b16 a[38:39], v15 offset:51200
v_mfma_f32_16x16x32_bf16 v[112:115], a[8:11], a[144:147], v[112:115]
s_mov_b32 s95, 1261568
ds_read_b128 a[160:163], v8 offset:20480
v_mfma_f32_16x16x32_bf16 v[140:143], a[8:11], a[148:151], v[140:143]
buffer_load_dwordx4 v6, s[12:15], s95 offen  lds
v_mfma_f32_16x16x32_bf16 v[56:59], a[8:11], a[136:139], v[56:59]
s_add_u32 m0, s82, 75776
ds_read_b64_tr_b16 a[40:41], v16 offset:49152
ds_read_b64_tr_b16 a[42:43], v16 offset:51200
v_mfma_f32_16x16x32_bf16 v[60:63], a[12:15], a[136:139], v[60:63]
s_mov_b32 s96, 1290240
ds_read_b64_tr_b16 a[44:45], v17 offset:49152
v_mfma_f32_16x16x32_bf16 v[144:147], a[12:15], a[148:151], v[144:147]
buffer_load_dwordx4 v6, s[12:15], s96 offen  lds
v_mfma_f32_16x16x32_bf16 v[116:119], a[12:15], a[144:147], v[116:119]
buffer_load_dword a255, v44, s[4:7], s3 offen
v_mfma_f32_16x16x32_bf16 v[88:91], a[12:15], a[140:143], v[88:91]
s_mov_b32 s97, 196608
ds_read_b128 a[164:167], v8 offset:22528
ds_read_b64_tr_b16 a[46:47], v17 offset:51200
v_mfma_f32_16x16x32_bf16 v[92:95], a[16:19], a[140:143], v[92:95]
s_add_u32 m0, s81, 126976
ds_read_b64_tr_b16 a[48:49], v18 offset:49152
s_add_u32 s3, s92, 2752512
v_mfma_f32_16x16x32_bf16 v[120:123], a[16:19], a[144:147], v[120:123]
buffer_load_dwordx4 v3, s[8:11], s97 offen  lds
v_mfma_f32_16x16x32_bf16 v[148:151], a[16:19], a[148:151], v[148:151]
s_add_u32 m0, s81, 128000
ds_read_b64_tr_b16 a[50:51], v18 offset:51200
ds_read_b64_tr_b16 a[52:53], v19 offset:49152
v_mfma_f32_16x16x32_bf16 v[64:67], a[16:19], a[136:139], v[64:67]
buffer_load_dwordx4 v4, s[8:11], s97 offen  lds
v_mfma_f32_16x16x32_bf16 v[68:71], a[20:23], a[136:139], v[68:71]
buffer_load_dword a255, v46, s[12:15], s3 offen
v_mfma_f32_16x16x32_bf16 v[152:155], a[20:23], a[148:151], v[152:155]
s_add_u32 m0, s81, 129024
ds_read_b64_tr_b16 a[54:55], v19 offset:51200
s_add_u32 s3, s92, 2359296
v_mfma_f32_16x16x32_bf16 v[124:127], a[20:23], a[144:147], v[124:127]
v_mfma_f32_16x16x32_bf16 v[96:99], a[20:23], a[140:143], v[96:99]
buffer_load_dwordx4 v5, s[8:11], s97 offen  lds
v_mfma_f32_16x16x32_bf16 v[100:103], a[24:27], a[140:143], v[100:103]
buffer_load_dword a255, v45, s[8:11], s3 offen
v_mfma_f32_16x16x32_bf16 v[128:131], a[24:27], a[144:147], v[128:131]
s_nop 0
v_mfma_f32_16x16x32_bf16 v[156:159], a[24:27], a[148:151], v[156:159]
s_waitcnt vmcnt(15) lgkmcnt(0)
v_mfma_f32_16x16x32_bf16 v[72:75], a[24:27], a[136:139], v[72:75]
s_barrier
v_mfma_f32_16x16x32_bf16 v[76:79], a[28:31], a[156:159], v[76:79]
s_add_u32 m0, s73, 8192
ds_read_b128 a[168:171], v7 offset:32768
ds_read_b64_tr_b16 a[0:1], v13 offset:0
v_mfma_f32_16x16x32_bf16 v[104:107], a[28:31], a[160:163], v[104:107]
s_mov_b32 s93, 131456
ds_read_b64_tr_b16 a[2:3], v13 offset:2048
s_and_b32 s92, s99, 3
v_mfma_f32_16x16x32_bf16 v[132:135], a[28:31], a[164:167], v[132:135]
buffer_load_dwordx4 v2, s[4:7], s93 offen  lds
v_mfma_f32_16x16x32_bf16 v[48:51], a[28:31], a[152:155], v[48:51]
s_add_u32 m0, s73, 12288
ds_read_b64_tr_b16 a[4:5], v14 offset:0
ds_read_b64_tr_b16 a[6:7], v14 offset:2048
v_mfma_f32_16x16x32_bf16 v[52:55], a[32:35], a[152:155], v[52:55]
s_mov_b32 s94, 196992
ds_read_b64_tr_b16 a[8:9], v15 offset:0
ds_read_b64_tr_b16 a[10:11], v15 offset:2048
v_mfma_f32_16x16x32_bf16 v[136:139], a[32:35], a[164:167], v[136:139]
buffer_load_dwordx4 v2, s[4:7], s94 offen  lds
v_mfma_f32_16x16x32_bf16 v[108:111], a[32:35], a[160:163], v[108:111]
s_add_u32 m0, s82, 81920
ds_read_b128 a[172:175], v7 offset:34816
ds_read_b64_tr_b16 a[12:13], v16 offset:0
v_mfma_f32_16x16x32_bf16 v[80:83], a[32:35], a[156:159], v[80:83]
s_mov_b32 s95, 1376256
ds_read_b64_tr_b16 a[14:15], v16 offset:2048
ds_read_b64_tr_b16 a[16:17], v17 offset:0
v_mfma_f32_16x16x32_bf16 v[84:87], a[36:39], a[156:159], v[84:87]
buffer_load_dwordx4 v6, s[12:15], s95 offen  lds
v_mfma_f32_16x16x32_bf16 v[112:115], a[36:39], a[160:163], v[112:115]
s_add_u32 m0, s82, 83968
ds_read_b64_tr_b16 a[18:19], v17 offset:2048
ds_read_b64_tr_b16 a[20:21], v18 offset:0
v_mfma_f32_16x16x32_bf16 v[140:143], a[36:39], a[164:167], v[140:143]
s_mov_b32 s96, 1404928
ds_read_b64_tr_b16 a[22:23], v18 offset:2048
ds_read_b128 a[176:179], v7 offset:36864
v_mfma_f32_16x16x32_bf16 v[56:59], a[36:39], a[152:155], v[56:59]
buffer_load_dwordx4 v6, s[12:15], s96 offen  lds
v_mfma_f32_16x16x32_bf16 v[60:63], a[40:43], a[152:155], v[60:63]
s_add_u32 m0, s82, 90112
ds_read_b64_tr_b16 a[24:25], v19 offset:0
ds_read_b64_tr_b16 a[26:27], v19 offset:2048
v_mfma_f32_16x16x32_bf16 v[144:147], a[40:43], a[164:167], v[144:147]
s_mov_b32 s97, 1490944
ds_read_b64_tr_b16 a[64:65], v9 offset:128
ds_read_b64_tr_b16 a[66:67], v9 offset:1664
v_mfma_f32_16x16x32_bf16 v[116:119], a[40:43], a[160:163], v[116:119]
buffer_load_dwordx4 v6, s[12:15], s97 offen  lds
v_mfma_f32_16x16x32_bf16 v[88:91], a[40:43], a[156:159], v[88:91]
s_add_u32 m0, s82, 92160
ds_read_b64_tr_b16 a[68:69], v10 offset:128
ds_read_b64_tr_b16 a[70:71], v10 offset:1664
v_mfma_f32_16x16x32_bf16 v[92:95], a[44:47], a[156:159], v[92:95]
s_mov_b32 s93, 1519616
ds_read_b128 a[180:183], v7 offset:38912
ds_read_b64_tr_b16 a[72:73], v9 offset:256
v_mfma_f32_16x16x32_bf16 v[120:123], a[44:47], a[160:163], v[120:123]
buffer_load_dwordx4 v6, s[12:15], s93 offen  lds
v_mfma_f32_16x16x32_bf16 v[148:151], a[44:47], a[164:167], v[148:151]
s_mov_b32 s94, 393216
ds_read_b64_tr_b16 a[74:75], v9 offset:1792
ds_read_b64_tr_b16 a[76:77], v10 offset:256
v_mfma_f32_16x16x32_bf16 v[64:67], a[44:47], a[152:155], v[64:67]
s_add_u32 m0, s81, 139264
ds_read_b64_tr_b16 a[78:79], v10 offset:1792
ds_read_b64_tr_b16 a[56:57], v9 offset:0
v_mfma_f32_16x16x32_bf16 v[68:71], a[48:51], a[152:155], v[68:71]
buffer_load_dwordx4 v3, s[8:11], s94 offen  lds
v_mfma_f32_16x16x32_bf16 v[152:155], a[48:51], a[164:167], v[152:155]
s_add_u32 m0, s81, 140288
ds_read_b64_tr_b16 a[58:59], v9 offset:1536
ds_read_b64_tr_b16 a[60:61], v10 offset:0
v_mfma_f32_16x16x32_bf16 v[124:127], a[48:51], a[160:163], v[124:127]
buffer_load_dwordx4 v4, s[8:11], s94 offen  lds
v_mfma_f32_16x16x32_bf16 v[96:99], a[48:51], a[156:159], v[96:99]
s_add_u32 m0, s81, 141312
ds_read_b64_tr_b16 a[62:63], v10 offset:1536
s_cmp_eq_u32 s92, 2
s_cselect_b32 s92, 0, s100
v_mfma_f32_16x16x32_bf16 v[100:103], a[52:55], a[156:159], v[100:103]
buffer_load_dwordx4 v5, s[8:11], s94 offen  lds
v_mfma_f32_16x16x32_bf16 v[128:131], a[52:55], a[160:163], v[128:131]
s_add_u32 s3, s92, 768
v_mfma_f32_16x16x32_bf16 v[156:159], a[52:55], a[164:167], v[156:159]
s_waitcnt vmcnt(10) lgkmcnt(0)
v_mfma_f32_16x16x32_bf16 v[72:75], a[52:55], a[152:155], v[72:75]
s_barrier
Lu4:
v_mfma_f32_16x16x32_bf16 v[76:79], a[0:3], a[172:175], v[76:79]
s_add_u32 m0, s73, 16384
ds_read_b128 a[184:187], v8 offset:32768
s_mov_b32 s95, 512
v_mfma_f32_16x16x32_bf16 v[104:107], a[0:3], a[176:179], v[104:107]
buffer_load_dwordx4 v2, s[4:7], s95 offen  lds
v_mfma_f32_16x16x32_bf16 v[132:135], a[0:3], a[180:183], v[132:135]
buffer_load_dword a255, v44, s[4:7], s3 offen
v_mfma_f32_16x16x32_bf16 v[48:51], a[0:3], a[168:171], v[48:51]
s_add_u32 m0, s73, 20480
ds_read_b64_tr_b16 a[28:29], v13 offset:16384
ds_read_b64_tr_b16 a[30:31], v13 offset:18432
v_mfma_f32_16x16x32_bf16 v[52:55], a[4:7], a[168:171], v[52:55]
s_mov_b32 s96, 66048
ds_read_b64_tr_b16 a[32:33], v14 offset:16384
s_add_u32 s3, s92, 2752512
v_mfma_f32_16x16x32_bf16 v[136:139], a[4:7], a[180:183], v[136:139]
buffer_load_dwordx4 v2, s[4:7], s96 offen  lds
v_mfma_f32_16x16x32_bf16 v[108:111], a[4:7], a[176:179], v[108:111]
buffer_load_dword a255, v46, s[12:15], s3 offen
v_mfma_f32_16x16x32_bf16 v[80:83], a[4:7], a[172:175], v[80:83]
s_add_u32 m0, s82, 98304
ds_read_b64_tr_b16 a[34:35], v14 offset:18432
ds_read_b64_tr_b16 a[36:37], v15 offset:16384
v_mfma_f32_16x16x32_bf16 v[84:87], a[8:11], a[172:175], v[84:87]
s_mov_b32 s97, 1605632
s_add_u32 s3, s92, 2359296
v_mfma_f32_16x16x32_bf16 v[112:115], a[8:11], a[176:179], v[112:115]
buffer_load_dwordx4 v6, s[12:15], s97 offen  lds
v_mfma_f32_16x16x32_bf16 v[140:143], a[8:11], a[180:183], v[140:143]
s_add_u32 m0, s82, 100352
ds_read_b64_tr_b16 a[38:39], v15 offset:18432
ds_read_b128 a[188:191], v8 offset:34816
v_mfma_f32_16x16x32_bf16 v[56:59], a[8:11], a[168:171], v[56:59]
s_mov_b32 s93, 1634304
v_mfma_f32_16x16x32_bf16 v[60:63], a[12:15], a[168:171], v[60:63]
buffer_load_dwordx4 v6, s[12:15], s93 offen  lds
v_mfma_f32_16x16x32_bf16 v[144:147], a[12:15], a[180:183], v[144:147]
s_add_u32 m0, s82, 106496
ds_read_b64_tr_b16 a[40:41], v16 offset:16384
ds_read_b64_tr_b16 a[42:43], v16 offset:18432
v_mfma_f32_16x16x32_bf16 v[116:119], a[12:15], a[176:179], v[116:119]
s_mov_b32 s94, 1720320
v_mfma_f32_16x16x32_bf16 v[88:91], a[12:15], a[172:175], v[88:91]
buffer_load_dwordx4 v6, s[12:15], s94 offen  lds
v_mfma_f32_16x16x32_bf16 v[92:95], a[16:19], a[172:175], v[92:95]
s_add_u32 m0, s82, 108544
ds_read_b64_tr_b16 a[44:45], v17 offset:16384
ds_read_b64_tr_b16 a[46:47], v17 offset:18432
v_mfma_f32_16x16x32_bf16 v[120:123], a[16:19], a[176:179], v[120:123]
buffer_load_dword a255, v45, s[8:11], s3 offen
v_mfma_f32_16x16x32_bf16 v[148:151], a[16:19], a[180:183], v[148:151]
s_mov_b32 s95, 1748992
ds_read_b64_tr_b16 a[48:49], v18 offset:16384
s_and_b32 s92, s99, 3
v_mfma_f32_16x16x32_bf16 v[64:67], a[16:19], a[168:171], v[64:67]
buffer_load_dwordx4 v6, s[12:15], s95 offen  lds
v_mfma_f32_16x16x32_bf16 v[68:71], a[20:23], a[168:171], v[68:71]
s_mov_b32 s96, 589824
ds_read_b64_tr_b16 a[50:51], v18 offset:18432
s_add_u32 m0, s81, 151552
v_mfma_f32_16x16x32_bf16 v[152:155], a[20:23], a[180:183], v[152:155]
s_cmp_eq_u32 s92, 3
s_cselect_b32 s92, 0, s100
ds_read_b128 a[192:195], v8 offset:36864
s_add_u32 s3, s92, 768
v_mfma_f32_16x16x32_bf16 v[124:127], a[20:23], a[176:179], v[124:127]
s_nop 0
ds_read_b64_tr_b16 a[52:53], v19 offset:16384
v_mfma_f32_16x16x32_bf16 v[96:99], a[20:23], a[172:175], v[96:99]
buffer_load_dwordx4 v3, s[8:11], s96 offen  lds
v_mfma_f32_16x16x32_bf16 v[100:103], a[24:27], a[172:175], v[100:103]
buffer_load_dword a255, v44, s[4:7], s3 offen
v_mfma_f32_16x16x32_bf16 v[128:131], a[24:27], a[176:179], v[128:131]
s_add_u32 m0, s81, 152576
ds_read_b64_tr_b16 a[54:55], v19 offset:18432
ds_read_b64_tr_b16 a[88:89], v9 offset:12416
v_mfma_f32_16x16x32_bf16 v[156:159], a[24:27], a[180:183], v[156:159]
buffer_load_dwordx4 v4, s[8:11], s96 offen  lds
v_mfma_f32_16x16x32_bf16 v[72:75], a[24:27], a[168:171], v[72:75]
s_add_u32 m0, s81, 153600
ds_read_b64_tr_b16 a[90:91], v9 offset:13952
s_add_u32 s3, s92, 2752512
v_mfma_f32_16x16x32_bf16 v[160:163], a[104:107], a[64:67], 0
buffer_load_dword a255, v46, s[12:15], s3 offen
v_mfma_f32_16x16x32_bf16 v[164:167], a[108:111], a[64:67], 0
s_add_u32 s3, s92, 2359296
ds_read_b64_tr_b16 a[92:93], v10 offset:12416
v_mfma_f32_16x16x32_bf16 v[176:179], a[112:115], a[64:67], 0
buffer_load_dwordx4 v5, s[8:11], s96 offen  lds
v_mfma_f32_16x16x32_bf16 v[180:183], a[116:119], a[64:67], 0
s_add_u32 m0, s73, 24576
ds_read_b64_tr_b16 a[94:95], v10 offset:13952
ds_read_b128 a[196:199], v8 offset:38912
v_mfma_f32_16x16x32_bf16 v[188:191], a[116:119], a[68:71], 0
buffer_load_dword a255, v45, s[8:11], s3 offen
v_mfma_f32_16x16x32_bf16 v[184:187], a[112:115], a[68:71], 0
s_mov_b32 s97, 131584
ds_read_b64_tr_b16 a[96:97], v9 offset:12544
v_mfma_f32_16x16x32_bf16 v[172:175], a[108:111], a[68:71], 0
buffer_load_dwordx4 v2, s[4:7], s97 offen  lds
v_mfma_f32_16x16x32_bf16 v[168:171], a[104:107], a[68:71], 0
s_add_u32 m0, s73, 28672
ds_read_b64_tr_b16 a[98:99], v9 offset:14080
s_mov_b32 s93, 197120
v_mfma_f32_16x16x32_bf16 v[192:195], a[104:107], a[72:75], 0
ds_read_b64_tr_b16 a[100:101], v10 offset:12544
v_mfma_f32_16x16x32_bf16 v[196:199], a[108:111], a[72:75], 0
buffer_load_dwordx4 v2, s[4:7], s93 offen  lds
v_mfma_f32_16x16x32_bf16 v[208:211], a[112:115], a[72:75], 0
s_add_u32 m0, s82, 49152
ds_read_b64_tr_b16 a[102:103], v10 offset:14080
s_mov_b32 s94, 1835008
v_mfma_f32_16x16x32_bf16 v[212:215], a[116:119], a[72:75], 0
ds_read_b64_tr_b16 a[80:81], v9 offset:12288
v_mfma_f32_16x16x32_bf16 v[220:223], a[116:119], a[76:79], 0
ds_read_b64_tr_b16 a[82:83], v9 offset:13824
v_mfma_f32_16x16x32_bf16 v[216:219], a[112:115], a[76:79], 0
buffer_load_dwordx4 v6, s[12:15], s94 offen  lds
v_mfma_f32_16x16x32_bf16 v[204:207], a[108:111], a[76:79], 0
s_add_u32 m0, s82, 51200
ds_read_b64_tr_b16 a[84:85], v10 offset:12288
s_mov_b32 s95, 1863680
v_mfma_f32_16x16x32_bf16 v[200:203], a[104:107], a[76:79], 0
v_mfma_f32_16x16x32_bf16 v[224:227], a[56:59], a[104:107], 0
ds_read_b64_tr_b16 a[86:87], v10 offset:13824
v_mfma_f32_16x16x32_bf16 v[232:235], a[56:59], a[108:111], 0
buffer_load_dwordx4 v6, s[12:15], s95 offen  lds
v_mfma_f32_16x16x32_bf16 v[240:243], a[56:59], a[112:115], 0
v_mfma_f32_16x16x32_bf16 v[248:251], a[56:59], a[116:119], 0
v_mfma_f32_16x16x32_bf16 v[252:255], a[60:63], a[116:119], 0
v_mfma_f32_16x16x32_bf16 v[244:247], a[60:63], a[112:115], 0
v_mfma_f32_16x16x32_bf16 v[236:239], a[60:63], a[108:111], 0
s_waitcnt vmcnt(19) lgkmcnt(0)
v_mfma_f32_16x16x32_bf16 v[228:231], a[60:63], a[104:107], 0
s_barrier
v_mfma_f32_16x16x32_bf16 v[76:79], a[28:31], a[188:191], v[76:79]
s_add_u32 m0, s82, 57344
ds_read_b128 a[104:107], v7 offset:0
s_mov_b32 s96, 1949696
v_mfma_f32_16x16x32_bf16 v[104:107], a[28:31], a[192:195], v[104:107]
buffer_load_dwordx4 v6, s[12:15], s96 offen  lds
v_mfma_f32_16x16x32_bf16 v[132:135], a[28:31], a[196:199], v[132:135]
s_add_u32 m0, s82, 59392
ds_read_b64_tr_b16 a[0:1], v13 offset:32768
s_mov_b32 s97, 1978368
v_mfma_f32_16x16x32_bf16 v[48:51], a[28:31], a[184:187], v[48:51]
s_and_b32 s51, s2, 8
ds_read_b64_tr_b16 a[2:3], v13 offset:34816
s_lshl_b32 s51, s51, 4
v_mfma_f32_16x16x32_bf16 v[52:55], a[32:35], a[184:187], v[52:55]
buffer_load_dwordx4 v6, s[12:15], s97 offen  lds
v_mfma_f32_16x16x32_bf16 v[136:139], a[32:35], a[196:199], v[136:139]
s_mov_b32 s93, 786432
ds_read_b64_tr_b16 a[4:5], v14 offset:32768
s_add_u32 m0, s81, 114688
v_mfma_f32_16x16x32_bf16 v[108:111], a[32:35], a[192:195], v[108:111]
s_cmp_eq_u32 s72, 0
s_cselect_b32 s51, s51, s100
ds_read_b64_tr_b16 a[6:7], v14 offset:34816
v_mfma_f32_16x16x32_bf16 v[80:83], a[32:35], a[188:191], v[80:83]
buffer_load_dwordx4 v3, s[8:11], s93 offen  lds
v_mfma_f32_16x16x32_bf16 v[84:87], a[36:39], a[188:191], v[84:87]
s_add_u32 m0, s81, 115712
ds_read_b64_tr_b16 a[8:9], v15 offset:32768
v_mfma_f32_16x16x32_bf16 v[112:115], a[36:39], a[192:195], v[112:115]
ds_read_b64_tr_b16 a[10:11], v15 offset:34816
v_mfma_f32_16x16x32_bf16 v[140:143], a[36:39], a[196:199], v[140:143]
ds_read_b128 a[108:111], v7 offset:2048
v_mfma_f32_16x16x32_bf16 v[56:59], a[36:39], a[184:187], v[56:59]
buffer_load_dwordx4 v4, s[8:11], s93 offen  lds
v_mfma_f32_16x16x32_bf16 v[60:63], a[40:43], a[184:187], v[60:63]
s_add_u32 m0, s81, 116736
ds_read_b64_tr_b16 a[12:13], v16 offset:32768
v_mfma_f32_16x16x32_bf16 v[144:147], a[40:43], a[196:199], v[144:147]
ds_read_b64_tr_b16 a[14:15], v16 offset:34816
v_mfma_f32_16x16x32_bf16 v[116:119], a[40:43], a[192:195], v[116:119]
buffer_load_dwordx4 v5, s[8:11], s93 offen  lds
v_mfma_f32_16x16x32_bf16 v[88:91], a[40:43], a[188:191], v[88:91]
s_add_u32 m0, s73, 32768
ds_read_b64_tr_b16 a[16:17], v17 offset:32768
s_mov_b32 s94, 640
v_mfma_f32_16x16x32_bf16 v[92:95], a[44:47], a[188:191], v[92:95]
ds_read_b64_tr_b16 a[18:19], v17 offset:34816
v_mfma_f32_16x16x32_bf16 v[120:123], a[44:47], a[192:195], v[120:123]
buffer_load_dwordx4 v2, s[4:7], s94 offen  lds
v_mfma_f32_16x16x32_bf16 v[148:151], a[44:47], a[196:199], v[148:151]
s_add_u32 m0, s73, 36864
ds_read_b64_tr_b16 a[20:21], v18 offset:32768
s_mov_b32 s95, 66176
v_mfma_f32_16x16x32_bf16 v[64:67], a[44:47], a[184:187], v[64:67]
Lpad1:
s_cbranch_execz Lpad5
s_nop 0
ds_read_b64_tr_b16 a[22:23], v18 offset:34816
v_mfma_f32_16x16x32_bf16 v[68:71], a[48:51], a[184:187], v[68:71]
v_mfma_f32_16x16x32_bf16 v[152:155], a[48:51], a[196:199], v[152:155]
buffer_load_dwordx4 v2, s[4:7], s95 offen  lds
v_mfma_f32_16x16x32_bf16 v[124:127], a[48:51], a[192:195], v[124:127]
s_add_u32 m0, s82, 65536
ds_read_b128 a[112:115], v7 offset:4096
ds_read_b64_tr_b16 a[24:25], v19 offset:32768
v_mfma_f32_16x16x32_bf16 v[96:99], a[48:51], a[188:191], v[96:99]
s_mov_b32 s96, 2064384
v_mfma_f32_16x16x32_bf16 v[100:103], a[52:55], a[188:191], v[100:103]
buffer_load_dwordx4 v6, s[12:15], s96 offen  lds
v_mfma_f32_16x16x32_bf16 v[128:131], a[52:55], a[192:195], v[128:131]
s_add_u32 m0, s82, 67584
ds_read_b64_tr_b16 a[26:27], v19 offset:34816
ds_read_b64_tr_b16 a[64:65], v9 offset:24704
v_mfma_f32_16x16x32_bf16 v[156:159], a[52:55], a[196:199], v[156:159]
s_mov_b32 s97, 2093056
v_mfma_f32_16x16x32_bf16 v[72:75], a[52:55], a[184:187], v[72:75]
ds_read_b64_tr_b16 a[66:67], v9 offset:26240
v_mfma_f32_16x16x32_bf16 v[160:163], a[120:123], a[88:91], v[160:163]
buffer_load_dwordx4 v6, s[12:15], s97 offen  lds
v_mfma_f32_16x16x32_bf16 v[164:167], a[124:127], a[88:91], v[164:167]
s_add_u32 m0, s82, 73728
ds_read_b64_tr_b16 a[68:69], v10 offset:24704
s_mov_b32 s93, 2179072
v_mfma_f32_16x16x32_bf16 v[176:179], a[128:131], a[88:91], v[176:179]
ds_read_b64_tr_b16 a[70:71], v10 offset:26240
v_mfma_f32_16x16x32_bf16 v[180:183], a[132:135], a[88:91], v[180:183]
buffer_load_dwordx4 v6, s[12:15], s93 offen  lds
v_mfma_f32_16x16x32_bf16 v[188:191], a[132:135], a[92:95], v[188:191]
s_add_u32 m0, s82, 75776
ds_read_b128 a[116:119], v7 offset:6144
s_mov_b32 s94, 2207744
v_mfma_f32_16x16x32_bf16 v[184:187], a[128:131], a[92:95], v[184:187]
ds_read_b64_tr_b16 a[72:73], v9 offset:24832
v_mfma_f32_16x16x32_bf16 v[172:175], a[124:127], a[92:95], v[172:175]
buffer_load_dwordx4 v6, s[12:15], s94 offen  lds
v_mfma_f32_16x16x32_bf16 v[168:171], a[120:123], a[92:95], v[168:171]
s_mov_b32 s95, 983040
ds_read_b64_tr_b16 a[74:75], v9 offset:26368
s_add_u32 m0, s81, 126976
v_mfma_f32_16x16x32_bf16 v[192:195], a[120:123], a[96:99], v[192:195]
ds_read_b64_tr_b16 a[76:77], v10 offset:24832
v_mfma_f32_16x16x32_bf16 v[196:199], a[124:127], a[96:99], v[196:199]
ds_read_b64_tr_b16 a[78:79], v10 offset:26368
v_mfma_f32_16x16x32_bf16 v[208:211], a[128:131], a[96:99], v[208:211]
buffer_load_dwordx4 v3, s[8:11], s95 offen  lds
v_mfma_f32_16x16x32_bf16 v[212:215], a[132:135], a[96:99], v[212:215]
s_add_u32 m0, s81, 128000
ds_read_b64_tr_b16 a[56:57], v9 offset:24576
v_mfma_f32_16x16x32_bf16 v[220:223], a[132:135], a[100:103], v[220:223]
ds_read_b64_tr_b16 a[58:59], v9 offset:26112
v_mfma_f32_16x16x32_bf16 v[216:219], a[128:131], a[100:103], v[216:219]
buffer_load_dwordx4 v4, s[8:11], s95 offen  lds
v_mfma_f32_16x16x32_bf16 v[204:207], a[124:127], a[100:103], v[204:207]
s_add_u32 m0, s81, 129024
ds_read_b64_tr_b16 a[60:61], v10 offset:24576
v_mfma_f32_16x16x32_bf16 v[200:203], a[120:123], a[100:103], v[200:203]
v_mfma_f32_16x16x32_bf16 v[224:227], a[80:83], a[120:123], v[224:227]
ds_read_b64_tr_b16 a[62:63], v10 offset:26112
v_mfma_f32_16x16x32_bf16 v[232:235], a[80:83], a[124:127], v[232:235]
buffer_load_dwordx4 v5, s[8:11], s95 offen  lds
v_mfma_f32_16x16x32_bf16 v[240:243], a[80:83], a[128:131], v[240:243]
v_mfma_f32_16x16x32_bf16 v[248:251], a[80:83], a[132:135], v[248:251]
v_mfma_f32_16x16x32_bf16 v[252:255], a[84:87], a[132:135], v[252:255]
v_mfma_f32_16x16x32_bf16 v[244:247], a[84:87], a[128:131], v[244:247]
v_mfma_f32_16x16x32_bf16 v[236:239], a[84:87], a[124:127], v[236:239]
s_waitcnt vmcnt(19) lgkmcnt(0)
v_mfma_f32_16x16x32_bf16 v[228:231], a[84:87], a[120:123], v[228:231]
s_barrier
v_mfma_f32_16x16x32_bf16 v[76:79], a[0:3], a[108:111], v[76:79]
s_add_u32 m0, s73, 40960
ds_read_b128 a[120:123], v8 offset:0
s_mov_b32 s96, 131712
v_mfma_f32_16x16x32_bf16 v[104:107], a[0:3], a[112:115], v[104:107]
buffer_load_dwordx4 v2, s[4:7], s96 offen  lds
v_mfma_f32_16x16x32_bf16 v[132:135], a[0:3], a[116:119], v[132:135]
s_add_u32 m0, s73, 45056
ds_read_b64_tr_b16 a[28:29], v13 offset:49152
s_mov_b32 s97, 197248
v_mfma_f32_16x16x32_bf16 v[48:51], a[0:3], a[104:107], v[48:51]
ds_read_b64_tr_b16 a[30:31], v13 offset:51200
v_cmp_gt_u32 vcc, 12, v0
v_mfma_f32_16x16x32_bf16 v[52:55], a[4:7], a[104:107], v[52:55]
ds_read_b64_tr_b16 a[32:33], v14 offset:49152
v_cndmask_b32 v44, v47, v37, vcc
v_mfma_f32_16x16x32_bf16 v[136:139], a[4:7], a[116:119], v[136:139]
s_nop 0
v_cmp_gt_u32 vcc, 21, v0
v_mfma_f32_16x16x32_bf16 v[108:111], a[4:7], a[112:115], v[108:111]
buffer_load_dwordx4 v2, s[4:7], s97 offen  lds
v_mfma_f32_16x16x32_bf16 v[80:83], a[4:7], a[108:111], v[80:83]
s_add_u32 m0, s82, 81920
ds_read_b64_tr_b16 a[34:35], v14 offset:51200
ds_read_b64_tr_b16 a[36:37], v15 offset:49152
v_mfma_f32_16x16x32_bf16 v[84:87], a[8:11], a[108:111], v[84:87]
s_mov_b32 s93, 2293760
v_cndmask_b32 v46, v47, v39, vcc
v_cmp_gt_u32 vcc, 18, v0
v_mfma_f32_16x16x32_bf16 v[112:115], a[8:11], a[112:115], v[112:115]
s_nop 0
ds_read_b64_tr_b16 a[38:39], v15 offset:51200
v_cndmask_b32 v45, v47, v38, vcc
v_mfma_f32_16x16x32_bf16 v[140:143], a[8:11], a[116:119], v[140:143]
s_cmp_eq_u32 s99, 0
s_cselect_b32 s92, 0, s100
ds_read_b128 a[124:127], v8 offset:2048
s_add_u32 s3, s92, 1280
v_mfma_f32_16x16x32_bf16 v[56:59], a[8:11], a[104:107], v[56:59]
v_mfma_f32_16x16x32_bf16 v[60:63], a[12:15], a[104:107], v[60:63]
buffer_load_dwordx4 v6, s[12:15], s93 offen  lds
v_mfma_f32_16x16x32_bf16 v[144:147], a[12:15], a[116:119], v[144:147]
s_add_u32 m0, s82, 83968
ds_read_b64_tr_b16 a[40:41], v16 offset:49152
ds_read_b64_tr_b16 a[42:43], v16 offset:51200
v_mfma_f32_16x16x32_bf16 v[116:119], a[12:15], a[112:115], v[116:119]
buffer_load_dword a255, v44, s[4:7], s3 offen
v_mfma_f32_16x16x32_bf16 v[88:91], a[12:15], a[108:111], v[88:91]
s_mov_b32 s94, 2322432
ds_read_b64_tr_b16 a[44:45], v17 offset:49152
s_add_u32 s3, s92, 4587520
v_mfma_f32_16x16x32_bf16 v[92:95], a[16:19], a[108:111], v[92:95]
ds_read_b64_tr_b16 a[46:47], v17 offset:51200
v_mfma_f32_16x16x32_bf16 v[120:123], a[16:19], a[112:115], v[120:123]
buffer_load_dwordx4 v6, s[12:15], s94 offen  lds
v_mfma_f32_16x16x32_bf16 v[148:151], a[16:19], a[116:119], v[148:151]
buffer_load_dword a255, v46, s[12:15], s3 offen
v_mfma_f32_16x16x32_bf16 v[64:67], a[16:19], a[104:107], v[64:67]
s_add_u32 m0, s82, 90112
ds_read_b64_tr_b16 a[48:49], v18 offset:49152
ds_read_b64_tr_b16 a[50:51], v18 offset:51200
v_mfma_f32_16x16x32_bf16 v[68:71], a[20:23], a[104:107], v[68:71]
s_mov_b32 s95, 2408448
s_cmp_eq_u32 s99, 0
s_cselect_b32 s98, s51, s100
s_add_u32 s3, s92, 3932160
v_mfma_f32_16x16x32_bf16 v[152:155], a[20:23], a[116:119], v[152:155]
buffer_load_dword a255, v45, s[8:11], s3 offen
v_mfma_f32_16x16x32_bf16 v[124:127], a[20:23], a[112:115], v[124:127]
s_nop 0
ds_read_b128 a[128:131], v8 offset:4096
ds_read_b64_tr_b16 a[52:53], v19 offset:49152
v_mfma_f32_16x16x32_bf16 v[96:99], a[20:23], a[108:111], v[96:99]
buffer_load_dwordx4 v6, s[12:15], s95 offen  lds
v_mfma_f32_16x16x32_bf16 v[100:103], a[24:27], a[108:111], v[100:103]
s_add_u32 m0, s82, 92160
ds_read_b64_tr_b16 a[54:55], v19 offset:51200
s_mov_b32 s96, 2437120
v_mfma_f32_16x16x32_bf16 v[128:131], a[24:27], a[112:115], v[128:131]
ds_read_b64_tr_b16 a[88:89], v9 offset:36992
v_mfma_f32_16x16x32_bf16 v[156:159], a[24:27], a[116:119], v[156:159]
v_mfma_f32_16x16x32_bf16 v[72:75], a[24:27], a[104:107], v[72:75]
s_nop 0
ds_read_b64_tr_b16 a[90:91], v9 offset:38528
v_mfma_f32_16x16x32_bf16 v[160:163], a[136:139], a[64:67], v[160:163]
buffer_load_dwordx4 v6, s[12:15], s96 offen  lds
v_mfma_f32_16x16x32_bf16 v[164:167], a[140:143], a[64:67], v[164:167]
s_mov_b32 s97, 1179648
ds_read_b64_tr_b16 a[92:93], v10 offset:36992
s_add_u32 m0, s81, 139264
v_mfma_f32_16x16x32_bf16 v[176:179], a[144:147], a[64:67], v[176:179]
ds_read_b64_tr_b16 a[94:95], v10 offset:38528
v_mfma_f32_16x16x32_bf16 v[180:183], a[148:151], a[64:67], v[180:183]
ds_read_b128 a[132:135], v8 offset:6144
v_mfma_f32_16x16x32_bf16 v[188:191], a[148:151], a[68:71], v[188:191]
v_mfma_f32_16x16x32_bf16 v[184:187], a[144:147], a[68:71], v[184:187]
ds_read_b64_tr_b16 a[96:97], v9 offset:37120
v_mfma_f32_16x16x32_bf16 v[172:175], a[140:143], a[68:71], v[172:175]
buffer_load_dwordx4 v3, s[8:11], s97 offen  lds
v_mfma_f32_16x16x32_bf16 v[168:171], a[136:139], a[68:71], v[168:171]
s_add_u32 m0, s81, 140288
ds_read_b64_tr_b16 a[98:99], v9 offset:38656
v_mfma_f32_16x16x32_bf16 v[192:195], a[136:139], a[72:75], v[192:195]
ds_read_b64_tr_b16 a[100:101], v10 offset:37120
v_mfma_f32_16x16x32_bf16 v[196:199], a[140:143], a[72:75], v[196:199]
ds_read_b64_tr_b16 a[102:103], v10 offset:38656
v_mfma_f32_16x16x32_bf16 v[208:211], a[144:147], a[72:75], v[208:211]
v_mfma_f32_16x16x32_bf16 v[212:215], a[148:151], a[72:75], v[212:215]
buffer_load_dwordx4 v4, s[8:11], s97 offen  lds
v_mfma_f32_16x16x32_bf16 v[220:223], a[148:151], a[76:79], v[220:223]
s_add_u32 m0, s81, 141312
ds_read_b64_tr_b16 a[80:81], v9 offset:36864
ds_read_b64_tr_b16 a[82:83], v9 offset:38400
v_mfma_f32_16x16x32_bf16 v[216:219], a[144:147], a[76:79], v[216:219]
s_nop 0
v_mfma_f32_16x16x32_bf16 v[204:207], a[140:143], a[76:79], v[204:207]
ds_read_b64_tr_b16 a[84:85], v10 offset:36864
v_mfma_f32_16x16x32_bf16 v[200:203], a[136:139], a[76:79], v[200:203]
v_mfma_f32_16x16x32_bf16 v[224:227], a[56:59], a[136:139], v[224:227]
ds_read_b64_tr_b16 a[86:87], v10 offset:38400
v_mfma_f32_16x16x32_bf16 v[232:235], a[56:59], a[140:143], v[232:235]
buffer_load_dwordx4 v5, s[8:11], s97 offen  lds
v_mfma_f32_16x16x32_bf16 v[240:243], a[56:59], a[144:147], v[240:243]
buffer_atomic_add v29, v27, s[32:35], s98 offen sc1
v_mfma_f32_16x16x32_bf16 v[248:251], a[56:59], a[148:151], v[248:251]
v_mfma_f32_16x16x32_bf16 v[252:255], a[60:63], a[148:151], v[252:255]
v_mfma_f32_16x16x32_bf16 v[244:247], a[60:63], a[144:147], v[244:247]
v_mfma_f32_16x16x32_bf16 v[236:239], a[60:63], a[140:143], v[236:239]
s_waitcnt vmcnt(22) lgkmcnt(0)
v_mfma_f32_16x16x32_bf16 v[228:231], a[60:63], a[136:139], v[228:231]
s_barrier
v_mfma_f32_16x16x32_bf16 v[76:79], a[28:31], a[124:127], v[76:79]
s_add_u32 m0, s73, 0
ds_read_b128 a[136:139], v7 offset:16384
s_mov_b32 s93, 768
v_mfma_f32_16x16x32_bf16 v[104:107], a[28:31], a[128:131], v[104:107]
buffer_load_dwordx4 v2, s[4:7], s93 offen  lds
v_mfma_f32_16x16x32_bf16 v[132:135], a[28:31], a[132:135], v[132:135]
s_add_u32 m0, s73, 4096
ds_read_b64_tr_b16 a[0:1], v13 offset:0
s_mov_b32 s94, 66304
v_mfma_f32_16x16x32_bf16 v[48:51], a[28:31], a[120:123], v[48:51]
s_cmp_eq_u32 s99, 1
s_cselect_b32 s92, 0, s100
ds_read_b64_tr_b16 a[2:3], v13 offset:2048
s_add_u32 s3, s92, 1280
v_mfma_f32_16x16x32_bf16 v[52:55], a[32:35], a[120:123], v[52:55]
buffer_load_dword a255, v44, s[4:7], s3 offen
v_mfma_f32_16x16x32_bf16 v[136:139], a[32:35], a[132:135], v[136:139]
s_add_u32 s3, s92, 4587520
ds_read_b64_tr_b16 a[4:5], v14 offset:0
v_mfma_f32_16x16x32_bf16 v[108:111], a[32:35], a[128:131], v[108:111]
buffer_load_dwordx4 v2, s[4:7], s94 offen  lds
v_mfma_f32_16x16x32_bf16 v[80:83], a[32:35], a[124:127], v[80:83]
s_add_u32 m0, s82, 98304
ds_read_b64_tr_b16 a[6:7], v14 offset:2048
ds_read_b64_tr_b16 a[8:9], v15 offset:0
v_mfma_f32_16x16x32_bf16 v[84:87], a[36:39], a[124:127], v[84:87]
buffer_load_dword a255, v46, s[12:15], s3 offen
v_mfma_f32_16x16x32_bf16 v[112:115], a[36:39], a[128:131], v[112:115]
s_mov_b32 s95, 2523136
ds_read_b64_tr_b16 a[10:11], v15 offset:2048
s_add_u32 s3, s92, 3932160
v_mfma_f32_16x16x32_bf16 v[140:143], a[36:39], a[132:135], v[140:143]
buffer_load_dword a255, v45, s[8:11], s3 offen
v_mfma_f32_16x16x32_bf16 v[56:59], a[36:39], a[120:123], v[56:59]
ds_read_b128 a[140:143], v7 offset:18432
v_mfma_f32_16x16x32_bf16 v[60:63], a[40:43], a[120:123], v[60:63]
buffer_load_dwordx4 v6, s[12:15], s95 offen  lds
v_mfma_f32_16x16x32_bf16 v[144:147], a[40:43], a[132:135], v[144:147]
s_add_u32 m0, s82, 100352
ds_read_b64_tr_b16 a[12:13], v16 offset:0
ds_read_b64_tr_b16 a[14:15], v16 offset:2048
v_mfma_f32_16x16x32_bf16 v[116:119], a[40:43], a[128:131], v[116:119]
s_mov_b32 s96, 2551808
v_mfma_f32_16x16x32_bf16 v[88:91], a[40:43], a[124:127], v[88:91]
ds_read_b64_tr_b16 a[16:17], v17 offset:0
v_mfma_f32_16x16x32_bf16 v[92:95], a[44:47], a[124:127], v[92:95]
ds_read_b64_tr_b16 a[18:19], v17 offset:2048
v_mfma_f32_16x16x32_bf16 v[120:123], a[44:47], a[128:131], v[120:123]
buffer_load_dwordx4 v6, s[12:15], s96 offen  lds
v_mfma_f32_16x16x32_bf16 v[148:151], a[44:47], a[132:135], v[148:151]
s_add_u32 m0, s82, 106496
ds_read_b64_tr_b16 a[20:21], v18 offset:0
s_mov_b32 s97, 2637824
v_mfma_f32_16x16x32_bf16 v[64:67], a[44:47], a[120:123], v[64:67]
ds_read_b64_tr_b16 a[22:23], v18 offset:2048
v_mfma_f32_16x16x32_bf16 v[68:71], a[48:51], a[120:123], v[68:71]
s_cmp_eq_u32 s99, 1
s_cselect_b32 s98, s51, s100
v_mfma_f32_16x16x32_bf16 v[152:155], a[48:51], a[132:135], v[152:155]
ds_read_b128 a[144:147], v7 offset:20480
v_mfma_f32_16x16x32_bf16 v[124:127], a[48:51], a[128:131], v[124:127]
ds_read_b64_tr_b16 a[24:25], v19 offset:0
v_mfma_f32_16x16x32_bf16 v[96:99], a[48:51], a[124:127], v[96:99]
buffer_load_dwordx4 v6, s[12:15], s97 offen  lds
v_mfma_f32_16x16x32_bf16 v[100:103], a[52:55], a[124:127], v[100:103]
s_add_u32 m0, s82, 108544
ds_read_b64_tr_b16 a[26:27], v19 offset:2048
s_mov_b32 s93, 2666496
v_mfma_f32_16x16x32_bf16 v[128:131], a[52:55], a[128:131], v[128:131]
ds_read_b64_tr_b16 a[64:65], v9 offset:128
v_mfma_f32_16x16x32_bf16 v[156:159], a[52:55], a[132:135], v[156:159]
v_mfma_f32_16x16x32_bf16 v[72:75], a[52:55], a[120:123], v[72:75]
ds_read_b64_tr_b16 a[66:67], v9 offset:1664
v_mfma_f32_16x16x32_bf16 v[160:163], a[152:155], a[88:91], v[160:163]
buffer_load_dwordx4 v6, s[12:15], s93 offen  lds
v_mfma_f32_16x16x32_bf16 v[164:167], a[156:159], a[88:91], v[164:167]
s_mov_b32 s94, 1376256
ds_read_b64_tr_b16 a[68:69], v10 offset:128
s_add_u32 m0, s81, 151552
v_mfma_f32_16x16x32_bf16 v[176:179], a[160:163], a[88:91], v[176:179]
ds_read_b64_tr_b16 a[70:71], v10 offset:1664
v_mfma_f32_16x16x32_bf16 v[180:183], a[164:167], a[88:91], v[180:183]
ds_read_b128 a[148:151], v7 offset:22528
v_mfma_f32_16x16x32_bf16 v[188:191], a[164:167], a[92:95], v[188:191]
v_mfma_f32_16x16x32_bf16 v[184:187], a[160:163], a[92:95], v[184:187]
ds_read_b64_tr_b16 a[72:73], v9 offset:256
v_mfma_f32_16x16x32_bf16 v[172:175], a[156:159], a[92:95], v[172:175]
buffer_load_dwordx4 v3, s[8:11], s94 offen  lds
v_mfma_f32_16x16x32_bf16 v[168:171], a[152:155], a[92:95], v[168:171]
s_add_u32 m0, s81, 152576
ds_read_b64_tr_b16 a[74:75], v9 offset:1792
v_mfma_f32_16x16x32_bf16 v[192:195], a[152:155], a[96:99], v[192:195]
ds_read_b64_tr_b16 a[76:77], v10 offset:256
v_mfma_f32_16x16x32_bf16 v[196:199], a[156:159], a[96:99], v[196:199]
ds_read_b64_tr_b16 a[78:79], v10 offset:1792
v_mfma_f32_16x16x32_bf16 v[208:211], a[160:163], a[96:99], v[208:211]
v_mfma_f32_16x16x32_bf16 v[212:215], a[164:167], a[96:99], v[212:215]
buffer_load_dwordx4 v4, s[8:11], s94 offen  lds
v_mfma_f32_16x16x32_bf16 v[220:223], a[164:167], a[100:103], v[220:223]
s_add_u32 m0, s81, 153600
ds_read_b64_tr_b16 a[56:57], v9 offset:0
ds_read_b64_tr_b16 a[58:59], v9 offset:1536
v_mfma_f32_16x16x32_bf16 v[216:219], a[160:163], a[100:103], v[216:219]
v_mfma_f32_16x16x32_bf16 v[204:207], a[156:159], a[100:103], v[204:207]
ds_read_b64_tr_b16 a[60:61], v10 offset:0
v_mfma_f32_16x16x32_bf16 v[200:203], a[152:155], a[100:103], v[200:203]
v_mfma_f32_16x16x32_bf16 v[224:227], a[80:83], a[152:155], v[224:227]
ds_read_b64_tr_b16 a[62:63], v10 offset:1536
v_mfma_f32_16x16x32_bf16 v[232:235], a[80:83], a[156:159], v[232:235]
buffer_load_dwordx4 v5, s[8:11], s94 offen  lds
v_mfma_f32_16x16x32_bf16 v[240:243], a[80:83], a[160:163], v[240:243]
buffer_atomic_add v29, v27, s[32:35], s98 offen sc1
v_mfma_f32_16x16x32_bf16 v[248:251], a[80:83], a[164:167], v[248:251]
v_mfma_f32_16x16x32_bf16 v[252:255], a[84:87], a[164:167], v[252:255]
v_mfma_f32_16x16x32_bf16 v[244:247], a[84:87], a[160:163], v[244:247]
v_mfma_f32_16x16x32_bf16 v[236:239], a[84:87], a[156:159], v[236:239]
s_waitcnt vmcnt(26) lgkmcnt(0)
v_mfma_f32_16x16x32_bf16 v[228:231], a[84:87], a[152:155], v[228:231]
s_barrier
Lu8:
v_mfma_f32_16x16x32_bf16 v[76:79], a[0:3], a[140:143], v[76:79]
s_add_u32 m0, s73, 8192
ds_read_b128 a[152:155], v8 offset:16384
s_mov_b32 s95, 131840
v_mfma_f32_16x16x32_bf16 v[104:107], a[0:3], a[144:147], v[104:107]
buffer_load_dwordx4 v2, s[4:7], s95 offen  lds
v_mfma_f32_16x16x32_bf16 v[132:135], a[0:3], a[148:151], v[132:135]
s_add_u32 m0, s73, 12288
ds_read_b64_tr_b16 a[28:29], v13 offset:16384
s_mov_b32 s96, 197376
v_mfma_f32_16x16x32_bf16 v[48:51], a[0:3], a[136:139], v[48:51]
s_cmp_eq_u32 s99, 2
s_cselect_b32 s92, 0, s100
ds_read_b64_tr_b16 a[30:31], v13 offset:18432
s_add_u32 s3, s92, 1280
v_mfma_f32_16x16x32_bf16 v[52:55], a[4:7], a[136:139], v[52:55]
buffer_load_dword a255, v44, s[4:7], s3 offen
v_mfma_f32_16x16x32_bf16 v[136:139], a[4:7], a[148:151], v[136:139]
s_add_u32 s3, s92, 4587520
ds_read_b64_tr_b16 a[32:33], v14 offset:16384
v_mfma_f32_16x16x32_bf16 v[108:111], a[4:7], a[144:147], v[108:111]
buffer_load_dwordx4 v2, s[4:7], s96 offen  lds
v_mfma_f32_16x16x32_bf16 v[80:83], a[4:7], a[140:143], v[80:83]
s_add_u32 m0, s82, 49152
ds_read_b64_tr_b16 a[34:35], v14 offset:18432
ds_read_b64_tr_b16 a[36:37], v15 offset:16384
v_mfma_f32_16x16x32_bf16 v[84:87], a[8:11], a[140:143], v[84:87]
buffer_load_dword a255, v46, s[12:15], s3 offen
v_mfma_f32_16x16x32_bf16 v[112:115], a[8:11], a[144:147], v[112:115]
s_mov_b32 s97, 2752512
ds_read_b64_tr_b16 a[38:39], v15 offset:18432
s_add_u32 s3, s92, 3932160
v_mfma_f32_16x16x32_bf16 v[140:143], a[8:11], a[148:151], v[140:143]
buffer_load_dword a255, v45, s[8:11], s3 offen
v_mfma_f32_16x16x32_bf16 v[56:59], a[8:11], a[136:139], v[56:59]
ds_read_b128 a[156:159], v8 offset:18432
v_mfma_f32_16x16x32_bf16 v[60:63], a[12:15], a[136:139], v[60:63]
buffer_load_dwordx4 v6, s[12:15], s97 offen  lds
v_mfma_f32_16x16x32_bf16 v[144:147], a[12:15], a[148:151], v[144:147]
s_add_u32 m0, s82, 51200
ds_read_b64_tr_b16 a[40:41], v16 offset:16384
ds_read_b64_tr_b16 a[42:43], v16 offset:18432
v_mfma_f32_16x16x32_bf16 v[116:119], a[12:15], a[144:147], v[116:119]
s_mov_b32 s93, 2781184
v_mfma_f32_16x16x32_bf16 v[88:91], a[12:15], a[140:143], v[88:91]
ds_read_b64_tr_b16 a[44:45], v17 offset:16384
v_mfma_f32_16x16x32_bf16 v[92:95], a[16:19], a[140:143], v[92:95]
ds_read_b64_tr_b16 a[46:47], v17 offset:18432
v_mfma_f32_16x16x32_bf16 v[120:123], a[16:19], a[144:147], v[120:123]
buffer_load_dwordx4 v6, s[12:15], s93 offen  lds
v_mfma_f32_16x16x32_bf16 v[148:151], a[16:19], a[148:151], v[148:151]
s_add_u32 m0, s82, 57344
ds_read_b64_tr_b16 a[48:49], v18 offset:16384
s_mov_b32 s94, 2867200
v_mfma_f32_16x16x32_bf16 v[64:67], a[16:19], a[136:139], v[64:67]
ds_read_b64_tr_b16 a[50:51], v18 offset:18432
v_mfma_f32_16x16x32_bf16 v[68:71], a[20:23], a[136:139], v[68:71]
s_cmp_eq_u32 s99, 2
s_cselect_b32 s98, s51, s100
v_mfma_f32_16x16x32_bf16 v[152:155], a[20:23], a[148:151], v[152:155]
ds_read_b128 a[160:163], v8 offset:20480
v_mfma_f32_16x16x32_bf16 v[124:127], a[20:23], a[144:147], v[124:127]
ds_read_b64_tr_b16 a[52:53], v19 offset:16384
v_mfma_f32_16x16x32_bf16 v[96:99], a[20:23], a[140:143], v[96:99]
buffer_load_dwordx4 v6, s[12:15], s94 offen  lds
v_mfma_f32_16x16x32_bf16 v[100:103], a[24:27], a[140:143], v[100:103]
s_add_u32 m0, s82, 59392
ds_read_b64_tr_b16 a[54:55], v19 offset:18432
s_mov_b32 s95, 2895872
v_mfma_f32_16x16x32_bf16 v[128:131], a[24:27], a[144:147], v[128:131]
ds_read_b64_tr_b16 a[88:89], v9 offset:12416
v_mfma_f32_16x16x32_bf16 v[156:159], a[24:27], a[148:151], v[156:159]
v_mfma_f32_16x16x32_bf16 v[72:75], a[24:27], a[136:139], v[72:75]
ds_read_b64_tr_b16 a[90:91], v9 offset:13952
v_mfma_f32_16x16x32_bf16 v[160:163], a[168:171], a[64:67], v[160:163]
buffer_load_dwordx4 v6, s[12:15], s95 offen  lds
v_mfma_f32_16x16x32_bf16 v[164:167], a[172:175], a[64:67], v[164:167]
s_mov_b32 s96, 1572864
ds_read_b64_tr_b16 a[92:93], v10 offset:12416
s_add_u32 m0, s81, 114688
v_mfma_f32_16x16x32_bf16 v[176:179], a[176:179], a[64:67], v[176:179]
ds_read_b64_tr_b16 a[94:95], v10 offset:13952
v_mfma_f32_16x16x32_bf16 v[180:183], a[180:183], a[64:67], v[180:183]
ds_read_b128 a[164:167], v8 offset:22528
v_mfma_f32_16x16x32_bf16 v[188:191], a[180:183], a[68:71], v[188:191]
v_mfma_f32_16x16x32_bf16 v[184:187], a[176:179], a[68:71], v[184:187]
ds_read_b64_tr_b16 a[96:97], v9 offset:12544
v_mfma_f32_16x16x32_bf16 v[172:175], a[172:175], a[68:71], v[172:175]
buffer_load_dwordx4 v3, s[8:11], s96 offen  lds
v_mfma_f32_16x16x32_bf16 v[168:171], a[168:171], a[68:71], v[168:171]
s_add_u32 m0, s81, 115712
ds_read_b64_tr_b16 a[98:99], v9 offset:14080
v_mfma_f32_16x16x32_bf16 v[192:195], a[168:171], a[72:75], v[192:195]
ds_read_b64_tr_b16 a[100:101], v10 offset:12544
v_mfma_f32_16x16x32_bf16 v[196:199], a[172:175], a[72:75], v[196:199]
ds_read_b64_tr_b16 a[102:103], v10 offset:14080
v_mfma_f32_16x16x32_bf16 v[208:211], a[176:179], a[72:75], v[208:211]
v_mfma_f32_16x16x32_bf16 v[212:215], a[180:183], a[72:75], v[212:215]
buffer_load_dwordx4 v4, s[8:11], s96 offen  lds
v_mfma_f32_16x16x32_bf16 v[220:223], a[180:183], a[76:79], v[220:223]
s_add_u32 m0, s81, 116736
ds_read_b64_tr_b16 a[80:81], v9 offset:12288
ds_read_b64_tr_b16 a[82:83], v9 offset:13824
v_mfma_f32_16x16x32_bf16 v[216:219], a[176:179], a[76:79], v[216:219]
v_mfma_f32_16x16x32_bf16 v[204:207], a[172:175], a[76:79], v[204:207]
ds_read_b64_tr_b16 a[84:85], v10 offset:12288
v_mfma_f32_16x16x32_bf16 v[200:203], a[168:171], a[76:79], v[200:203]
v_mfma_f32_16x16x32_bf16 v[224:227], a[56:59], a[168:171], v[224:227]
ds_read_b64_tr_b16 a[86:87], v10 offset:13824
v_mfma_f32_16x16x32_bf16 v[232:235], a[56:59], a[172:175], v[232:235]
buffer_load_dwordx4 v5, s[8:11], s96 offen  lds
v_mfma_f32_16x16x32_bf16 v[240:243], a[56:59], a[176:179], v[240:243]
buffer_atomic_add v29, v27, s[32:35], s98 offen sc1
v_mfma_f32_16x16x32_bf16 v[248:251], a[56:59], a[180:183], v[248:251]
v_mfma_f32_16x16x32_bf16 v[252:255], a[60:63], a[180:183], v[252:255]
v_mfma_f32_16x16x32_bf16 v[244:247], a[60:63], a[176:179], v[244:247]
v_mfma_f32_16x16x32_bf16 v[236:239], a[60:63], a[172:175], v[236:239]
s_waitcnt vmcnt(27) lgkmcnt(0)
v_mfma_f32_16x16x32_bf16 v[228:231], a[60:63], a[168:171], v[228:231]
s_barrier
v_mfma_f32_16x16x32_bf16 v[76:79], a[28:31], a[156:159], v[76:79]
s_add_u32 m0, s73, 16384
ds_read_b128 a[168:171], v7 offset:32768
s_mov_b32 s97, 896
v_mfma_f32_16x16x32_bf16 v[104:107], a[28:31], a[160:163], v[104:107]
buffer_load_dwordx4 v2, s[4:7], s97 offen  lds
v_mfma_f32_16x16x32_bf16 v[132:135], a[28:31], a[164:167], v[132:135]
s_add_u32 m0, s73, 20480
ds_read_b64_tr_b16 a[0:1], v13 offset:32768
s_mov_b32 s93, 66432
v_mfma_f32_16x16x32_bf16 v[48:51], a[28:31], a[152:155], v[48:51]
s_cmp_eq_u32 s99, 3
s_cselect_b32 s92, 0, s100
ds_read_b64_tr_b16 a[2:3], v13 offset:34816
s_add_u32 s3, s92, 1280
v_mfma_f32_16x16x32_bf16 v[52:55], a[32:35], a[152:155], v[52:55]
buffer_load_dword a255, v44, s[4:7], s3 offen
v_mfma_f32_16x16x32_bf16 v[136:139], a[32:35], a[164:167], v[136:139]
s_add_u32 s3, s92, 4587520
ds_read_b64_tr_b16 a[4:5], v14 offset:32768
v_mfma_f32_16x16x32_bf16 v[108:111], a[32:35], a[160:163], v[108:111]
buffer_load_dwordx4 v2, s[4:7], s93 offen  lds
v_mfma_f32_16x16x32_bf16 v[80:83], a[32:35], a[156:159], v[80:83]
s_add_u32 m0, s82, 65536
ds_read_b64_tr_b16 a[6:7], v14 offset:34816
ds_read_b64_tr_b16 a[8:9], v15 offset:32768
v_mfma_f32_16x16x32_bf16 v[84:87], a[36:39], a[156:159], v[84:87]
buffer_load_dword a255, v46, s[12:15], s3 offen
v_mfma_f32_16x16x32_bf16 v[112:115], a[36:39], a[160:163], v[112:115]
s_mov_b32 s94, 2981888
ds_read_b64_tr_b16 a[10:11], v15 offset:34816
s_add_u32 s3, s92, 3932160
v_mfma_f32_16x16x32_bf16 v[140:143], a[36:39], a[164:167], v[140:143]
buffer_load_dword a255, v45, s[8:11], s3 offen
v_mfma_f32_16x16x32_bf16 v[56:59], a[36:39], a[152:155], v[56:59]
ds_read_b128 a[172:175], v7 offset:34816
v_mfma_f32_16x16x32_bf16 v[60:63], a[40:43], a[152:155], v[60:63]
buffer_load_dwordx4 v6, s[12:15], s94 offen  lds
v_mfma_f32_16x16x32_bf16 v[144:147], a[40:43], a[164:167], v[144:147]
s_add_u32 m0, s82, 67584
ds_read_b64_tr_b16 a[12:13], v16 offset:32768
ds_read_b64_tr_b16 a[14:15], v16 offset:34816
v_mfma_f32_16x16x32_bf16 v[116:119], a[40:43], a[160:163], v[116:119]
s_mov_b32 s95, 3010560
v_mfma_f32_16x16x32_bf16 v[88:91], a[40:43], a[156:159], v[88:91]
ds_read_b64_tr_b16 a[16:17], v17 offset:32768
v_mfma_f32_16x16x32_bf16 v[92:95], a[44:47], a[156:159], v[92:95]
ds_read_b64_tr_b16 a[18:19], v17 offset:34816
v_mfma_f32_16x16x32_bf16 v[120:123], a[44:47], a[160:163], v[120:123]
buffer_load_dwordx4 v6, s[12:15], s95 offen  lds
v_mfma_f32_16x16x32_bf16 v[148:151], a[44:47], a[164:167], v[148:151]
s_add_u32 m0, s82, 73728
ds_read_b64_tr_b16 a[20:21], v18 offset:32768
s_mov_b32 s96, 3096576
v_mfma_f32_16x16x32_bf16 v[64:67], a[44:47], a[152:155], v[64:67]
ds_read_b64_tr_b16 a[22:23], v18 offset:34816
v_mfma_f32_16x16x32_bf16 v[68:71], a[48:51], a[152:155], v[68:71]
s_cmp_eq_u32 s99, 3
s_cselect_b32 s98, s51, s100
v_mfma_f32_16x16x32_bf16 v[152:155], a[48:51], a[164:167], v[152:155]
ds_read_b128 a[176:179], v7 offset:36864
v_mfma_f32_16x16x32_bf16 v[124:127], a[48:51], a[160:163], v[124:127]
ds_read_b64_tr_b16 a[24:25], v19 offset:32768
v_mfma_f32_16x16x32_bf16 v[96:99], a[48:51], a[156:159], v[96:99]
buffer_load_dwordx4 v6, s[12:15], s96 offen  lds
v_mfma_f32_16x16x32_bf16 v[100:103], a[52:55], a[156:159], v[100:103]
s_add_u32 m0, s82, 75776
ds_read_b64_tr_b16 a[26:27], v19 offset:34816
s_mov_b32 s97, 3125248
v_mfma_f32_16x16x32_bf16 v[128:131], a[52:55], a[160:163], v[128:131]
ds_read_b64_tr_b16 a[64:65], v9 offset:24704
v_mfma_f32_16x16x32_bf16 v[156:159], a[52:55], a[164:167], v[156:159]
v_mfma_f32_16x16x32_bf16 v[72:75], a[52:55], a[152:155], v[72:75]
ds_read_b64_tr_b16 a[66:67], v9 offset:26240
v_mfma_f32_16x16x32_bf16 v[160:163], a[184:187], a[88:91], v[160:163]
buffer_load_dwordx4 v6, s[12:15], s97 offen  lds
v_mfma_f32_16x16x32_bf16 v[164:167], a[188:191], a[88:91], v[164:167]
s_mov_b32 s93, 1769472
ds_read_b64_tr_b16 a[68:69], v10 offset:24704
s_add_u32 m0, s81, 126976
v_mfma_f32_16x16x32_bf16 v[176:179], a[192:195], a[88:91], v[176:179]
ds_read_b64_tr_b16 a[70:71], v10 offset:26240
v_mfma_f32_16x16x32_bf16 v[180:183], a[196:199], a[88:91], v[180:183]
ds_read_b128 a[180:183], v7 offset:38912
v_mfma_f32_16x16x32_bf16 v[188:191], a[196:199], a[92:95], v[188:191]
Lpad2:
s_cbranch_execz Lpad6
s_nop 0
v_mfma_f32_16x16x32_bf16 v[184:187], a[192:195], a[92:95], v[184:187]
ds_read_b64_tr_b16 a[72:73], v9 offset:24832
v_mfma_f32_16x16x32_bf16 v[172:175], a[188:191], a[92:95], v[172:175]
buffer_load_dwordx4 v3, s[8:11], s93 offen  lds
v_mfma_f32_16x16x32_bf16 v[168:171], a[184:187], a[92:95], v[168:171]
s_add_u32 m0, s81, 128000
ds_read_b64_tr_b16 a[74:75], v9 offset:26368
v_mfma_f32_16x16x32_bf16 v[192:195], a[184:187], a[96:99], v[192:195]
ds_read_b64_tr_b16 a[76:77], v10 offset:24832
v_mfma_f32_16x16x32_bf16 v[196:199], a[188:191], a[96:99], v[196:199]
ds_read_b64_tr_b16 a[78:79], v10 offset:26368
v_mfma_f32_16x16x32_bf16 v[208:211], a[192:195], a[96:99], v[208:211]
v_mfma_f32_16x16x32_bf16 v[212:215], a[196:199], a[96:99], v[212:215]
buffer_load_dwordx4 v4, s[8:11], s93 offen  lds
v_mfma_f32_16x16x32_bf16 v[220:223], a[196:199], a[100:103], v[220:223]
s_add_u32 m0, s81, 129024
ds_read_b64_tr_b16 a[56:57], v9 offset:24576
ds_read_b64_tr_b16 a[58:59], v9 offset:26112
v_mfma_f32_16x16x32_bf16 v[216:219], a[192:195], a[100:103], v[216:219]
v_mfma_f32_16x16x32_bf16 v[204:207], a[188:191], a[100:103], v[204:207]
ds_read_b64_tr_b16 a[60:61], v10 offset:24576
v_mfma_f32_16x16x32_bf16 v[200:203], a[184:187], a[100:103], v[200:203]
v_mfma_f32_16x16x32_bf16 v[224:227], a[80:83], a[184:187], v[224:227]
ds_read_b64_tr_b16 a[62:63], v10 offset:26112
v_mfma_f32_16x16x32_bf16 v[232:235], a[80:83], a[188:191], v[232:235]
buffer_load_dwordx4 v5, s[8:11], s93 offen  lds
v_mfma_f32_16x16x32_bf16 v[240:243], a[80:83], a[192:195], v[240:243]
buffer_atomic_add v29, v27, s[32:35], s98 offen sc1
v_mfma_f32_16x16x32_bf16 v[248:251], a[80:83], a[196:199], v[248:251]
v_mfma_f32_16x16x32_bf16 v[252:255], a[84:87], a[196:199], v[252:255]
v_mfma_f32_16x16x32_bf16 v[244:247], a[84:87], a[192:195], v[244:247]
v_mfma_f32_16x16x32_bf16 v[236:239], a[84:87], a[188:191], v[236:239]
s_waitcnt vmcnt(27) lgkmcnt(0)
v_mfma_f32_16x16x32_bf16 v[228:231], a[84:87], a[184:187], v[228:231]
s_barrier
v_mfma_f32_16x16x32_bf16 v[76:79], a[0:3], a[172:175], v[76:79]
s_add_u32 m0, s73, 24576
ds_read_b128 a[184:187], v8 offset:32768
s_mov_b32 s94, 131968
v_mfma_f32_16x16x32_bf16 v[104:107], a[0:3], a[176:179], v[104:107]
buffer_load_dwordx4 v2, s[4:7], s94 offen  lds
v_mfma_f32_16x16x32_bf16 v[132:135], a[0:3], a[180:183], v[132:135]
s_add_u32 m0, s73, 28672
ds_read_b64_tr_b16 a[28:29], v13 offset:49152
s_mov_b32 s95, 197504
v_mfma_f32_16x16x32_bf16 v[48:51], a[0:3], a[168:171], v[48:51]
s_cmp_eq_u32 s99, 4
s_cselect_b32 s92, 0, s100
ds_read_b64_tr_b16 a[30:31], v13 offset:51200
s_add_u32 s3, s92, 1280
v_mfma_f32_16x16x32_bf16 v[52:55], a[4:7], a[168:171], v[52:55]
buffer_load_dword a255, v44, s[4:7], s3 offen
v_mfma_f32_16x16x32_bf16 v[136:139], a[4:7], a[180:183], v[136:139]
s_add_u32 s3, s92, 4587520
ds_read_b64_tr_b16 a[32:33], v14 offset:49152
v_mfma_f32_16x16x32_bf16 v[108:111], a[4:7], a[176:179], v[108:111]
buffer_load_dwordx4 v2, s[4:7], s95 offen  lds
v_mfma_f32_16x16x32_bf16 v[80:83], a[4:7], a[172:175], v[80:83]
s_add_u32 m0, s82, 81920
ds_read_b64_tr_b16 a[34:35], v14 offset:51200
ds_read_b64_tr_b16 a[36:37], v15 offset:49152
v_mfma_f32_16x16x32_bf16 v[84:87], a[8:11], a[172:175], v[84:87]
buffer_load_dword a255, v46, s[12:15], s3 offen
v_mfma_f32_16x16x32_bf16 v[112:115], a[8:11], a[176:179], v[112:115]
s_mov_b32 s96, 3211264
ds_read_b64_tr_b16 a[38:39], v15 offset:51200
s_add_u32 s3, s92, 3932160
v_mfma_f32_16x16x32_bf16 v[140:143], a[8:11], a[180:183], v[140:143]
buffer_load_dword a255, v45, s[8:11], s3 offen
v_mfma_f32_16x16x32_bf16 v[56:59], a[8:11], a[168:171], v[56:59]
ds_read_b128 a[188:191], v8 offset:34816
v_mfma_f32_16x16x32_bf16 v[60:63], a[12:15], a[168:171], v[60:63]
buffer_load_dwordx4 v6, s[12:15], s96 offen  lds
v_mfma_f32_16x16x32_bf16 v[144:147], a[12:15], a[180:183], v[144:147]
s_add_u32 m0, s82, 83968
ds_read_b64_tr_b16 a[40:41], v16 offset:49152
ds_read_b64_tr_b16 a[42:43], v16 offset:51200
v_mfma_f32_16x16x32_bf16 v[116:119], a[12:15], a[176:179], v[116:119]
s_mov_b32 s97, 3239936
v_mfma_f32_16x16x32_bf16 v[88:91], a[12:15], a[172:175], v[88:91]
ds_read_b64_tr_b16 a[44:45], v17 offset:49152
v_mfma_f32_16x16x32_bf16 v[92:95], a[16:19], a[172:175], v[92:95]
ds_read_b64_tr_b16 a[46:47], v17 offset:51200
v_mfma_f32_16x16x32_bf16 v[120:123], a[16:19], a[176:179], v[120:123]
buffer_load_dwordx4 v6, s[12:15], s97 offen  lds
v_mfma_f32_16x16x32_bf16 v[148:151], a[16:19], a[180:183], v[148:151]
s_add_u32 m0, s82, 90112
ds_read_b64_tr_b16 a[48:49], v18 offset:49152
s_mov_b32 s93, 3325952
v_mfma_f32_16x16x32_bf16 v[64:67], a[16:19], a[168:171], v[64:67]
ds_read_b64_tr_b16 a[50:51], v18 offset:51200
v_mfma_f32_16x16x32_bf16 v[68:71], a[20:23], a[168:171], v[68:71]
s_cmp_eq_u32 s99, 4
s_cselect_b32 s98, s51, s100
v_mfma_f32_16x16x32_bf16 v[152:155], a[20:23], a[180:183], v[152:155]
ds_read_b128 a[192:195], v8 offset:36864
v_mfma_f32_16x16x32_bf16 v[124:127], a[20:23], a[176:179], v[124:127]
ds_read_b64_tr_b16 a[52:53], v19 offset:49152
v_mfma_f32_16x16x32_bf16 v[96:99], a[20:23], a[172:175], v[96:99]
buffer_load_dwordx4 v6, s[12:15], s93 offen  lds
v_mfma_f32_16x16x32_bf16 v[100:103], a[24:27], a[172:175], v[100:103]
s_add_u32 m0, s82, 92160
ds_read_b64_tr_b16 a[54:55], v19 offset:51200
s_mov_b32 s94, 3354624
v_mfma_f32_16x16x32_bf16 v[128:131], a[24:27], a[176:179], v[128:131]
ds_read_b64_tr_b16 a[88:89], v9 offset:36992
v_mfma_f32_16x16x32_bf16 v[156:159], a[24:27], a[180:183], v[156:159]
v_mfma_f32_16x16x32_bf16 v[72:75], a[24:27], a[168:171], v[72:75]
ds_read_b64_tr_b16 a[90:91], v9 offset:38528
v_mfma_f32_16x16x32_bf16 v[160:163], a[104:107], a[64:67], v[160:163]
buffer_load_dwordx4 v6, s[12:15], s94 offen  lds
v_mfma_f32_16x16x32_bf16 v[164:167], a[108:111], a[64:67], v[164:167]
s_mov_b32 s95, 1966080
ds_read_b64_tr_b16 a[92:93], v10 offset:36992
s_add_u32 m0, s81, 139264
v_mfma_f32_16x16x32_bf16 v[176:179], a[112:115], a[64:67], v[176:179]
ds_read_b64_tr_b16 a[94:95], v10 offset:38528
v_mfma_f32_16x16x32_bf16 v[180:183], a[116:119], a[64:67], v[180:183]
ds_read_b128 a[196:199], v8 offset:38912
v_mfma_f32_16x16x32_bf16 v[188:191], a[116:119], a[68:71], v[188:191]
v_mfma_f32_16x16x32_bf16 v[184:187], a[112:115], a[68:71], v[184:187]
ds_read_b64_tr_b16 a[96:97], v9 offset:37120
v_mfma_f32_16x16x32_bf16 v[172:175], a[108:111], a[68:71], v[172:175]
buffer_load_dwordx4 v3, s[8:11], s95 offen  lds
v_mfma_f32_16x16x32_bf16 v[168:171], a[104:107], a[68:71], v[168:171]
s_add_u32 m0, s81, 140288
ds_read_b64_tr_b16 a[98:99], v9 offset:38656
v_mfma_f32_16x16x32_bf16 v[192:195], a[104:107], a[72:75], v[192:195]
ds_read_b64_tr_b16 a[100:101], v10 offset:37120
v_mfma_f32_16x16x32_bf16 v[196:199], a[108:111], a[72:75], v[196:199]
ds_read_b64_tr_b16 a[102:103], v10 offset:38656
v_mfma_f32_16x16x32_bf16 v[208:211], a[112:115], a[72:75], v[208:211]
v_mfma_f32_16x16x32_bf16 v[212:215], a[116:119], a[72:75], v[212:215]
buffer_load_dwordx4 v4, s[8:11], s95 offen  lds
v_mfma_f32_16x16x32_bf16 v[220:223], a[116:119], a[76:79], v[220:223]
s_add_u32 m0, s81, 141312
ds_read_b64_tr_b16 a[80:81], v9 offset:36864
ds_read_b64_tr_b16 a[82:83], v9 offset:38400
v_mfma_f32_16x16x32_bf16 v[216:219], a[112:115], a[76:79], v[216:219]
v_mfma_f32_16x16x32_bf16 v[204:207], a[108:111], a[76:79], v[204:207]
ds_read_b64_tr_b16 a[84:85], v10 offset:36864
v_mfma_f32_16x16x32_bf16 v[200:203], a[104:107], a[76:79], v[200:203]
v_mfma_f32_16x16x32_bf16 v[224:227], a[56:59], a[104:107], v[224:227]
ds_read_b64_tr_b16 a[86:87], v10 offset:38400
v_mfma_f32_16x16x32_bf16 v[232:235], a[56:59], a[108:111], v[232:235]
buffer_load_dwordx4 v5, s[8:11], s95 offen  lds
v_mfma_f32_16x16x32_bf16 v[240:243], a[56:59], a[112:115], v[240:243]
buffer_atomic_add v29, v27, s[32:35], s98 offen sc1
v_mfma_f32_16x16x32_bf16 v[248:251], a[56:59], a[116:119], v[248:251]
v_mfma_f32_16x16x32_bf16 v[252:255], a[60:63], a[116:119], v[252:255]
v_mfma_f32_16x16x32_bf16 v[244:247], a[60:63], a[112:115], v[244:247]
v_mfma_f32_16x16x32_bf16 v[236:239], a[60:63], a[108:111], v[236:239]
s_waitcnt vmcnt(27) lgkmcnt(0)
v_mfma_f32_16x16x32_bf16 v[228:231], a[60:63], a[104:107], v[228:231]
s_barrier
v_mfma_f32_16x16x32_bf16 v[76:79], a[28:31], a[188:191], v[76:79]
s_add_u32 m0, s73, 32768
ds_read_b128 a[104:107], v7 offset:0
s_mov_b32 s96, 1024
v_mfma_f32_16x16x32_bf16 v[104:107], a[28:31], a[192:195], v[104:107]
buffer_load_dwordx4 v2, s[4:7], s96 offen  lds
v_mfma_f32_16x16x32_bf16 v[132:135], a[28:31], a[196:199], v[132:135]
s_add_u32 m0, s73, 36864
ds_read_b64_tr_b16 a[0:1], v13 offset:0
s_mov_b32 s97, 66560
v_mfma_f32_16x16x32_bf16 v[48:51], a[28:31], a[184:187], v[48:51]
s_cmp_eq_u32 s99, 5
s_cselect_b32 s92, 0, s100
ds_read_b64_tr_b16 a[2:3], v13 offset:2048
s_add_u32 s3, s92, 1280
v_mfma_f32_16x16x32_bf16 v[52:55], a[32:35], a[184:187], v[52:55]
buffer_load_dword a255, v44, s[4:7], s3 offen
v_mfma_f32_16x16x32_bf16 v[136:139], a[32:35], a[196:199], v[136:139]
s_add_u32 s3, s92, 4587520
ds_read_b64_tr_b16 a[4:5], v14 offset:0
v_mfma_f32_16x16x32_bf16 v[108:111], a[32:35], a[192:195], v[108:111]
buffer_load_dwordx4 v2, s[4:7], s97 offen  lds
v_mfma_f32_16x16x32_bf16 v[80:83], a[32:35], a[188:191], v[80:83]
s_add_u32 m0, s82, 98304
ds_read_b64_tr_b16 a[6:7], v14 offset:2048
ds_read_b64_tr_b16 a[8:9], v15 offset:0
v_mfma_f32_16x16x32_bf16 v[84:87], a[36:39], a[188:191], v[84:87]
buffer_load_dword a255, v46, s[12:15], s3 offen
v_mfma_f32_16x16x32_bf16 v[112:115], a[36:39], a[192:195], v[112:115]
s_mov_b32 s93, 3440640
ds_read_b64_tr_b16 a[10:11], v15 offset:2048
s_add_u32 s3, s92, 3932160
v_mfma_f32_16x16x32_bf16 v[140:143], a[36:39], a[196:199], v[140:143]
buffer_load_dword a255, v45, s[8:11], s3 offen
v_mfma_f32_16x16x32_bf16 v[56:59], a[36:39], a[184:187], v[56:59]
ds_read_b128 a[108:111], v7 offset:2048
v_mfma_f32_16x16x32_bf16 v[60:63], a[40:43], a[184:187], v[60:63]
buffer_load_dwordx4 v6, s[12:15], s93 offen  lds
v_mfma_f32_16x16x32_bf16 v[144:147], a[40:43], a[196:199], v[144:147]
s_add_u32 m0, s82, 100352
ds_read_b64_tr_b16 a[12:13], v16 offset:0
ds_read_b64_tr_b16 a[14:15], v16 offset:2048
v_mfma_f32_16x16x32_bf16 v[116:119], a[40:43], a[192:195], v[116:119]
s_mov_b32 s94, 3469312
v_mfma_f32_16x16x32_bf16 v[88:91], a[40:43], a[188:191], v[88:91]
ds_read_b64_tr_b16 a[16:17], v17 offset:0
v_mfma_f32_16x16x32_bf16 v[92:95], a[44:47], a[188:191], v[92:95]
ds_read_b64_tr_b16 a[18:19], v17 offset:2048
v_mfma_f32_16x16x32_bf16 v[120:123], a[44:47], a[192:195], v[120:123]
buffer_load_dwordx4 v6, s[12:15], s94 offen  lds
v_mfma_f32_16x16x32_bf16 v[148:151], a[44:47], a[196:199], v[148:151]
s_add_u32 m0, s82, 106496
ds_read_b64_tr_b16 a[20:21], v18 offset:0
s_mov_b32 s95, 3555328
v_mfma_f32_16x16x32_bf16 v[64:67], a[44:47], a[184:187], v[64:67]
ds_read_b64_tr_b16 a[22:23], v18 offset:2048
v_mfma_f32_16x16x32_bf16 v[68:71], a[48:51], a[184:187], v[68:71]
s_cmp_eq_u32 s99, 5
s_cselect_b32 s98, s51, s100
v_mfma_f32_16x16x32_bf16 v[152:155], a[48:51], a[196:199], v[152:155]
ds_read_b128 a[112:115], v7 offset:4096
v_mfma_f32_16x16x32_bf16 v[124:127], a[48:51], a[192:195], v[124:127]
ds_read_b64_tr_b16 a[24:25], v19 offset:0
v_mfma_f32_16x16x32_bf16 v[96:99], a[48:51], a[188:191], v[96:99]
buffer_load_dwordx4 v6, s[12:15], s95 offen  lds
v_mfma_f32_16x16x32_bf16 v[100:103], a[52:55], a[188:191], v[100:103]
s_add_u32 m0, s82, 108544
ds_read_b64_tr_b16 a[26:27], v19 offset:2048
s_mov_b32 s96, 3584000
v_mfma_f32_16x16x32_bf16 v[128:131], a[52:55], a[192:195], v[128:131]
ds_read_b64_tr_b16 a[64:65], v9 offset:128
v_mfma_f32_16x16x32_bf16 v[156:159], a[52:55], a[196:199], v[156:159]
v_mfma_f32_16x16x32_bf16 v[72:75], a[52:55], a[184:187], v[72:75]
ds_read_b64_tr_b16 a[66:67], v9 offset:1664
v_mfma_f32_16x16x32_bf16 v[160:163], a[120:123], a[88:91], v[160:163]
buffer_load_dwordx4 v6, s[12:15], s96 offen  lds
v_mfma_f32_16x16x32_bf16 v[164:167], a[124:127], a[88:91], v[164:167]
s_mov_b32 s97, 2162688
ds_read_b64_tr_b16 a[68:69], v10 offset:128
s_add_u32 m0, s81, 151552
v_mfma_f32_16x16x32_bf16 v[176:179], a[128:131], a[88:91], v[176:179]
ds_read_b64_tr_b16 a[70:71], v10 offset:1664
v_mfma_f32_16x16x32_bf16 v[180:183], a[132:135], a[88:91], v[180:183]
ds_read_b128 a[116:119], v7 offset:6144
v_mfma_f32_16x16x32_bf16 v[188:191], a[132:135], a[92:95], v[188:191]
v_mfma_f32_16x16x32_bf16 v[184:187], a[128:131], a[92:95], v[184:187]
ds_read_b64_tr_b16 a[72:73], v9 offset:256
v_mfma_f32_16x16x32_bf16 v[172:175], a[124:127], a[92:95], v[172:175]
buffer_load_dwordx4 v3, s[8:11], s97 offen  lds
v_mfma_f32_16x16x32_bf16 v[168:171], a[120:123], a[92:95], v[168:171]
s_add_u32 m0, s81, 152576
ds_read_b64_tr_b16 a[74:75], v9 offset:1792
v_mfma_f32_16x16x32_bf16 v[192:195], a[120:123], a[96:99], v[192:195]
ds_read_b64_tr_b16 a[76:77], v10 offset:256
v_mfma_f32_16x16x32_bf16 v[196:199], a[124:127], a[96:99], v[196:199]
ds_read_b64_tr_b16 a[78:79], v10 offset:1792
v_mfma_f32_16x16x32_bf16 v[208:211], a[128:131], a[96:99], v[208:211]
v_mfma_f32_16x16x32_bf16 v[212:215], a[132:135], a[96:99], v[212:215]
buffer_load_dwordx4 v4, s[8:11], s97 offen  lds
v_mfma_f32_16x16x32_bf16 v[220:223], a[132:135], a[100:103], v[220:223]
s_add_u32 m0, s81, 153600
ds_read_b64_tr_b16 a[56:57], v9 offset:0
ds_read_b64_tr_b16 a[58:59], v9 offset:1536
v_mfma_f32_16x16x32_bf16 v[216:219], a[128:131], a[100:103], v[216:219]
v_mfma_f32_16x16x32_bf16 v[204:207], a[124:127], a[100:103], v[204:207]
ds_read_b64_tr_b16 a[60:61], v10 offset:0
v_mfma_f32_16x16x32_bf16 v[200:203], a[120:123], a[100:103], v[200:203]
v_mfma_f32_16x16x32_bf16 v[224:227], a[80:83], a[120:123], v[224:227]
ds_read_b64_tr_b16 a[62:63], v10 offset:1536
v_mfma_f32_16x16x32_bf16 v[232:235], a[80:83], a[124:127], v[232:235]
buffer_load_dwordx4 v5, s[8:11], s97 offen  lds
v_mfma_f32_16x16x32_bf16 v[240:243], a[80:83], a[128:131], v[240:243]
buffer_atomic_add v29, v27, s[32:35], s98 offen sc1
v_mfma_f32_16x16x32_bf16 v[248:251], a[80:83], a[132:135], v[248:251]
v_mfma_f32_16x16x32_bf16 v[252:255], a[84:87], a[132:135], v[252:255]
v_mfma_f32_16x16x32_bf16 v[244:247], a[84:87], a[128:131], v[244:247]
v_mfma_f32_16x16x32_bf16 v[236:239], a[84:87], a[124:127], v[236:239]
s_waitcnt vmcnt(27) lgkmcnt(0)
v_mfma_f32_16x16x32_bf16 v[228:231], a[84:87], a[120:123], v[228:231]
s_barrier
Lu12:
v_mfma_f32_16x16x32_bf16 v[76:79], a[0:3], a[108:111], v[76:79]
s_add_u32 m0, s73, 40960
ds_read_b128 a[120:123], v8 offset:0
s_mov_b32 s93, 132096
v_mfma_f32_16x16x32_bf16 v[104:107], a[0:3], a[112:115], v[104:107]
buffer_load_dwordx4 v2, s[4:7], s93 offen  lds
v_mfma_f32_16x16x32_bf16 v[132:135], a[0:3], a[116:119], v[132:135]
s_add_u32 m0, s73, 45056
ds_read_b64_tr_b16 a[28:29], v13 offset:16384
s_mov_b32 s94, 197632
v_mfma_f32_16x16x32_bf16 v[48:51], a[0:3], a[104:107], v[48:51]
s_cmp_eq_u32 s99, 6
s_cselect_b32 s92, 0, s100
ds_read_b64_tr_b16 a[30:31], v13 offset:18432
s_add_u32 s3, s92, 1280
v_mfma_f32_16x16x32_bf16 v[52:55], a[4:7], a[104:107], v[52:55]
buffer_load_dword a255, v44, s[4:7], s3 offen
v_mfma_f32_16x16x32_bf16 v[136:139], a[4:7], a[116:119], v[136:139]
s_add_u32 s3, s92, 4587520
ds_read_b64_tr_b16 a[32:33], v14 offset:16384
v_mfma_f32_16x16x32_bf16 v[108:111], a[4:7], a[112:115], v[108:111]
buffer_load_dwordx4 v2, s[4:7], s94 offen  lds
v_mfma_f32_16x16x32_bf16 v[80:83], a[4:7], a[108:111], v[80:83]
s_add_u32 m0, s82, 49152
ds_read_b64_tr_b16 a[34:35], v14 offset:18432
ds_read_b64_tr_b16 a[36:37], v15 offset:16384
v_mfma_f32_16x16x32_bf16 v[84:87], a[8:11], a[108:111], v[84:87]
buffer_load_dword a255, v46, s[12:15], s3 offen
v_mfma_f32_16x16x32_bf16 v[112:115], a[8:11], a[112:115], v[112:115]
s_mov_b32 s95, 3670016
ds_read_b64_tr_b16 a[38:39], v15 offset:18432
s_add_u32 s3, s92, 3932160
v_mfma_f32_16x16x32_bf16 v[140:143], a[8:11], a[116:119], v[140:143]
buffer_load_dword a255, v45, s[8:11], s3 offen
v_mfma_f32_16x16x32_bf16 v[56:59], a[8:11], a[104:107], v[56:59]
ds_read_b128 a[124:127], v8 offset:2048
v_mfma_f32_16x16x32_bf16 v[60:63], a[12:15], a[104:107], v[60:63]
buffer_load_dwordx4 v6, s[12:15], s95 offen  lds
v_mfma_f32_16x16x32_bf16 v[144:147], a[12:15], a[116:119], v[144:147]
s_add_u32 m0, s82, 51200
ds_read_b64_tr_b16 a[40:41], v16 offset:16384
ds_read_b64_tr_b16 a[42:43], v16 offset:18432
v_mfma_f32_16x16x32_bf16 v[116:119], a[12:15], a[112:115], v[116:119]
s_mov_b32 s96, 3698688
v_mfma_f32_16x16x32_bf16 v[88:91], a[12:15], a[108:111], v[88:91]
ds_read_b64_tr_b16 a[44:45], v17 offset:16384
v_mfma_f32_16x16x32_bf16 v[92:95], a[16:19], a[108:111], v[92:95]
ds_read_b64_tr_b16 a[46:47], v17 offset:18432
v_mfma_f32_16x16x32_bf16 v[120:123], a[16:19], a[112:115], v[120:123]
buffer_load_dwordx4 v6, s[12:15], s96 offen  lds
v_mfma_f32_16x16x32_bf16 v[148:151], a[16:19], a[116:119], v[148:151]
s_add_u32 m0, s82, 57344
ds_read_b64_tr_b16 a[48:49], v18 offset:16384
s_mov_b32 s97, 3784704
v_mfma_f32_16x16x32_bf16 v[64:67], a[16:19], a[104:107], v[64:67]
ds_read_b64_tr_b16 a[50:51], v18 offset:18432
v_mfma_f32_16x16x32_bf16 v[68:71], a[20:23], a[104:107], v[68:71]
s_cmp_eq_u32 s99, 6
s_cselect_b32 s98, s51, s100
v_mfma_f32_16x16x32_bf16 v[152:155], a[20:23], a[116:119], v[152:155]
ds_read_b128 a[128:131], v8 offset:4096
v_mfma_f32_16x16x32_bf16 v[124:127], a[20:23], a[112:115], v[124:127]
ds_read_b64_tr_b16 a[52:53], v19 offset:16384
v_mfma_f32_16x16x32_bf16 v[96:99], a[20:23], a[108:111], v[96:99]
buffer_load_dwordx4 v6, s[12:15], s97 offen  lds
v_mfma_f32_16x16x32_bf16 v[100:103], a[24:27], a[108:111], v[100:103]
s_add_u32 m0, s82, 59392
ds_read_b64_tr_b16 a[54:55], v19 offset:18432
s_mov_b32 s93, 3813376
v_mfma_f32_16x16x32_bf16 v[128:131], a[24:27], a[112:115], v[128:131]
ds_read_b64_tr_b16 a[88:89], v9 offset:12416
v_mfma_f32_16x16x32_bf16 v[156:159], a[24:27], a[116:119], v[156:159]
v_mfma_f32_16x16x32_bf16 v[72:75], a[24:27], a[104:107], v[72:75]
ds_read_b64_tr_b16 a[90:91], v9 offset:13952
v_mfma_f32_16x16x32_bf16 v[160:163], a[136:139], a[64:67], v[160:163]
buffer_load_dwordx4 v6, s[12:15], s93 offen  lds
v_mfma_f32_16x16x32_bf16 v[164:167], a[140:143], a[64:67], v[164:167]
s_mov_b32 s94, 2359296
ds_read_b64_tr_b16 a[92:93], v10 offset:12416
s_add_u32 m0, s81, 114688
v_mfma_f32_16x16x32_bf16 v[176:179], a[144:147], a[64:67], v[176:179]
ds_read_b64_tr_b16 a[94:95], v10 offset:13952
v_mfma_f32_16x16x32_bf16 v[180:183], a[148:151], a[64:67], v[180:183]
ds_read_b128 a[132:135], v8 offset:6144
v_mfma_f32_16x16x32_bf16 v[188:191], a[148:151], a[68:71], v[188:191]
v_mfma_f32_16x16x32_bf16 v[184:187], a[144:147], a[68:71], v[184:187]
ds_read_b64_tr_b16 a[96:97], v9 offset:12544
v_mfma_f32_16x16x32_bf16 v[172:175], a[140:143], a[68:71], v[172:175]
buffer_load_dwordx4 v3, s[8:11], s94 offen  lds
v_mfma_f32_16x16x32_bf16 v[168:171], a[136:139], a[68:71], v[168:171]
s_add_u32 m0, s81, 115712
ds_read_b64_tr_b16 a[98:99], v9 offset:14080
v_mfma_f32_16x16x32_bf16 v[192:195], a[136:139], a[72:75], v[192:195]
ds_read_b64_tr_b16 a[100:101], v10 offset:12544
v_mfma_f32_16x16x32_bf16 v[196:199], a[140:143], a[72:75], v[196:199]
ds_read_b64_tr_b16 a[102:103], v10 offset:14080
v_mfma_f32_16x16x32_bf16 v[208:211], a[144:147], a[72:75], v[208:211]
v_mfma_f32_16x16x32_bf16 v[212:215], a[148:151], a[72:75], v[212:215]
buffer_load_dwordx4 v4, s[8:11], s94 offen  lds
v_mfma_f32_16x16x32_bf16 v[220:223], a[148:151], a[76:79], v[220:223]
s_add_u32 m0, s81, 116736
ds_read_b64_tr_b16 a[80:81], v9 offset:12288
ds_read_b64_tr_b16 a[82:83], v9 offset:13824
v_mfma_f32_16x16x32_bf16 v[216:219], a[144:147], a[76:79], v[216:219]
v_mfma_f32_16x16x32_bf16 v[204:207], a[140:143], a[76:79], v[204:207]
ds_read_b64_tr_b16 a[84:85], v10 offset:12288
v_mfma_f32_16x16x32_bf16 v[200:203], a[136:139], a[76:79], v[200:203]
v_mfma_f32_16x16x32_bf16 v[224:227], a[56:59], a[136:139], v[224:227]
ds_read_b64_tr_b16 a[86:87], v10 offset:13824
v_mfma_f32_16x16x32_bf16 v[232:235], a[56:59], a[140:143], v[232:235]
buffer_load_dwordx4 v5, s[8:11], s94 offen  lds
v_mfma_f32_16x16x32_bf16 v[240:243], a[56:59], a[144:147], v[240:243]
buffer_atomic_add v29, v27, s[32:35], s98 offen sc1
v_mfma_f32_16x16x32_bf16 v[248:251], a[56:59], a[148:151], v[248:251]
buffer_store_dwordx4 v[20:23], v1, s[24:27], s58 offen offset:0 sc1
v_mfma_f32_16x16x32_bf16 v[252:255], a[60:63], a[148:151], v[252:255]
v_mfma_f32_16x16x32_bf16 v[244:247], a[60:63], a[144:147], v[244:247]
s_nop 0
v_mfma_f32_16x16x32_bf16 v[236:239], a[60:63], a[140:143], v[236:239]
s_waitcnt vmcnt(28) lgkmcnt(0)
v_mfma_f32_16x16x32_bf16 v[228:231], a[60:63], a[136:139], v[228:231]
s_barrier
v_mfma_f32_16x16x32_bf16 v[76:79], a[28:31], a[124:127], v[76:79]
s_add_u32 m0, s73, 0
ds_read_b128 a[136:139], v7 offset:16384
s_mov_b32 s95, 1152
v_mfma_f32_16x16x32_bf16 v[104:107], a[28:31], a[128:131], v[104:107]
buffer_load_dwordx4 v2, s[4:7], s95 offen  lds
v_mfma_f32_16x16x32_bf16 v[132:135], a[28:31], a[132:135], v[132:135]
s_add_u32 m0, s73, 4096
ds_read_b64_tr_b16 a[0:1], v13 offset:32768
s_mov_b32 s96, 66688
v_mfma_f32_16x16x32_bf16 v[48:51], a[28:31], a[120:123], v[48:51]
s_cmp_eq_u32 s99, 7
s_cselect_b32 s92, 0, s100
ds_read_b64_tr_b16 a[2:3], v13 offset:34816
s_add_u32 s3, s92, 1280
v_mfma_f32_16x16x32_bf16 v[52:55], a[32:35], a[120:123], v[52:55]
buffer_load_dword a255, v44, s[4:7], s3 offen
v_mfma_f32_16x16x32_bf16 v[136:139], a[32:35], a[132:135], v[136:139]
s_add_u32 s3, s92, 4587520
ds_read_b64_tr_b16 a[4:5], v14 offset:32768
v_mfma_f32_16x16x32_bf16 v[108:111], a[32:35], a[128:131], v[108:111]
buffer_load_dwordx4 v2, s[4:7], s96 offen  lds
v_mfma_f32_16x16x32_bf16 v[80:83], a[32:35], a[124:127], v[80:83]
s_add_u32 m0, s82, 65536
ds_read_b64_tr_b16 a[6:7], v14 offset:34816
ds_read_b64_tr_b16 a[8:9], v15 offset:32768
v_mfma_f32_16x16x32_bf16 v[84:87], a[36:39], a[124:127], v[84:87]
buffer_load_dword a255, v46, s[12:15], s3 offen
v_mfma_f32_16x16x32_bf16 v[112:115], a[36:39], a[128:131], v[112:115]
s_mov_b32 s97, 3899392
ds_read_b64_tr_b16 a[10:11], v15 offset:34816
s_add_u32 s3, s92, 3932160
v_mfma_f32_16x16x32_bf16 v[140:143], a[36:39], a[132:135], v[140:143]
buffer_load_dword a255, v45, s[8:11], s3 offen
v_mfma_f32_16x16x32_bf16 v[56:59], a[36:39], a[120:123], v[56:59]
ds_read_b128 a[140:143], v7 offset:18432
v_mfma_f32_16x16x32_bf16 v[60:63], a[40:43], a[120:123], v[60:63]
buffer_load_dwordx4 v6, s[12:15], s97 offen  lds
v_mfma_f32_16x16x32_bf16 v[144:147], a[40:43], a[132:135], v[144:147]
s_add_u32 m0, s82, 67584
ds_read_b64_tr_b16 a[12:13], v16 offset:32768
ds_read_b64_tr_b16 a[14:15], v16 offset:34816
v_mfma_f32_16x16x32_bf16 v[116:119], a[40:43], a[128:131], v[116:119]
s_mov_b32 s93, 3928064
v_mfma_f32_16x16x32_bf16 v[88:91], a[40:43], a[124:127], v[88:91]
ds_read_b64_tr_b16 a[16:17], v17 offset:32768
v_mfma_f32_16x16x32_bf16 v[92:95], a[44:47], a[124:127], v[92:95]
ds_read_b64_tr_b16 a[18:19], v17 offset:34816
v_mfma_f32_16x16x32_bf16 v[120:123], a[44:47], a[128:131], v[120:123]
buffer_load_dwordx4 v6, s[12:15], s93 offen  lds
v_mfma_f32_16x16x32_bf16 v[148:151], a[44:47], a[132:135], v[148:151]
s_add_u32 m0, s82, 73728
ds_read_b64_tr_b16 a[20:21], v18 offset:32768
s_mov_b32 s94, 4014080
v_mfma_f32_16x16x32_bf16 v[64:67], a[44:47], a[120:123], v[64:67]
ds_read_b64_tr_b16 a[22:23], v18 offset:34816
v_mfma_f32_16x16x32_bf16 v[68:71], a[48:51], a[120:123], v[68:71]
s_cmp_eq_u32 s99, 7
s_cselect_b32 s98, s51, s100
v_mfma_f32_16x16x32_bf16 v[152:155], a[48:51], a[132:135], v[152:155]
ds_read_b128 a[144:147], v7 offset:20480
v_mfma_f32_16x16x32_bf16 v[124:127], a[48:51], a[128:131], v[124:127]
ds_read_b64_tr_b16 a[24:25], v19 offset:32768
v_mfma_f32_16x16x32_bf16 v[96:99], a[48:51], a[124:127], v[96:99]
buffer_load_dwordx4 v6, s[12:15], s94 offen  lds
v_mfma_f32_16x16x32_bf16 v[100:103], a[52:55], a[124:127], v[100:103]
s_add_u32 m0, s82, 75776
ds_read_b64_tr_b16 a[26:27], v19 offset:34816
s_mov_b32 s95, 4042752
v_mfma_f32_16x16x32_bf16 v[128:131], a[52:55], a[128:131], v[128:131]
ds_read_b64_tr_b16 a[64:65], v9 offset:24704
v_mfma_f32_16x16x32_bf16 v[156:159], a[52:55], a[132:135], v[156:159]
v_mfma_f32_16x16x32_bf16 v[72:75], a[52:55], a[120:123], v[72:75]
ds_read_b64_tr_b16 a[66:67], v9 offset:26240
v_mfma_f32_16x16x32_bf16 v[160:163], a[152:155], a[88:91], v[160:163]
buffer_load_dwordx4 v6, s[12:15], s95 offen  lds
v_mfma_f32_16x16x32_bf16 v[164:167], a[156:159], a[88:91], v[164:167]
s_mov_b32 s96, 2555904
ds_read_b64_tr_b16 a[68:69], v10 offset:24704
s_add_u32 m0, s81, 126976
v_mfma_f32_16x16x32_bf16 v[176:179], a[160:163], a[88:91], v[176:179]
ds_read_b64_tr_b16 a[70:71], v10 offset:26240
v_mfma_f32_16x16x32_bf16 v[180:183], a[164:167], a[88:91], v[180:183]
ds_read_b128 a[148:151], v7 offset:22528
v_mfma_f32_16x16x32_bf16 v[188:191], a[164:167], a[92:95], v[188:191]
v_mfma_f32_16x16x32_bf16 v[184:187], a[160:163], a[92:95], v[184:187]
ds_read_b64_tr_b16 a[72:73], v9 offset:24832
v_mfma_f32_16x16x32_bf16 v[172:175], a[156:159], a[92:95], v[172:175]
buffer_load_dwordx4 v3, s[8:11], s96 offen  lds
v_mfma_f32_16x16x32_bf16 v[168:171], a[152:155], a[92:95], v[168:171]
s_add_u32 m0, s81, 128000
ds_read_b64_tr_b16 a[74:75], v9 offset:26368
v_mfma_f32_16x16x32_bf16 v[192:195], a[152:155], a[96:99], v[192:195]
ds_read_b64_tr_b16 a[76:77], v10 offset:24832
v_mfma_f32_16x16x32_bf16 v[196:199], a[156:159], a[96:99], v[196:199]
ds_read_b64_tr_b16 a[78:79], v10 offset:26368
v_mfma_f32_16x16x32_bf16 v[208:211], a[160:163], a[96:99], v[208:211]
v_mfma_f32_16x16x32_bf16 v[212:215], a[164:167], a[96:99], v[212:215]
buffer_load_dwordx4 v4, s[8:11], s96 offen  lds
v_mfma_f32_16x16x32_bf16 v[220:223], a[164:167], a[100:103], v[220:223]
s_add_u32 m0, s81, 129024
ds_read_b64_tr_b16 a[56:57], v9 offset:24576
ds_read_b64_tr_b16 a[58:59], v9 offset:26112
v_mfma_f32_16x16x32_bf16 v[216:219], a[160:163], a[100:103], v[216:219]
v_mfma_f32_16x16x32_bf16 v[204:207], a[156:159], a[100:103], v[204:207]
ds_read_b64_tr_b16 a[60:61], v10 offset:24576
v_mfma_f32_16x16x32_bf16 v[200:203], a[152:155], a[100:103], v[200:203]
v_mfma_f32_16x16x32_bf16 v[224:227], a[80:83], a[152:155], v[224:227]
ds_read_b64_tr_b16 a[62:63], v10 offset:26112
v_mfma_f32_16x16x32_bf16 v[232:235], a[80:83], a[156:159], v[232:235]
buffer_load_dwordx4 v5, s[8:11], s96 offen  lds
v_mfma_f32_16x16x32_bf16 v[240:243], a[80:83], a[160:163], v[240:243]
buffer_atomic_add v29, v27, s[32:35], s98 offen sc1
v_mfma_f32_16x16x32_bf16 v[248:251], a[80:83], a[164:167], v[248:251]
buffer_store_dwordx4 v[20:23], v1, s[24:27], s58 offen offset:1024 sc1
v_mfma_f32_16x16x32_bf16 v[252:255], a[84:87], a[164:167], v[252:255]
v_mfma_f32_16x16x32_bf16 v[244:247], a[84:87], a[160:163], v[244:247]
v_mfma_f32_16x16x32_bf16 v[236:239], a[84:87], a[156:159], v[236:239]
s_waitcnt vmcnt(29) lgkmcnt(0)
v_mfma_f32_16x16x32_bf16 v[228:231], a[84:87], a[152:155], v[228:231]
s_barrier
v_mfma_f32_16x16x32_bf16 v[76:79], a[0:3], a[140:143], v[76:79]
s_add_u32 m0, s73, 8192
ds_read_b128 a[152:155], v8 offset:16384
s_mov_b32 s97, 132224
v_mfma_f32_16x16x32_bf16 v[104:107], a[0:3], a[144:147], v[104:107]
buffer_load_dwordx4 v2, s[4:7], s97 offen  lds
v_mfma_f32_16x16x32_bf16 v[132:135], a[0:3], a[148:151], v[132:135]
s_add_u32 m0, s73, 12288
ds_read_b64_tr_b16 a[28:29], v13 offset:49152
s_mov_b32 s93, 197760
v_mfma_f32_16x16x32_bf16 v[48:51], a[0:3], a[136:139], v[48:51]
Lpad3:
s_cbranch_execz Lpad7
s_nop 0
ds_read_b64_tr_b16 a[30:31], v13 offset:51200
v_mfma_f32_16x16x32_bf16 v[52:55], a[4:7], a[136:139], v[52:55]
ds_read_b64_tr_b16 a[32:33], v14 offset:49152
v_mfma_f32_16x16x32_bf16 v[136:139], a[4:7], a[148:151], v[136:139]
v_mfma_f32_16x16x32_bf16 v[108:111], a[4:7], a[144:147], v[108:111]
buffer_load_dwordx4 v2, s[4:7], s93 offen  lds
v_mfma_f32_16x16x32_bf16 v[80:83], a[4:7], a[140:143], v[80:83]
s_add_u32 m0, s82, 81920
ds_read_b64_tr_b16 a[34:35], v14 offset:51200
ds_read_b64_tr_b16 a[36:37], v15 offset:49152
v_mfma_f32_16x16x32_bf16 v[84:87], a[8:11], a[140:143], v[84:87]
s_mov_b32 s94, 4128768
v_mfma_f32_16x16x32_bf16 v[112:115], a[8:11], a[144:147], v[112:115]
ds_read_b64_tr_b16 a[38:39], v15 offset:51200
v_mfma_f32_16x16x32_bf16 v[140:143], a[8:11], a[148:151], v[140:143]
ds_read_b128 a[156:159], v8 offset:18432
v_mfma_f32_16x16x32_bf16 v[56:59], a[8:11], a[136:139], v[56:59]
v_mfma_f32_16x16x32_bf16 v[60:63], a[12:15], a[136:139], v[60:63]
buffer_load_dwordx4 v6, s[12:15], s94 offen  lds
v_mfma_f32_16x16x32_bf16 v[144:147], a[12:15], a[148:151], v[144:147]
s_add_u32 m0, s82, 83968
ds_read_b64_tr_b16 a[40:41], v16 offset:49152
ds_read_b64_tr_b16 a[42:43], v16 offset:51200
v_mfma_f32_16x16x32_bf16 v[116:119], a[12:15], a[144:147], v[116:119]
s_mov_b32 s95, 4157440
v_mfma_f32_16x16x32_bf16 v[88:91], a[12:15], a[140:143], v[88:91]
ds_read_b64_tr_b16 a[44:45], v17 offset:49152
v_mfma_f32_16x16x32_bf16 v[92:95], a[16:19], a[140:143], v[92:95]
ds_read_b64_tr_b16 a[46:47], v17 offset:51200
v_mfma_f32_16x16x32_bf16 v[120:123], a[16:19], a[144:147], v[120:123]
buffer_load_dwordx4 v6, s[12:15], s95 offen  lds
v_mfma_f32_16x16x32_bf16 v[148:151], a[16:19], a[148:151], v[148:151]
s_add_u32 m0, s82, 90112
ds_read_b64_tr_b16 a[48:49], v18 offset:49152
s_mov_b32 s96, 4243456
v_mfma_f32_16x16x32_bf16 v[64:67], a[16:19], a[136:139], v[64:67]
ds_read_b64_tr_b16 a[50:51], v18 offset:51200
v_mfma_f32_16x16x32_bf16 v[68:71], a[20:23], a[136:139], v[68:71]
v_mfma_f32_16x16x32_bf16 v[152:155], a[20:23], a[148:151], v[152:155]
ds_read_b128 a[160:163], v8 offset:20480
v_mfma_f32_16x16x32_bf16 v[124:127], a[20:23], a[144:147], v[124:127]
ds_read_b64_tr_b16 a[52:53], v19 offset:49152
v_mfma_f32_16x16x32_bf16 v[96:99], a[20:23], a[140:143], v[96:99]
buffer_load_dwordx4 v6, s[12:15], s96 offen  lds
v_mfma_f32_16x16x32_bf16 v[100:103], a[24:27], a[140:143], v[100:103]
s_add_u32 m0, s82, 92160
ds_read_b64_tr_b16 a[54:55], v19 offset:51200
s_mov_b32 s97, 4272128
v_mfma_f32_16x16x32_bf16 v[128:131], a[24:27], a[144:147], v[128:131]
ds_read_b64_tr_b16 a[88:89], v9 offset:36992
v_mfma_f32_16x16x32_bf16 v[156:159], a[24:27], a[148:151], v[156:159]
v_mfma_f32_16x16x32_bf16 v[72:75], a[24:27], a[136:139], v[72:75]
ds_read_b64_tr_b16 a[90:91], v9 offset:38528
v_mfma_f32_16x16x32_bf16 v[160:163], a[168:171], a[64:67], v[160:163]
buffer_load_dwordx4 v6, s[12:15], s97 offen  lds
v_mfma_f32_16x16x32_bf16 v[164:167], a[172:175], a[64:67], v[164:167]
s_mov_b32 s93, 2752512
ds_read_b64_tr_b16 a[92:93], v10 offset:36992
s_add_u32 m0, s81, 139264
v_mfma_f32_16x16x32_bf16 v[176:179], a[176:179], a[64:67], v[176:179]
buffer_load_dwordx4 a[228:231], v1, s[4:7], s48 offen offset:0
v_mfma_f32_16x16x32_bf16 v[180:183], a[180:183], a[64:67], v[180:183]
s_nop 0
ds_read_b64_tr_b16 a[94:95], v10 offset:38528
ds_read_b128 a[164:167], v8 offset:22528
v_mfma_f32_16x16x32_bf16 v[188:191], a[180:183], a[68:71], v[188:191]
buffer_load_dwordx4 a[236:239], v1, s[4:7], s49 offen offset:0
v_mfma_f32_16x16x32_bf16 v[184:187], a[176:179], a[68:71], v[184:187]
s_nop 0
ds_read_b64_tr_b16 a[96:97], v9 offset:37120
v_mfma_f32_16x16x32_bf16 v[172:175], a[172:175], a[68:71], v[172:175]
buffer_load_dwordx4 v3, s[8:11], s93 offen  lds
v_mfma_f32_16x16x32_bf16 v[168:171], a[168:171], a[68:71], v[168:171]
buffer_load_dwordx4 a[244:247], v1, s[44:47], 0 offen offset:0
v_mfma_f32_16x16x32_bf16 v[192:195], a[168:171], a[72:75], v[192:195]
s_add_u32 m0, s81, 140288
ds_read_b64_tr_b16 a[98:99], v9 offset:38656
ds_read_b64_tr_b16 a[100:101], v10 offset:37120
v_mfma_f32_16x16x32_bf16 v[196:199], a[172:175], a[72:75], v[196:199]
buffer_load_dwordx4 a[232:235], v1, s[4:7], s48 offen offset:1024
v_mfma_f32_16x16x32_bf16 v[208:211], a[176:179], a[72:75], v[208:211]
ds_read_b64_tr_b16 a[102:103], v10 offset:38656
v_mfma_f32_16x16x32_bf16 v[212:215], a[180:183], a[72:75], v[212:215]
buffer_load_dwordx4 v4, s[8:11], s93 offen  lds
v_mfma_f32_16x16x32_bf16 v[220:223], a[180:183], a[76:79], v[220:223]
s_add_u32 m0, s81, 141312
ds_read_b64_tr_b16 a[80:81], v9 offset:36864
ds_read_b64_tr_b16 a[82:83], v9 offset:38400
v_mfma_f32_16x16x32_bf16 v[216:219], a[176:179], a[76:79], v[216:219]
buffer_load_dwordx4 a[240:243], v1, s[4:7], s49 offen offset:1024
v_mfma_f32_16x16x32_bf16 v[204:207], a[172:175], a[76:79], v[204:207]
buffer_load_dwordx4 a[248:251], v1, s[44:47], 0 offen offset:1024
v_mfma_f32_16x16x32_bf16 v[200:203], a[168:171], a[76:79], v[200:203]
ds_read_b64_tr_b16 a[84:85], v10 offset:36864
v_mfma_f32_16x16x32_bf16 v[224:227], a[56:59], a[168:171], v[224:227]
ds_read_b64_tr_b16 a[86:87], v10 offset:38400
v_mfma_f32_16x16x32_bf16 v[232:235], a[56:59], a[172:175], v[232:235]
buffer_load_dwordx4 v5, s[8:11], s93 offen  lds
v_mfma_f32_16x16x32_bf16 v[240:243], a[56:59], a[176:179], v[240:243]
buffer_store_dwordx4 v[20:23], v1, s[24:27], s58 offen offset:2048 sc1
v_mfma_f32_16x16x32_bf16 v[248:251], a[56:59], a[180:183], v[248:251]
v_mfma_f32_16x16x32_bf16 v[252:255], a[60:63], a[180:183], v[252:255]
v_mfma_f32_16x16x32_bf16 v[244:247], a[60:63], a[176:179], v[244:247]
v_mfma_f32_16x16x32_bf16 v[236:239], a[60:63], a[172:175], v[236:239]
s_waitcnt vmcnt(32) lgkmcnt(0)
v_mfma_f32_16x16x32_bf16 v[228:231], a[60:63], a[168:171], v[228:231]
s_barrier
v_mfma_f32_16x16x32_bf16 v[76:79], a[28:31], a[156:159], v[76:79]
s_add_u32 m0, s73, 16384
ds_read_b128 a[168:171], v7 offset:32768
s_mov_b32 s94, 1280
v_mfma_f32_16x16x32_bf16 v[104:107], a[28:31], a[160:163], v[104:107]
buffer_load_dwordx4 v2, s[4:7], s94 offen  lds
v_mfma_f32_16x16x32_bf16 v[132:135], a[28:31], a[164:167], v[132:135]
s_add_u32 m0, s73, 20480
ds_read_b64_tr_b16 a[0:1], v13 offset:0
s_mov_b32 s95, 66816
v_mfma_f32_16x16x32_bf16 v[48:51], a[28:31], a[152:155], v[48:51]
ds_read_b64_tr_b16 a[2:3], v13 offset:2048
v_lshrrev_b32 v11, 3, v0
v_mfma_f32_16x16x32_bf16 v[52:55], a[32:35], a[152:155], v[52:55]
ds_read_b64_tr_b16 a[4:5], v14 offset:0
v_lshlrev_b32 v11, 4, v11
v_mfma_f32_16x16x32_bf16 v[136:139], a[32:35], a[164:167], v[136:139]
s_nop 0
v_and_or_b32 v11, v0, 7, v11
v_lshlrev_b32 v11, 7, v11
v_mfma_f32_16x16x32_bf16 v[108:111], a[32:35], a[160:163], v[108:111]
buffer_load_dwordx4 v2, s[4:7], s95 offen  lds
v_mfma_f32_16x16x32_bf16 v[80:83], a[32:35], a[156:159], v[80:83]
s_add_u32 m0, s82, 98304
ds_read_b64_tr_b16 a[6:7], v14 offset:2048
ds_read_b64_tr_b16 a[8:9], v15 offset:0
v_mfma_f32_16x16x32_bf16 v[84:87], a[36:39], a[156:159], v[84:87]
s_mov_b32 s96, 4358144
v_cmp_gt_u32 vcc, 16, v0
v_mfma_f32_16x16x32_bf16 v[112:115], a[36:39], a[160:163], v[112:115]
ds_read_b64_tr_b16 a[10:11], v15 offset:2048
v_cndmask_b32 v11, v47, v11, vcc
v_mfma_f32_16x16x32_bf16 v[140:143], a[36:39], a[164:167], v[140:143]
s_cmp_eq_u32 s99, 0
s_cselect_b32 s92, 0, s100
ds_read_b128 a[172:175], v7 offset:34816
s_add_u32 s3, s92, s70
v_mfma_f32_16x16x32_bf16 v[56:59], a[36:39], a[152:155], v[56:59]
v_mfma_f32_16x16x32_bf16 v[60:63], a[40:43], a[152:155], v[60:63]
buffer_load_dwordx4 v6, s[12:15], s96 offen  lds
v_mfma_f32_16x16x32_bf16 v[144:147], a[40:43], a[164:167], v[144:147]
s_add_u32 m0, s82, 100352
ds_read_b64_tr_b16 a[12:13], v16 offset:0
ds_read_b64_tr_b16 a[14:15], v16 offset:2048
v_mfma_f32_16x16x32_bf16 v[116:119], a[40:43], a[160:163], v[116:119]
buffer_load_dword a255, v11, s[20:23], s3 offen
v_mfma_f32_16x16x32_bf16 v[88:91], a[40:43], a[156:159], v[88:91]
s_mov_b32 s97, 4386816
ds_read_b64_tr_b16 a[16:17], v17 offset:0
s_cmp_eq_u32 s99, 1
s_cselect_b32 s92, 0, s100
v_mfma_f32_16x16x32_bf16 v[92:95], a[44:47], a[156:159], v[92:95]
s_add_u32 s3, s92, s70
ds_read_b64_tr_b16 a[18:19], v17 offset:2048
v_mfma_f32_16x16x32_bf16 v[120:123], a[44:47], a[160:163], v[120:123]
buffer_load_dwordx4 v6, s[12:15], s97 offen  lds
v_mfma_f32_16x16x32_bf16 v[148:151], a[44:47], a[164:167], v[148:151]
buffer_load_dword a255, v11, s[20:23], s3 offen
v_mfma_f32_16x16x32_bf16 v[64:67], a[44:47], a[152:155], v[64:67]
s_add_u32 m0, s82, 106496
ds_read_b64_tr_b16 a[20:21], v18 offset:0
ds_read_b64_tr_b16 a[22:23], v18 offset:2048
v_mfma_f32_16x16x32_bf16 v[68:71], a[48:51], a[152:155], v[68:71]
s_mov_b32 s93, 4472832
v_mfma_f32_16x16x32_bf16 v[152:155], a[48:51], a[164:167], v[152:155]
ds_read_b128 a[176:179], v7 offset:36864
v_mfma_f32_16x16x32_bf16 v[124:127], a[48:51], a[160:163], v[124:127]
ds_read_b64_tr_b16 a[24:25], v19 offset:0
v_mfma_f32_16x16x32_bf16 v[96:99], a[48:51], a[156:159], v[96:99]
buffer_load_dwordx4 v6, s[12:15], s93 offen  lds
v_mfma_f32_16x16x32_bf16 v[100:103], a[52:55], a[156:159], v[100:103]
s_add_u32 m0, s82, 108544
ds_read_b64_tr_b16 a[26:27], v19 offset:2048
s_mov_b32 s94, 4501504
v_mfma_f32_16x16x32_bf16 v[128:131], a[52:55], a[160:163], v[128:131]
ds_read_b64_tr_b16 a[64:65], v9 offset:128
v_mfma_f32_16x16x32_bf16 v[156:159], a[52:55], a[164:167], v[156:159]
v_mfma_f32_16x16x32_bf16 v[72:75], a[52:55], a[152:155], v[72:75]
ds_read_b64_tr_b16 a[66:67], v9 offset:1664
v_mfma_f32_16x16x32_bf16 v[160:163], a[184:187], a[88:91], v[160:163]
buffer_load_dwordx4 v6, s[12:15], s94 offen  lds
v_mfma_f32_16x16x32_bf16 v[164:167], a[188:191], a[88:91], v[164:167]
s_mov_b32 s95, 2949120
ds_read_b64_tr_b16 a[68:69], v10 offset:128
s_add_u32 m0, s81, 151552
v_mfma_f32_16x16x32_bf16 v[176:179], a[192:195], a[88:91], v[176:179]
ds_read_b64_tr_b16 a[70:71], v10 offset:1664
v_mfma_f32_16x16x32_bf16 v[180:183], a[196:199], a[88:91], v[180:183]
ds_read_b128 a[180:183], v7 offset:38912
v_mfma_f32_16x16x32_bf16 v[188:191], a[196:199], a[92:95], v[188:191]
v_mfma_f32_16x16x32_bf16 v[184:187], a[192:195], a[92:95], v[184:187]
ds_read_b64_tr_b16 a[72:73], v9 offset:256
v_mfma_f32_16x16x32_bf16 v[172:175], a[188:191], a[92:95], v[172:175]
buffer_load_dwordx4 v3, s[8:11], s95 offen  lds
v_mfma_f32_16x16x32_bf16 v[168:171], a[184:187], a[92:95], v[168:171]
s_add_u32 m0, s81, 152576
ds_read_b64_tr_b16 a[74:75], v9 offset:1792
v_mfma_f32_16x16x32_bf16 v[192:195], a[184:187], a[96:99], v[192:195]
ds_read_b64_tr_b16 a[76:77], v10 offset:256
v_mfma_f32_16x16x32_bf16 v[196:199], a[188:191], a[96:99], v[196:199]
ds_read_b64_tr_b16 a[78:79], v10 offset:1792
v_mfma_f32_16x16x32_bf16 v[208:211], a[192:195], a[96:99], v[208:211]
v_mfma_f32_16x16x32_bf16 v[212:215], a[196:199], a[96:99], v[212:215]
buffer_load_dwordx4 v4, s[8:11], s95 offen  lds
v_mfma_f32_16x16x32_bf16 v[220:223], a[196:199], a[100:103], v[220:223]
s_add_u32 m0, s81, 153600
ds_read_b64_tr_b16 a[56:57], v9 offset:0
ds_read_b64_tr_b16 a[58:59], v9 offset:1536
v_mfma_f32_16x16x32_bf16 v[216:219], a[192:195], a[100:103], v[216:219]
v_mfma_f32_16x16x32_bf16 v[204:207], a[188:191], a[100:103], v[204:207]
ds_read_b64_tr_b16 a[60:61], v10 offset:0
v_mfma_f32_16x16x32_bf16 v[200:203], a[184:187], a[100:103], v[200:203]
v_mfma_f32_16x16x32_bf16 v[224:227], a[80:83], a[184:187], v[224:227]
ds_read_b64_tr_b16 a[62:63], v10 offset:1536
v_mfma_f32_16x16x32_bf16 v[232:235], a[80:83], a[188:191], v[232:235]
buffer_load_dwordx4 v5, s[8:11], s95 offen  lds
v_mfma_f32_16x16x32_bf16 v[240:243], a[80:83], a[192:195], v[240:243]
buffer_store_dwordx4 v[20:23], v1, s[24:27], s58 offen offset:3072 sc1
v_mfma_f32_16x16x32_bf16 v[248:251], a[80:83], a[196:199], v[248:251]
v_mfma_f32_16x16x32_bf16 v[252:255], a[84:87], a[196:199], v[252:255]
v_mfma_f32_16x16x32_bf16 v[244:247], a[84:87], a[192:195], v[244:247]
v_mfma_f32_16x16x32_bf16 v[236:239], a[84:87], a[188:191], v[236:239]
s_waitcnt vmcnt(30) lgkmcnt(0)
v_mfma_f32_16x16x32_bf16 v[228:231], a[84:87], a[184:187], v[228:231]
s_barrier
Lu16:
v_mfma_f32_16x16x32_bf16 v[76:79], a[0:3], a[172:175], v[76:79]
s_add_u32 m0, s73, 24576
ds_read_b128 a[184:187], v8 offset:32768
s_mov_b32 s96, 132352
v_mfma_f32_16x16x32_bf16 v[104:107], a[0:3], a[176:179], v[104:107]
buffer_load_dwordx4 v2, s[4:7], s96 offen  lds
v_mfma_f32_16x16x32_bf16 v[132:135], a[0:3], a[180:183], v[132:135]
s_add_u32 m0, s73, 28672
ds_read_b64_tr_b16 a[28:29], v13 offset:16384
s_mov_b32 s97, 197888
v_mfma_f32_16x16x32_bf16 v[48:51], a[0:3], a[168:171], v[48:51]
s_cmp_eq_u32 s99, 2
s_cselect_b32 s92, 0, s100
ds_read_b64_tr_b16 a[30:31], v13 offset:18432
s_add_u32 s3, s92, s70
v_mfma_f32_16x16x32_bf16 v[52:55], a[4:7], a[168:171], v[52:55]
buffer_load_dword a255, v11, s[20:23], s3 offen
v_mfma_f32_16x16x32_bf16 v[136:139], a[4:7], a[180:183], v[136:139]
s_cmp_eq_u32 s99, 3
s_cselect_b32 s92, 0, s100
ds_read_b64_tr_b16 a[32:33], v14 offset:16384
s_add_u32 s3, s92, s70
v_mfma_f32_16x16x32_bf16 v[108:111], a[4:7], a[176:179], v[108:111]
buffer_load_dwordx4 v2, s[4:7], s97 offen  lds
v_mfma_f32_16x16x32_bf16 v[80:83], a[4:7], a[172:175], v[80:83]
s_add_u32 m0, s82, 49152
ds_read_b64_tr_b16 a[34:35], v14 offset:18432
ds_read_b64_tr_b16 a[36:37], v15 offset:16384
v_mfma_f32_16x16x32_bf16 v[84:87], a[8:11], a[172:175], v[84:87]
buffer_load_dword a255, v11, s[20:23], s3 offen
v_mfma_f32_16x16x32_bf16 v[112:115], a[8:11], a[176:179], v[112:115]
s_mov_b32 s93, 4587520
ds_read_b64_tr_b16 a[38:39], v15 offset:18432
s_waitcnt vmcnt(18)
v_mfma_f32_16x16x32_bf16 v[140:143], a[8:11], a[180:183], v[140:143]
s_nop 0
ds_read_b128 a[188:191], v8 offset:34816
v_mov_b32 v32, 0
v_mfma_f32_16x16x32_bf16 v[56:59], a[8:11], a[168:171], v[56:59]
v_mov_b32 v33, 0
v_accvgpr_read_b32 v41, a244
v_mfma_f32_16x16x32_bf16 v[60:63], a[12:15], a[168:171], v[60:63]
buffer_load_dwordx4 v6, s[12:15], s93 offen  lds
v_mfma_f32_16x16x32_bf16 v[144:147], a[12:15], a[180:183], v[144:147]
s_add_u32 m0, s82, 51200
ds_read_b64_tr_b16 a[40:41], v16 offset:16384
ds_read_b64_tr_b16 a[42:43], v16 offset:18432
v_mfma_f32_16x16x32_bf16 v[116:119], a[12:15], a[176:179], v[116:119]
s_mov_b32 s94, 4616192
v_lshlrev_b32 v40, 16, v41
v_and_b32 v41, 0xffff0000, v41
v_mfma_f32_16x16x32_bf16 v[88:91], a[12:15], a[172:175], v[88:91]
ds_read_b64_tr_b16 a[44:45], v17 offset:16384
v_accvgpr_read_b32 v43, a228
v_mfma_f32_16x16x32_bf16 v[92:95], a[16:19], a[172:175], v[92:95]
ds_read_b64_tr_b16 a[46:47], v17 offset:18432
v_lshlrev_b32 v42, 16, v43
v_mfma_f32_16x16x32_bf16 v[120:123], a[16:19], a[176:179], v[120:123]
buffer_load_dwordx4 v6, s[12:15], s94 offen  lds
v_mfma_f32_16x16x32_bf16 v[148:151], a[16:19], a[180:183], v[148:151]
s_add_u32 m0, s82, 57344
ds_read_b64_tr_b16 a[48:49], v18 offset:16384
s_mov_b32 s95, 4702208
v_mfma_f32_16x16x32_bf16 v[64:67], a[16:19], a[168:171], v[64:67]
ds_read_b64_tr_b16 a[50:51], v18 offset:18432
v_and_b32 v43, 0xffff0000, v43
v_mfma_f32_16x16x32_bf16 v[68:71], a[20:23], a[168:171], v[68:71]
v_fmac_f32 v32, v42, v40
v_fmac_f32 v32, v43, v41
v_mfma_f32_16x16x32_bf16 v[152:155], a[20:23], a[180:183], v[152:155]
ds_read_b128 a[192:195], v8 offset:36864
v_accvgpr_read_b32 v43, a236
v_mfma_f32_16x16x32_bf16 v[124:127], a[20:23], a[176:179], v[124:127]
s_nop 0
ds_read_b64_tr_b16 a[52:53], v19 offset:16384
v_lshlrev_b32 v42, 16, v43
v_mfma_f32_16x16x32_bf16 v[96:99], a[20:23], a[172:175], v[96:99]
buffer_load_dwordx4 v6, s[12:15], s95 offen  lds
v_mfma_f32_16x16x32_bf16 v[100:103], a[24:27], a[172:175], v[100:103]
s_add_u32 m0, s82, 59392
ds_read_b64_tr_b16 a[54:55], v19 offset:18432
s_mov_b32 s96, 4730880
v_mfma_f32_16x16x32_bf16 v[128:131], a[24:27], a[176:179], v[128:131]
ds_read_b64_tr_b16 a[88:89], v9 offset:12416
v_and_b32 v43, 0xffff0000, v43
v_mfma_f32_16x16x32_bf16 v[156:159], a[24:27], a[180:183], v[156:159]
v_fmac_f32 v33, v42, v40
v_fmac_f32 v33, v43, v41
v_mfma_f32_16x16x32_bf16 v[72:75], a[24:27], a[168:171], v[72:75]
ds_read_b64_tr_b16 a[90:91], v9 offset:13952
v_accvgpr_read_b32 v41, a245
v_mfma_f32_16x16x32_bf16 v[160:163], a[104:107], a[64:67], v[160:163]
buffer_load_dwordx4 v6, s[12:15], s96 offen  lds
v_mfma_f32_16x16x32_bf16 v[164:167], a[108:111], a[64:67], v[164:167]
s_mov_b32 s97, 3145728
ds_read_b64_tr_b16 a[92:93], v10 offset:12416
s_add_u32 m0, s81, 114688
v_mfma_f32_16x16x32_bf16 v[176:179], a[112:115], a[64:67], v[176:179]
s_nop 0
ds_read_b64_tr_b16 a[94:95], v10 offset:13952
v_lshlrev_b32 v40, 16, v41
v_mfma_f32_16x16x32_bf16 v[180:183], a[116:119], a[64:67], v[180:183]
ds_read_b128 a[196:199], v8 offset:38912
v_and_b32 v41, 0xffff0000, v41
v_mfma_f32_16x16x32_bf16 v[188:191], a[116:119], a[68:71], v[188:191]
v_accvgpr_read_b32 v43, a229
v_lshlrev_b32 v42, 16, v43
v_mfma_f32_16x16x32_bf16 v[184:187], a[112:115], a[68:71], v[184:187]
ds_read_b64_tr_b16 a[96:97], v9 offset:12544
v_and_b32 v43, 0xffff0000, v43
v_mfma_f32_16x16x32_bf16 v[172:175], a[108:111], a[68:71], v[172:175]
buffer_load_dwordx4 v3, s[8:11], s97 offen  lds
v_mfma_f32_16x16x32_bf16 v[168:171], a[104:107], a[68:71], v[168:171]
s_add_u32 m0, s81, 115712
ds_read_b64_tr_b16 a[98:99], v9 offset:14080
v_fmac_f32 v32, v42, v40
v_mfma_f32_16x16x32_bf16 v[192:195], a[104:107], a[72:75], v[192:195]
ds_read_b64_tr_b16 a[100:101], v10 offset:12544
v_fmac_f32 v32, v43, v41
v_mfma_f32_16x16x32_bf16 v[196:199], a[108:111], a[72:75], v[196:199]
ds_read_b64_tr_b16 a[102:103], v10 offset:14080
v_accvgpr_read_b32 v43, a237
v_mfma_f32_16x16x32_bf16 v[208:211], a[112:115], a[72:75], v[208:211]
v_lshlrev_b32 v42, 16, v43
v_and_b32 v43, 0xffff0000, v43
v_mfma_f32_16x16x32_bf16 v[212:215], a[116:119], a[72:75], v[212:215]
buffer_load_dwordx4 v4, s[8:11], s97 offen  lds
v_mfma_f32_16x16x32_bf16 v[220:223], a[116:119], a[76:79], v[220:223]
s_add_u32 m0, s81, 116736
ds_read_b64_tr_b16 a[80:81], v9 offset:12288
ds_read_b64_tr_b16 a[82:83], v9 offset:13824
v_mfma_f32_16x16x32_bf16 v[216:219], a[112:115], a[76:79], v[216:219]
v_fmac_f32 v33, v42, v40
v_fmac_f32 v33, v43, v41
v_mfma_f32_16x16x32_bf16 v[204:207], a[108:111], a[76:79], v[204:207]
ds_read_b64_tr_b16 a[84:85], v10 offset:12288
v_accvgpr_read_b32 v41, a246
v_mfma_f32_16x16x32_bf16 v[200:203], a[104:107], a[76:79], v[200:203]
v_lshlrev_b32 v40, 16, v41
v_and_b32 v41, 0xffff0000, v41
v_mfma_f32_16x16x32_bf16 v[224:227], a[56:59], a[104:107], v[224:227]
ds_read_b64_tr_b16 a[86:87], v10 offset:13824
v_accvgpr_read_b32 v43, a230
v_mfma_f32_16x16x32_bf16 v[232:235], a[56:59], a[108:111], v[232:235]
buffer_load_dwordx4 v5, s[8:11], s97 offen  lds
v_mfma_f32_16x16x32_bf16 v[240:243], a[56:59], a[112:115], v[240:243]
v_lshlrev_b32 v42, 16, v43
v_and_b32 v43, 0xffff0000, v43
v_mfma_f32_16x16x32_bf16 v[248:251], a[56:59], a[116:119], v[248:251]
v_fmac_f32 v32, v42, v40
v_fmac_f32 v32, v43, v41
v_mfma_f32_16x16x32_bf16 v[252:255], a[60:63], a[116:119], v[252:255]
v_accvgpr_read_b32 v43, a238
v_lshlrev_b32 v42, 16, v43
v_mfma_f32_16x16x32_bf16 v[244:247], a[60:63], a[112:115], v[244:247]
v_and_b32 v43, 0xffff0000, v43
v_fmac_f32 v33, v42, v40
v_mfma_f32_16x16x32_bf16 v[236:239], a[60:63], a[108:111], v[236:239]
s_waitcnt vmcnt(24) lgkmcnt(0)
v_fmac_f32 v33, v43, v41
v_accvgpr_read_b32 v41, a247
v_mfma_f32_16x16x32_bf16 v[228:231], a[60:63], a[104:107], v[228:231]
s_barrier
v_lshlrev_b32 v40, 16, v41
v_and_b32 v41, 0xffff0000, v41
v_mfma_f32_16x16x32_bf16 v[76:79], a[28:31], a[188:191], v[76:79]
s_add_u32 m0, s73, 32768
ds_read_b128 a[104:107], v7 offset:0
s_mov_b32 s93, 1408
v_mfma_f32_16x16x32_bf16 v[104:107], a[28:31], a[192:195], v[104:107]
buffer_load_dwordx4 v2, s[4:7], s93 offen  lds
v_mfma_f32_16x16x32_bf16 v[132:135], a[28:31], a[196:199], v[132:135]
s_add_u32 m0, s73, 36864
ds_read_b64_tr_b16 a[0:1], v13 offset:32768
s_mov_b32 s94, 66944
v_mfma_f32_16x16x32_bf16 v[48:51], a[28:31], a[184:187], v[48:51]
s_cmp_eq_u32 s99, 4
s_cselect_b32 s92, 0, s100
ds_read_b64_tr_b16 a[2:3], v13 offset:34816
s_add_u32 s3, s92, s70
v_mfma_f32_16x16x32_bf16 v[52:55], a[32:35], a[184:187], v[52:55]
buffer_load_dword a255, v11, s[20:23], s3 offen
v_mfma_f32_16x16x32_bf16 v[136:139], a[32:35], a[196:199], v[136:139]
s_nop 0
ds_read_b64_tr_b16 a[4:5], v14 offset:32768
v_accvgpr_read_b32 v43, a231
v_mfma_f32_16x16x32_bf16 v[108:111], a[32:35], a[192:195], v[108:111]
buffer_load_dwordx4 v2, s[4:7], s94 offen  lds
v_mfma_f32_16x16x32_bf16 v[80:83], a[32:35], a[188:191], v[80:83]
s_add_u32 m0, s82, 65536
ds_read_b64_tr_b16 a[6:7], v14 offset:34816
ds_read_b64_tr_b16 a[8:9], v15 offset:32768
v_mfma_f32_16x16x32_bf16 v[84:87], a[36:39], a[188:191], v[84:87]
s_mov_b32 s95, 4816896
v_lshlrev_b32 v42, 16, v43
v_and_b32 v43, 0xffff0000, v43
v_mfma_f32_16x16x32_bf16 v[112:115], a[36:39], a[192:195], v[112:115]
ds_read_b64_tr_b16 a[10:11], v15 offset:34816
v_fmac_f32 v32, v42, v40
v_mfma_f32_16x16x32_bf16 v[140:143], a[36:39], a[196:199], v[140:143]
ds_read_b128 a[108:111], v7 offset:2048
v_fmac_f32 v32, v43, v41
v_mfma_f32_16x16x32_bf16 v[56:59], a[36:39], a[184:187], v[56:59]
v_accvgpr_read_b32 v43, a239
v_lshlrev_b32 v42, 16, v43
v_mfma_f32_16x16x32_bf16 v[60:63], a[40:43], a[184:187], v[60:63]
buffer_load_dwordx4 v6, s[12:15], s95 offen  lds
v_mfma_f32_16x16x32_bf16 v[144:147], a[40:43], a[196:199], v[144:147]
s_add_u32 m0, s82, 67584
ds_read_b64_tr_b16 a[12:13], v16 offset:32768
ds_read_b64_tr_b16 a[14:15], v16 offset:34816
v_mfma_f32_16x16x32_bf16 v[116:119], a[40:43], a[192:195], v[116:119]
s_mov_b32 s96, 4845568
v_and_b32 v43, 0xffff0000, v43
v_fmac_f32 v33, v42, v40
v_mfma_f32_16x16x32_bf16 v[88:91], a[40:43], a[188:191], v[88:91]
ds_read_b64_tr_b16 a[16:17], v17 offset:32768
v_fmac_f32 v33, v43, v41
v_mfma_f32_16x16x32_bf16 v[92:95], a[44:47], a[188:191], v[92:95]
ds_read_b64_tr_b16 a[18:19], v17 offset:34816
v_accvgpr_read_b32 v41, a248
v_mfma_f32_16x16x32_bf16 v[120:123], a[44:47], a[192:195], v[120:123]
buffer_load_dwordx4 v6, s[12:15], s96 offen  lds
v_mfma_f32_16x16x32_bf16 v[148:151], a[44:47], a[196:199], v[148:151]
s_add_u32 m0, s82, 73728
ds_read_b64_tr_b16 a[20:21], v18 offset:32768
s_mov_b32 s97, 4931584
v_mfma_f32_16x16x32_bf16 v[64:67], a[44:47], a[184:187], v[64:67]
ds_read_b64_tr_b16 a[22:23], v18 offset:34816
v_lshlrev_b32 v40, 16, v41
v_mfma_f32_16x16x32_bf16 v[68:71], a[48:51], a[184:187], v[68:71]
v_and_b32 v41, 0xffff0000, v41
v_accvgpr_read_b32 v43, a232
v_mfma_f32_16x16x32_bf16 v[152:155], a[48:51], a[196:199], v[152:155]
ds_read_b128 a[112:115], v7 offset:4096
v_lshlrev_b32 v42, 16, v43
v_mfma_f32_16x16x32_bf16 v[124:127], a[48:51], a[192:195], v[124:127]
ds_read_b64_tr_b16 a[24:25], v19 offset:32768
v_and_b32 v43, 0xffff0000, v43
v_mfma_f32_16x16x32_bf16 v[96:99], a[48:51], a[188:191], v[96:99]
buffer_load_dwordx4 v6, s[12:15], s97 offen  lds
v_mfma_f32_16x16x32_bf16 v[100:103], a[52:55], a[188:191], v[100:103]
s_add_u32 m0, s82, 75776
ds_read_b64_tr_b16 a[26:27], v19 offset:34816
s_mov_b32 s93, 4960256
v_mfma_f32_16x16x32_bf16 v[128:131], a[52:55], a[192:195], v[128:131]
s_nop 0
ds_read_b64_tr_b16 a[64:65], v9 offset:24704
v_fmac_f32 v32, v42, v40
v_mfma_f32_16x16x32_bf16 v[156:159], a[52:55], a[196:199], v[156:159]
v_fmac_f32 v32, v43, v41
v_accvgpr_read_b32 v43, a240
v_mfma_f32_16x16x32_bf16 v[72:75], a[52:55], a[184:187], v[72:75]
ds_read_b64_tr_b16 a[66:67], v9 offset:26240
v_lshlrev_b32 v42, 16, v43
v_mfma_f32_16x16x32_bf16 v[160:163], a[120:123], a[88:91], v[160:163]
buffer_load_dwordx4 v6, s[12:15], s93 offen  lds
v_mfma_f32_16x16x32_bf16 v[164:167], a[124:127], a[88:91], v[164:167]
s_mov_b32 s94, 3342336
ds_read_b64_tr_b16 a[68:69], v10 offset:24704
s_add_u32 m0, s81, 126976
v_mfma_f32_16x16x32_bf16 v[176:179], a[128:131], a[88:91], v[176:179]
ds_read_b64_tr_b16 a[70:71], v10 offset:26240
v_and_b32 v43, 0xffff0000, v43
v_mfma_f32_16x16x32_bf16 v[180:183], a[132:135], a[88:91], v[180:183]
ds_read_b128 a[116:119], v7 offset:6144
v_fmac_f32 v33, v42, v40
v_mfma_f32_16x16x32_bf16 v[188:191], a[132:135], a[92:95], v[188:191]
v_fmac_f32 v33, v43, v41
v_accvgpr_read_b32 v41, a249
v_mfma_f32_16x16x32_bf16 v[184:187], a[128:131], a[92:95], v[184:187]
s_nop 0
ds_read_b64_tr_b16 a[72:73], v9 offset:24832
v_lshlrev_b32 v40, 16, v41
v_mfma_f32_16x16x32_bf16 v[172:175], a[124:127], a[92:95], v[172:175]
buffer_load_dwordx4 v3, s[8:11], s94 offen  lds
v_mfma_f32_16x16x32_bf16 v[168:171], a[120:123], a[92:95], v[168:171]
s_add_u32 m0, s81, 128000
ds_read_b64_tr_b16 a[74:75], v9 offset:26368
v_and_b32 v41, 0xffff0000, v41
v_mfma_f32_16x16x32_bf16 v[192:195], a[120:123], a[96:99], v[192:195]
ds_read_b64_tr_b16 a[76:77], v10 offset:24832
v_accvgpr_read_b32 v43, a233
v_mfma_f32_16x16x32_bf16 v[196:199], a[124:127], a[96:99], v[196:199]
ds_read_b64_tr_b16 a[78:79], v10 offset:26368
v_lshlrev_b32 v42, 16, v43
v_mfma_f32_16x16x32_bf16 v[208:211], a[128:131], a[96:99], v[208:211]
v_and_b32 v43, 0xffff0000, v43
v_fmac_f32 v32, v42, v40
v_mfma_f32_16x16x32_bf16 v[212:215], a[132:135], a[96:99], v[212:215]
buffer_load_dwordx4 v4, s[8:11], s94 offen  lds
v_mfma_f32_16x16x32_bf16 v[220:223], a[132:135], a[100:103], v[220:223]
s_add_u32 m0, s81, 129024
ds_read_b64_tr_b16 a[56:57], v9 offset:24576
ds_read_b64_tr_b16 a[58:59], v9 offset:26112
v_mfma_f32_16x16x32_bf16 v[216:219], a[128:131], a[100:103], v[216:219]
v_fmac_f32 v32, v43, v41
v_accvgpr_read_b32 v43, a241
v_mfma_f32_16x16x32_bf16 v[204:207], a[124:127], a[100:103], v[204:207]
ds_read_b64_tr_b16 a[60:61], v10 offset:24576
v_lshlrev_b32 v42, 16, v43
v_mfma_f32_16x16x32_bf16 v[200:203], a[120:123], a[100:103], v[200:203]
v_and_b32 v43, 0xffff0000, v43
v_fmac_f32 v33, v42, v40
v_mfma_f32_16x16x32_bf16 v[224:227], a[80:83], a[120:123], v[224:227]
ds_read_b64_tr_b16 a[62:63], v10 offset:26112
v_fmac_f32 v33, v43, v41
v_mfma_f32_16x16x32_bf16 v[232:235], a[80:83], a[124:127], v[232:235]
buffer_load_dwordx4 v5, s[8:11], s94 offen  lds
v_mfma_f32_16x16x32_bf16 v[240:243], a[80:83], a[128:131], v[240:243]
v_accvgpr_read_b32 v41, a250
v_lshlrev_b32 v40, 16, v41
v_mfma_f32_16x16x32_bf16 v[248:251], a[80:83], a[132:135], v[248:251]
v_and_b32 v41, 0xffff0000, v41
v_accvgpr_read_b32 v43, a234
v_mfma_f32_16x16x32_bf16 v[252:255], a[84:87], a[132:135], v[252:255]
Lpad4:
s_cbranch_execz Lpad8
s_nop 0
v_lshlrev_b32 v42, 16, v43
v_and_b32 v43, 0xffff0000, v43
v_mfma_f32_16x16x32_bf16 v[244:247], a[84:87], a[128:131], v[244:247]
v_fmac_f32 v32, v42, v40
v_fmac_f32 v32, v43, v41
v_mfma_f32_16x16x32_bf16 v[236:239], a[84:87], a[124:127], v[236:239]
s_waitcnt vmcnt(22) lgkmcnt(0)
v_accvgpr_read_b32 v43, a242
v_lshlrev_b32 v42, 16, v43
v_mfma_f32_16x16x32_bf16 v[228:231], a[84:87], a[120:123], v[228:231]
s_barrier
v_and_b32 v43, 0xffff0000, v43
v_fmac_f32 v33, v42, v40
v_mfma_f32_16x16x32_bf16 v[76:79], a[0:3], a[108:111], v[76:79]
s_add_u32 m0, s73, 40960
ds_read_b128 a[120:123], v8 offset:0
s_mov_b32 s95, 132480
v_mfma_f32_16x16x32_bf16 v[104:107], a[0:3], a[112:115], v[104:107]
buffer_load_dwordx4 v2, s[4:7], s95 offen  lds
v_mfma_f32_16x16x32_bf16 v[132:135], a[0:3], a[116:119], v[132:135]
s_add_u32 m0, s73, 45056
ds_read_b64_tr_b16 a[28:29], v13 offset:49152
s_mov_b32 s96, 198016
v_mfma_f32_16x16x32_bf16 v[48:51], a[0:3], a[104:107], v[48:51]
s_cmp_eq_u32 s99, 5
s_cselect_b32 s92, 0, s100
ds_read_b64_tr_b16 a[30:31], v13 offset:51200
s_add_u32 s3, s92, s70
v_mfma_f32_16x16x32_bf16 v[52:55], a[4:7], a[104:107], v[52:55]
buffer_load_dword a255, v11, s[20:23], s3 offen
v_mfma_f32_16x16x32_bf16 v[136:139], a[4:7], a[116:119], v[136:139]
s_cmp_eq_u32 s99, 6
s_cselect_b32 s92, 0, s100
ds_read_b64_tr_b16 a[32:33], v14 offset:49152
s_add_u32 s3, s92, s70
v_mfma_f32_16x16x32_bf16 v[108:111], a[4:7], a[112:115], v[108:111]
buffer_load_dwordx4 v2, s[4:7], s96 offen  lds
v_mfma_f32_16x16x32_bf16 v[80:83], a[4:7], a[108:111], v[80:83]
s_add_u32 m0, s82, 81920
ds_read_b64_tr_b16 a[34:35], v14 offset:51200
ds_read_b64_tr_b16 a[36:37], v15 offset:49152
v_mfma_f32_16x16x32_bf16 v[84:87], a[8:11], a[108:111], v[84:87]
buffer_load_dword a255, v11, s[20:23], s3 offen
v_mfma_f32_16x16x32_bf16 v[112:115], a[8:11], a[112:115], v[112:115]
s_mov_b32 s97, 5046272
ds_read_b64_tr_b16 a[38:39], v15 offset:51200
v_fmac_f32 v33, v43, v41
v_mfma_f32_16x16x32_bf16 v[140:143], a[8:11], a[116:119], v[140:143]
ds_read_b128 a[124:127], v8 offset:2048
v_accvgpr_read_b32 v41, a251
v_mfma_f32_16x16x32_bf16 v[56:59], a[8:11], a[104:107], v[56:59]
v_lshlrev_b32 v40, 16, v41
v_and_b32 v41, 0xffff0000, v41
v_mfma_f32_16x16x32_bf16 v[60:63], a[12:15], a[104:107], v[60:63]
buffer_load_dwordx4 v6, s[12:15], s97 offen  lds
v_mfma_f32_16x16x32_bf16 v[144:147], a[12:15], a[116:119], v[144:147]
s_add_u32 m0, s82, 83968
ds_read_b64_tr_b16 a[40:41], v16 offset:49152
ds_read_b64_tr_b16 a[42:43], v16 offset:51200
v_mfma_f32_16x16x32_bf16 v[116:119], a[12:15], a[112:115], v[116:119]
s_mov_b32 s93, 5074944
v_accvgpr_read_b32 v43, a235
v_lshlrev_b32 v42, 16, v43
v_mfma_f32_16x16x32_bf16 v[88:91], a[12:15], a[108:111], v[88:91]
ds_read_b64_tr_b16 a[44:45], v17 offset:49152
v_and_b32 v43, 0xffff0000, v43
v_mfma_f32_16x16x32_bf16 v[92:95], a[16:19], a[108:111], v[92:95]
ds_read_b64_tr_b16 a[46:47], v17 offset:51200
v_fmac_f32 v32, v42, v40
v_mfma_f32_16x16x32_bf16 v[120:123], a[16:19], a[112:115], v[120:123]
buffer_load_dwordx4 v6, s[12:15], s93 offen  lds
v_mfma_f32_16x16x32_bf16 v[148:151], a[16:19], a[116:119], v[148:151]
s_add_u32 m0, s82, 90112
ds_read_b64_tr_b16 a[48:49], v18 offset:49152
s_mov_b32 s94, 5160960
v_mfma_f32_16x16x32_bf16 v[64:67], a[16:19], a[104:107], v[64:67]
s_nop 0
ds_read_b64_tr_b16 a[50:51], v18 offset:51200
v_fmac_f32 v32, v43, v41
v_mfma_f32_16x16x32_bf16 v[68:71], a[20:23], a[104:107], v[68:71]
v_accvgpr_read_b32 v43, a243
v_lshlrev_b32 v42, 16, v43
v_mfma_f32_16x16x32_bf16 v[152:155], a[20:23], a[116:119], v[152:155]
ds_read_b128 a[128:131], v8 offset:4096
v_and_b32 v43, 0xffff0000, v43
v_mfma_f32_16x16x32_bf16 v[124:127], a[20:23], a[112:115], v[124:127]
ds_read_b64_tr_b16 a[52:53], v19 offset:49152
v_fmac_f32 v33, v42, v40
v_mfma_f32_16x16x32_bf16 v[96:99], a[20:23], a[108:111], v[96:99]
buffer_load_dwordx4 v6, s[12:15], s94 offen  lds
v_mfma_f32_16x16x32_bf16 v[100:103], a[24:27], a[108:111], v[100:103]
s_add_u32 m0, s82, 92160
ds_read_b64_tr_b16 a[54:55], v19 offset:51200
s_mov_b32 s95, 5189632
v_mfma_f32_16x16x32_bf16 v[128:131], a[24:27], a[112:115], v[128:131]
ds_read_b64_tr_b16 a[88:89], v9 offset:36992
v_fmac_f32 v33, v43, v41
v_mfma_f32_16x16x32_bf16 v[156:159], a[24:27], a[116:119], v[156:159]
v_mfma_f32_16x16x32_bf16 v[72:75], a[24:27], a[104:107], v[72:75]
s_nop 0
ds_read_b64_tr_b16 a[90:91], v9 offset:38528
v_add_f32_dpp v32, v32, v32 row_ror:8 row_mask:0xf bank_mask:0xf
v_mfma_f32_16x16x32_bf16 v[160:163], a[136:139], a[64:67], v[160:163]
buffer_load_dwordx4 v6, s[12:15], s95 offen  lds
v_mfma_f32_16x16x32_bf16 v[164:167], a[140:143], a[64:67], v[164:167]
s_mov_b32 s96, 3538944
ds_read_b64_tr_b16 a[92:93], v10 offset:36992
s_add_u32 m0, s81, 139264
v_mfma_f32_16x16x32_bf16 v[176:179], a[144:147], a[64:67], v[176:179]
ds_read_b64_tr_b16 a[94:95], v10 offset:38528
v_add_f32_dpp v33, v33, v33 row_ror:8 row_mask:0xf bank_mask:0xf
v_mfma_f32_16x16x32_bf16 v[180:183], a[148:151], a[64:67], v[180:183]
ds_read_b128 a[132:135], v8 offset:6144
v_add_f32_dpp v32, v32, v32 row_ror:4 row_mask:0xf bank_mask:0xf
v_mfma_f32_16x16x32_bf16 v[188:191], a[148:151], a[68:71], v[188:191]
v_add_f32_dpp v33, v33, v33 row_ror:4 row_mask:0xf bank_mask:0xf
v_add_f32_dpp v32, v32, v32 row_ror:2 row_mask:0xf bank_mask:0xf
v_mfma_f32_16x16x32_bf16 v[184:187], a[144:147], a[68:71], v[184:187]
ds_read_b64_tr_b16 a[96:97], v9 offset:37120
v_add_f32_dpp v33, v33, v33 row_ror:2 row_mask:0xf bank_mask:0xf
v_mfma_f32_16x16x32_bf16 v[172:175], a[140:143], a[68:71], v[172:175]
buffer_load_dwordx4 v3, s[8:11], s96 offen  lds
v_mfma_f32_16x16x32_bf16 v[168:171], a[136:139], a[68:71], v[168:171]
s_add_u32 m0, s81, 140288
ds_read_b64_tr_b16 a[98:99], v9 offset:38656
v_add_f32_dpp v32, v32, v32 row_ror:1 row_mask:0xf bank_mask:0xf
v_mfma_f32_16x16x32_bf16 v[192:195], a[136:139], a[72:75], v[192:195]
s_nop 0
ds_read_b64_tr_b16 a[100:101], v10 offset:37120
v_add_f32_dpp v33, v33, v33 row_ror:1 row_mask:0xf bank_mask:0xf
v_mfma_f32_16x16x32_bf16 v[196:199], a[140:143], a[72:75], v[196:199]
ds_read_b64_tr_b16 a[102:103], v10 offset:38656
v_mov_b32 v40, v32
v_mfma_f32_16x16x32_bf16 v[208:211], a[144:147], a[72:75], v[208:211]
v_mov_b32 v41, v33
v_permlane16_swap_b32 v32, v40
v_mfma_f32_16x16x32_bf16 v[212:215], a[148:151], a[72:75], v[212:215]
buffer_load_dwordx4 v4, s[8:11], s96 offen  lds
v_mfma_f32_16x16x32_bf16 v[220:223], a[148:151], a[76:79], v[220:223]
s_add_u32 m0, s81, 141312
ds_read_b64_tr_b16 a[80:81], v9 offset:36864
ds_read_b64_tr_b16 a[82:83], v9 offset:38400
v_mfma_f32_16x16x32_bf16 v[216:219], a[144:147], a[76:79], v[216:219]
v_permlane16_swap_b32 v33, v41
v_add_f32 v32, v32, v40
v_mfma_f32_16x16x32_bf16 v[204:207], a[140:143], a[76:79], v[204:207]
ds_read_b64_tr_b16 a[84:85], v10 offset:36864
v_add_f32 v33, v33, v41
v_mfma_f32_16x16x32_bf16 v[200:203], a[136:139], a[76:79], v[200:203]
v_mov_b32 v40, v32
v_mov_b32 v41, v33
v_mfma_f32_16x16x32_bf16 v[224:227], a[56:59], a[136:139], v[224:227]
ds_read_b64_tr_b16 a[86:87], v10 offset:38400
v_permlane32_swap_b32 v32, v40
v_mfma_f32_16x16x32_bf16 v[232:235], a[56:59], a[140:143], v[232:235]
buffer_load_dwordx4 v5, s[8:11], s96 offen  lds
v_mfma_f32_16x16x32_bf16 v[240:243], a[56:59], a[144:147], v[240:243]
v_permlane32_swap_b32 v33, v41
v_add_f32 v32, v32, v40
v_mfma_f32_16x16x32_bf16 v[248:251], a[56:59], a[148:151], v[248:251]
v_add_f32 v33, v33, v41
v_cvt_pk_bf16_f32 v40, v32, v33
v_mfma_f32_16x16x32_bf16 v[252:255], a[60:63], a[148:151], v[252:255]
v_lshlrev_b32 v32, 16, v40
v_and_b32 v33, 0xffff0000, v40
v_mfma_f32_16x16x32_bf16 v[244:247], a[60:63], a[144:147], v[244:247]
s_nop 0
v_mul_f32_e64 v32, -v32, s90
v_mul_f32_e64 v33, -v33, s90
v_mfma_f32_16x16x32_bf16 v[236:239], a[60:63], a[140:143], v[236:239]
s_waitcnt vmcnt(21) lgkmcnt(0)
v_exp_f32 v32, v32
v_mfma_f32_16x16x32_bf16 v[228:231], a[60:63], a[136:139], v[228:231]
s_barrier
v_exp_f32 v33, v33
v_mfma_f32_16x16x32_bf16 v[76:79], a[28:31], a[124:127], v[76:79]
s_add_u32 m0, s73, 0
ds_read_b128 a[136:139], v7 offset:16384
s_mov_b32 s97, 1536
v_mfma_f32_16x16x32_bf16 v[104:107], a[28:31], a[128:131], v[104:107]
buffer_load_dwordx4 v2, s[4:7], s97 offen  lds
v_mfma_f32_16x16x32_bf16 v[132:135], a[28:31], a[132:135], v[132:135]
s_add_u32 m0, s73, 4096
ds_read_b64_tr_b16 a[0:1], v13 offset:0
s_mov_b32 s93, 67072
v_mfma_f32_16x16x32_bf16 v[48:51], a[28:31], a[120:123], v[48:51]
s_cmp_eq_u32 s99, 7
s_cselect_b32 s92, 0, s100
ds_read_b64_tr_b16 a[2:3], v13 offset:2048
s_add_u32 s3, s92, s70
v_mfma_f32_16x16x32_bf16 v[52:55], a[32:35], a[120:123], v[52:55]
buffer_load_dword a255, v11, s[20:23], s3 offen
v_mfma_f32_16x16x32_bf16 v[136:139], a[32:35], a[132:135], v[136:139]
ds_read_b64_tr_b16 a[4:5], v14 offset:0
v_add_f32 v32, 1.0, v32
v_mfma_f32_16x16x32_bf16 v[108:111], a[32:35], a[128:131], v[108:111]
buffer_load_dwordx4 v2, s[4:7], s93 offen  lds
v_mfma_f32_16x16x32_bf16 v[80:83], a[32:35], a[124:127], v[80:83]
s_add_u32 m0, s82, 98304
ds_read_b64_tr_b16 a[6:7], v14 offset:2048
ds_read_b64_tr_b16 a[8:9], v15 offset:0
v_mfma_f32_16x16x32_bf16 v[84:87], a[36:39], a[124:127], v[84:87]
s_mov_b32 s94, 5275648
v_rcp_f32 v32, v32
v_mfma_f32_16x16x32_bf16 v[112:115], a[36:39], a[128:131], v[112:115]
s_nop 0
ds_read_b64_tr_b16 a[10:11], v15 offset:2048
v_add_f32 v33, 1.0, v33
v_mfma_f32_16x16x32_bf16 v[140:143], a[36:39], a[132:135], v[140:143]
ds_read_b128 a[140:143], v7 offset:18432
v_bfe_u32 v42, v0, 1, 3
v_mfma_f32_16x16x32_bf16 v[56:59], a[36:39], a[120:123], v[56:59]
v_rcp_f32 v33, v33
v_mfma_f32_16x16x32_bf16 v[60:63], a[40:43], a[120:123], v[60:63]
buffer_load_dwordx4 v6, s[12:15], s94 offen  lds
v_mfma_f32_16x16x32_bf16 v[144:147], a[40:43], a[132:135], v[144:147]
s_add_u32 m0, s82, 100352
ds_read_b64_tr_b16 a[12:13], v16 offset:0
ds_read_b64_tr_b16 a[14:15], v16 offset:2048
v_mfma_f32_16x16x32_bf16 v[116:119], a[40:43], a[128:131], v[116:119]
s_mov_b32 s95, 5304320
v_cvt_pk_bf16_f32 v40, v32, v33
v_lshlrev_b32 v32, 16, v40
v_mfma_f32_16x16x32_bf16 v[88:91], a[40:43], a[124:127], v[88:91]
ds_read_b64_tr_b16 a[16:17], v17 offset:0
v_and_b32 v33, 0xffff0000, v40
v_mfma_f32_16x16x32_bf16 v[92:95], a[44:47], a[124:127], v[92:95]
ds_read_b64_tr_b16 a[18:19], v17 offset:2048
v_lshrrev_b32 v40, 4, v0
v_mfma_f32_16x16x32_bf16 v[120:123], a[44:47], a[128:131], v[120:123]
buffer_load_dwordx4 v6, s[12:15], s95 offen  lds
v_mfma_f32_16x16x32_bf16 v[148:151], a[44:47], a[132:135], v[148:151]
buffer_store_dword v32, v27, s[24:27], s50 offen offset:0 sc1
v_mfma_f32_16x16x32_bf16 v[64:67], a[44:47], a[120:123], v[64:67]
s_add_u32 m0, s82, 106496
ds_read_b64_tr_b16 a[20:21], v18 offset:0
ds_read_b64_tr_b16 a[22:23], v18 offset:2048
v_mfma_f32_16x16x32_bf16 v[68:71], a[48:51], a[120:123], v[68:71]
buffer_store_dword v33, v27, s[24:27], s50 offen offset:16 sc1
v_mfma_f32_16x16x32_bf16 v[152:155], a[48:51], a[132:135], v[152:155]
s_mov_b32 s96, 5390336
ds_read_b128 a[144:147], v7 offset:20480
s_mul_i32 s48, s76, 3670016
v_mfma_f32_16x16x32_bf16 v[124:127], a[48:51], a[128:131], v[124:127]
s_mul_i32 s49, s76, 57344
ds_read_b64_tr_b16 a[24:25], v19 offset:0
s_lshl_b32 s50, s80, 2
v_mfma_f32_16x16x32_bf16 v[96:99], a[48:51], a[124:127], v[96:99]
buffer_load_dwordx4 v6, s[12:15], s96 offen  lds
v_mfma_f32_16x16x32_bf16 v[100:103], a[52:55], a[124:127], v[100:103]
s_add_u32 m0, s82, 108544
ds_read_b64_tr_b16 a[26:27], v19 offset:2048
s_mov_b32 s97, 5419008
v_mfma_f32_16x16x32_bf16 v[128:131], a[52:55], a[128:131], v[128:131]
ds_read_b64_tr_b16 a[64:65], v9 offset:128
v_add_u32 v41, s50, v40
v_mfma_f32_16x16x32_bf16 v[156:159], a[52:55], a[132:135], v[156:159]
v_xor_b32 v41, v41, v42
v_lshlrev_b32 v41, 5, v41
v_mfma_f32_16x16x32_bf16 v[72:75], a[52:55], a[120:123], v[72:75]
s_nop 0
ds_read_b64_tr_b16 a[66:67], v9 offset:1664
v_and_b32 v42, 1, v0
v_mfma_f32_16x16x32_bf16 v[160:163], a[152:155], a[88:91], v[160:163]
buffer_load_dwordx4 v6, s[12:15], s97 offen  lds
v_mfma_f32_16x16x32_bf16 v[164:167], a[156:159], a[88:91], v[164:167]
s_mov_b32 s93, 3735552
ds_read_b64_tr_b16 a[68:69], v10 offset:128
s_add_u32 m0, s81, 151552
v_mfma_f32_16x16x32_bf16 v[176:179], a[160:163], a[88:91], v[176:179]
ds_read_b64_tr_b16 a[70:71], v10 offset:1664
v_lshl_add_u32 v41, v42, 4, v41
v_mfma_f32_16x16x32_bf16 v[180:183], a[164:167], a[88:91], v[180:183]
ds_read_b128 a[148:151], v7 offset:22528
v_lshl_add_u32 v41, v40, 11, v41
v_mfma_f32_16x16x32_bf16 v[188:191], a[164:167], a[92:95], v[188:191]
s_lshl_b32 s50, s82, 3
s_lshl_b32 s51, s78, 8
s_add_u32 s50, s50, s51
v_mfma_f32_16x16x32_bf16 v[184:187], a[160:163], a[92:95], v[184:187]
ds_read_b64_tr_b16 a[72:73], v9 offset:256
v_add_u32 v34, s50, v41
v_mfma_f32_16x16x32_bf16 v[172:175], a[156:159], a[92:95], v[172:175]
buffer_load_dwordx4 v3, s[8:11], s93 offen  lds
v_mfma_f32_16x16x32_bf16 v[168:171], a[152:155], a[92:95], v[168:171]
s_add_u32 m0, s81, 152576
ds_read_b64_tr_b16 a[74:75], v9 offset:1792
v_add_u32 v35, 16384, v34
v_mfma_f32_16x16x32_bf16 v[192:195], a[152:155], a[96:99], v[192:195]
s_lshl_b32 s50, s74, 3
ds_read_b64_tr_b16 a[76:77], v10 offset:256
s_lshl_b32 s51, s79, 2
v_mfma_f32_16x16x32_bf16 v[196:199], a[156:159], a[96:99], v[196:199]
s_add_u32 s50, s50, s51
ds_read_b64_tr_b16 a[78:79], v10 offset:1792
s_mul_i32 s50, s50, 147456
v_mfma_f32_16x16x32_bf16 v[208:211], a[160:163], a[96:99], v[208:211]
s_nop 0
v_add_u32 v36, s50, v1
s_mul_i32 s50, s75, 7168
v_mfma_f32_16x16x32_bf16 v[212:215], a[164:167], a[96:99], v[212:215]
buffer_load_dwordx4 v4, s[8:11], s93 offen  lds
v_mfma_f32_16x16x32_bf16 v[220:223], a[164:167], a[100:103], v[220:223]
s_add_u32 m0, s81, 153600
ds_read_b64_tr_b16 a[56:57], v9 offset:0
ds_read_b64_tr_b16 a[58:59], v9 offset:1536
v_mfma_f32_16x16x32_bf16 v[216:219], a[160:163], a[100:103], v[216:219]
s_lshl_b32 s51, s80, 12
s_add_u32 s51, s51, s50
v_add_u32 v32, s51, v36
v_mfma_f32_16x16x32_bf16 v[204:207], a[156:159], a[100:103], v[204:207]
s_mul_i32 s51, s80, 294912
ds_read_b64_tr_b16 a[60:61], v10 offset:0
s_add_u32 s51, s51, s50
v_mfma_f32_16x16x32_bf16 v[200:203], a[152:155], a[100:103], v[200:203]
s_add_u32 s51, s51, 3072
v_add_u32 v33, s51, v36
s_lshl_b32 s51, s83, 10
v_mfma_f32_16x16x32_bf16 v[224:227], a[80:83], a[152:155], v[224:227]
s_add_u32 s51, s51, 114688
ds_read_b64_tr_b16 a[62:63], v10 offset:1536
v_add_u32 v36, s51, v36
v_mfma_f32_16x16x32_bf16 v[232:235], a[80:83], a[156:159], v[232:235]
buffer_load_dwordx4 v5, s[8:11], s93 offen  lds
v_mfma_f32_16x16x32_bf16 v[240:243], a[80:83], a[160:163], v[240:243]
s_mov_b32 s36, 147456
s_mov_b32 s37, 294912
s_mov_b32 s38, 442368
v_mfma_f32_16x16x32_bf16 v[248:251], a[80:83], a[164:167], v[248:251]
s_mov_b32 s46, 32505856
s_lshl_b32 s50, s83, 4
s_add_u32 s50, s50, s74
v_mfma_f32_16x16x32_bf16 v[252:255], a[84:87], a[164:167], v[252:255]
s_mul_i32 s52, s50, 5120
s_add_u32 s52, s52, 27262976
s_add_u32 s53, s52, 4096
v_mfma_f32_16x16x32_bf16 v[244:247], a[84:87], a[160:163], v[244:247]
s_lshl_b32 s50, s79, 11
s_add_u32 s52, s52, s50
s_mul_i32 s54, s83, 5120
v_mfma_f32_16x16x32_bf16 v[236:239], a[84:87], a[156:159], v[236:239]
s_waitcnt vmcnt(23) lgkmcnt(0)
s_add_u32 s54, s54, 31457280
s_add_u32 s55, s54, 4096
v_mfma_f32_16x16x32_bf16 v[228:231], a[84:87], a[152:155], v[228:231]
s_barrier
s_lshl_b32 s50, s84, 7
s_add_u32 s56, s54, s50
Lu20:
v_mfma_f32_16x16x32_bf16 v[76:79], a[0:3], a[140:143], v[76:79]
s_add_u32 m0, s73, 8192
ds_read_b128 a[152:155], v8 offset:16384
s_mov_b32 s94, 132608
v_mfma_f32_16x16x32_bf16 v[104:107], a[0:3], a[144:147], v[104:107]
buffer_load_dwordx4 v2, s[4:7], s94 offen  lds
v_mfma_f32_16x16x32_bf16 v[132:135], a[0:3], a[148:151], v[132:135]
s_add_u32 m0, s73, 12288
ds_read_b64_tr_b16 a[28:29], v13 offset:16384
s_mov_b32 s95, 198144
v_mfma_f32_16x16x32_bf16 v[48:51], a[0:3], a[136:139], v[48:51]
s_lshl_b32 s50, s78, 8
ds_read_b64_tr_b16 a[30:31], v13 offset:18432
v_lshrrev_b32 v28, 3, v0
v_mfma_f32_16x16x32_bf16 v[52:55], a[4:7], a[136:139], v[52:55]
s_lshl_b32 s51, s76, 7
ds_read_b64_tr_b16 a[32:33], v14 offset:16384
v_lshlrev_b32 v28, 4, v28
v_mfma_f32_16x16x32_bf16 v[136:139], a[4:7], a[148:151], v[136:139]
s_add_u32 s39, s50, s51
v_and_or_b32 v28, v0, 7, v28
v_lshlrev_b32 v28, 7, v28
v_mfma_f32_16x16x32_bf16 v[108:111], a[4:7], a[144:147], v[108:111]
buffer_load_dwordx4 v2, s[4:7], s95 offen  lds
v_mfma_f32_16x16x32_bf16 v[80:83], a[4:7], a[140:143], v[80:83]
s_add_u32 m0, s82, 49152
ds_read_b64_tr_b16 a[34:35], v14 offset:18432
ds_read_b64_tr_b16 a[36:37], v15 offset:16384
v_mfma_f32_16x16x32_bf16 v[84:87], a[8:11], a[140:143], v[84:87]
s_mov_b32 s96, 5505024
v_cmp_gt_u32 vcc, 56, v0
s_lshl_b32 s50, s79, 12
v_mfma_f32_16x16x32_bf16 v[112:115], a[8:11], a[144:147], v[112:115]
s_add_u32 s50, s50, 139264
ds_read_b64_tr_b16 a[38:39], v15 offset:18432
v_cndmask_b32 v28, v47, v28, vcc
v_mfma_f32_16x16x32_bf16 v[140:143], a[8:11], a[148:151], v[140:143]
s_cmp_eq_u32 s99, 0
s_cselect_b32 s92, 0, s100
ds_read_b128 a[156:159], v8 offset:18432
s_add_u32 s3, s92, s71
v_mfma_f32_16x16x32_bf16 v[56:59], a[8:11], a[136:139], v[56:59]
s_lshl_b32 s51, s80, 3
s_add_u32 s51, s51, s50
v_add_u32 v40, s51, v1
v_mfma_f32_16x16x32_bf16 v[60:63], a[12:15], a[136:139], v[60:63]
buffer_load_dwordx4 v6, s[12:15], s96 offen  lds
v_mfma_f32_16x16x32_bf16 v[144:147], a[12:15], a[148:151], v[144:147]
s_add_u32 m0, s82, 51200
ds_read_b64_tr_b16 a[40:41], v16 offset:16384
ds_read_b64_tr_b16 a[42:43], v16 offset:18432
v_mfma_f32_16x16x32_bf16 v[116:119], a[12:15], a[144:147], v[116:119]
buffer_load_dword a255, v28, s[16:19], s3 offen
v_mfma_f32_16x16x32_bf16 v[88:91], a[12:15], a[140:143], v[88:91]
s_mov_b32 s97, 5533696
ds_read_b64_tr_b16 a[44:45], v17 offset:16384
s_lshl_b32 s51, s80, 11
v_mfma_f32_16x16x32_bf16 v[92:95], a[16:19], a[140:143], v[92:95]
s_add_u32 s51, s51, s50
ds_read_b64_tr_b16 a[46:47], v17 offset:18432
v_add_u32 v41, s51, v1
v_mfma_f32_16x16x32_bf16 v[120:123], a[16:19], a[144:147], v[120:123]
buffer_load_dwordx4 v6, s[12:15], s97 offen  lds
v_mfma_f32_16x16x32_bf16 v[148:151], a[16:19], a[148:151], v[148:151]
s_add_u32 m0, s82, 57344
ds_read_b64_tr_b16 a[48:49], v18 offset:16384
s_mov_b32 s93, 5619712
v_mfma_f32_16x16x32_bf16 v[64:67], a[16:19], a[136:139], v[64:67]
ds_read_b64_tr_b16 a[50:51], v18 offset:18432
v_mfma_f32_16x16x32_bf16 v[68:71], a[20:23], a[136:139], v[68:71]
v_mfma_f32_16x16x32_bf16 v[152:155], a[20:23], a[148:151], v[152:155]
ds_read_b128 a[160:163], v8 offset:20480
v_mfma_f32_16x16x32_bf16 v[124:127], a[20:23], a[144:147], v[124:127]
ds_read_b64_tr_b16 a[52:53], v19 offset:16384
v_mfma_f32_16x16x32_bf16 v[96:99], a[20:23], a[140:143], v[96:99]
buffer_load_dwordx4 v6, s[12:15], s93 offen  lds
v_mfma_f32_16x16x32_bf16 v[100:103], a[24:27], a[140:143], v[100:103]
s_add_u32 m0, s82, 59392
ds_read_b64_tr_b16 a[54:55], v19 offset:18432
s_mov_b32 s94, 5648384
v_mfma_f32_16x16x32_bf16 v[128:131], a[24:27], a[144:147], v[128:131]
ds_read_b64_tr_b16 a[88:89], v9 offset:12416
v_mfma_f32_16x16x32_bf16 v[156:159], a[24:27], a[148:151], v[156:159]
v_mfma_f32_16x16x32_bf16 v[72:75], a[24:27], a[136:139], v[72:75]
ds_read_b64_tr_b16 a[90:91], v9 offset:13952
v_mfma_f32_16x16x32_bf16 v[160:163], a[168:171], a[64:67], v[160:163]
buffer_load_dwordx4 v6, s[12:15], s94 offen  lds
v_mfma_f32_16x16x32_bf16 v[164:167], a[172:175], a[64:67], v[164:167]
s_mov_b32 s95, 3932160
ds_read_b64_tr_b16 a[92:93], v10 offset:12416
s_add_u32 m0, s81, 114688
v_mfma_f32_16x16x32_bf16 v[176:179], a[176:179], a[64:67], v[176:179]
ds_read_b64_tr_b16 a[94:95], v10 offset:13952
v_mfma_f32_16x16x32_bf16 v[180:183], a[180:183], a[64:67], v[180:183]
ds_read_b128 a[164:167], v8 offset:22528
v_mfma_f32_16x16x32_bf16 v[188:191], a[180:183], a[68:71], v[188:191]
v_mfma_f32_16x16x32_bf16 v[184:187], a[176:179], a[68:71], v[184:187]
ds_read_b64_tr_b16 a[96:97], v9 offset:12544
v_mfma_f32_16x16x32_bf16 v[172:175], a[172:175], a[68:71], v[172:175]
buffer_load_dwordx4 v3, s[8:11], s95 offen  lds
v_mfma_f32_16x16x32_bf16 v[168:171], a[168:171], a[68:71], v[168:171]
s_add_u32 m0, s81, 115712
ds_read_b64_tr_b16 a[98:99], v9 offset:14080
v_mfma_f32_16x16x32_bf16 v[192:195], a[168:171], a[72:75], v[192:195]
ds_read_b64_tr_b16 a[100:101], v10 offset:12544
v_mfma_f32_16x16x32_bf16 v[196:199], a[172:175], a[72:75], v[196:199]
ds_read_b64_tr_b16 a[102:103], v10 offset:14080
v_mfma_f32_16x16x32_bf16 v[208:211], a[176:179], a[72:75], v[208:211]
v_mfma_f32_16x16x32_bf16 v[212:215], a[180:183], a[72:75], v[212:215]
buffer_load_dwordx4 v4, s[8:11], s95 offen  lds
v_mfma_f32_16x16x32_bf16 v[220:223], a[180:183], a[76:79], v[220:223]
s_add_u32 m0, s81, 116736
ds_read_b64_tr_b16 a[80:81], v9 offset:12288
ds_read_b64_tr_b16 a[82:83], v9 offset:13824
v_mfma_f32_16x16x32_bf16 v[216:219], a[176:179], a[76:79], v[216:219]
v_mfma_f32_16x16x32_bf16 v[204:207], a[172:175], a[76:79], v[204:207]
ds_read_b64_tr_b16 a[84:85], v10 offset:12288
v_mfma_f32_16x16x32_bf16 v[200:203], a[168:171], a[76:79], v[200:203]
v_mfma_f32_16x16x32_bf16 v[224:227], a[56:59], a[168:171], v[224:227]
ds_read_b64_tr_b16 a[86:87], v10 offset:13824
v_mfma_f32_16x16x32_bf16 v[232:235], a[56:59], a[172:175], v[232:235]
buffer_load_dwordx4 v5, s[8:11], s95 offen  lds
v_mfma_f32_16x16x32_bf16 v[240:243], a[56:59], a[176:179], v[240:243]
v_mfma_f32_16x16x32_bf16 v[248:251], a[56:59], a[180:183], v[248:251]
v_mfma_f32_16x16x32_bf16 v[252:255], a[60:63], a[180:183], v[252:255]
v_mfma_f32_16x16x32_bf16 v[244:247], a[60:63], a[176:179], v[244:247]
v_mfma_f32_16x16x32_bf16 v[236:239], a[60:63], a[172:175], v[236:239]
s_waitcnt vmcnt(22) lgkmcnt(0)
v_mfma_f32_16x16x32_bf16 v[228:231], a[60:63], a[168:171], v[228:231]
s_barrier
v_mfma_f32_16x16x32_bf16 v[76:79], a[28:31], a[156:159], v[76:79]
s_add_u32 m0, s73, 16384
ds_read_b128 a[168:171], v7 offset:32768
s_mov_b32 s96, 1664
v_mfma_f32_16x16x32_bf16 v[104:107], a[28:31], a[160:163], v[104:107]
buffer_load_dwordx4 v2, s[4:7], s96 offen  lds
v_mfma_f32_16x16x32_bf16 v[132:135], a[28:31], a[164:167], v[132:135]
s_add_u32 m0, s73, 20480
ds_read_b64_tr_b16 a[0:1], v13 offset:32768
s_mov_b32 s97, 67200
v_mfma_f32_16x16x32_bf16 v[48:51], a[28:31], a[152:155], v[48:51]
s_cmp_eq_u32 s99, 1
s_cselect_b32 s92, 0, s100
ds_read_b64_tr_b16 a[2:3], v13 offset:34816
s_add_u32 s3, s92, s71
v_mfma_f32_16x16x32_bf16 v[52:55], a[32:35], a[152:155], v[52:55]
buffer_load_dword a255, v28, s[16:19], s3 offen
v_mfma_f32_16x16x32_bf16 v[136:139], a[32:35], a[164:167], v[136:139]
s_nop 0
ds_read_b64_tr_b16 a[4:5], v14 offset:32768
v_mfma_f32_16x16x32_bf16 v[108:111], a[32:35], a[160:163], v[108:111]
buffer_load_dwordx4 v2, s[4:7], s97 offen  lds
v_mfma_f32_16x16x32_bf16 v[80:83], a[32:35], a[156:159], v[80:83]
s_add_u32 m0, s82, 65536
ds_read_b64_tr_b16 a[6:7], v14 offset:34816
ds_read_b64_tr_b16 a[8:9], v15 offset:32768
v_mfma_f32_16x16x32_bf16 v[84:87], a[36:39], a[156:159], v[84:87]
s_mov_b32 s93, 5734400
v_mfma_f32_16x16x32_bf16 v[112:115], a[36:39], a[160:163], v[112:115]
ds_read_b64_tr_b16 a[10:11], v15 offset:34816
v_mfma_f32_16x16x32_bf16 v[140:143], a[36:39], a[164:167], v[140:143]
ds_read_b128 a[172:175], v7 offset:34816
v_mfma_f32_16x16x32_bf16 v[56:59], a[36:39], a[152:155], v[56:59]
v_mfma_f32_16x16x32_bf16 v[60:63], a[40:43], a[152:155], v[60:63]
buffer_load_dwordx4 v6, s[12:15], s93 offen  lds
v_mfma_f32_16x16x32_bf16 v[144:147], a[40:43], a[164:167], v[144:147]
s_add_u32 m0, s82, 67584
ds_read_b64_tr_b16 a[12:13], v16 offset:32768
ds_read_b64_tr_b16 a[14:15], v16 offset:34816
v_mfma_f32_16x16x32_bf16 v[116:119], a[40:43], a[160:163], v[116:119]
s_mov_b32 s94, 5763072
v_mfma_f32_16x16x32_bf16 v[88:91], a[40:43], a[156:159], v[88:91]
ds_read_b64_tr_b16 a[16:17], v17 offset:32768
v_mfma_f32_16x16x32_bf16 v[92:95], a[44:47], a[156:159], v[92:95]
ds_read_b64_tr_b16 a[18:19], v17 offset:34816
v_mfma_f32_16x16x32_bf16 v[120:123], a[44:47], a[160:163], v[120:123]
buffer_load_dwordx4 v6, s[12:15], s94 offen  lds
v_mfma_f32_16x16x32_bf16 v[148:151], a[44:47], a[164:167], v[148:151]
s_add_u32 m0, s82, 73728
ds_read_b64_tr_b16 a[20:21], v18 offset:32768
s_mov_b32 s95, 5849088
v_mfma_f32_16x16x32_bf16 v[64:67], a[44:47], a[152:155], v[64:67]
ds_read_b64_tr_b16 a[22:23], v18 offset:34816
v_mfma_f32_16x16x32_bf16 v[68:71], a[48:51], a[152:155], v[68:71]
v_mfma_f32_16x16x32_bf16 v[152:155], a[48:51], a[164:167], v[152:155]
ds_read_b128 a[176:179], v7 offset:36864
v_mfma_f32_16x16x32_bf16 v[124:127], a[48:51], a[160:163], v[124:127]
ds_read_b64_tr_b16 a[24:25], v19 offset:32768
v_mfma_f32_16x16x32_bf16 v[96:99], a[48:51], a[156:159], v[96:99]
buffer_load_dwordx4 v6, s[12:15], s95 offen  lds
v_mfma_f32_16x16x32_bf16 v[100:103], a[52:55], a[156:159], v[100:103]
s_add_u32 m0, s82, 75776
ds_read_b64_tr_b16 a[26:27], v19 offset:34816
s_mov_b32 s96, 5877760
v_mfma_f32_16x16x32_bf16 v[128:131], a[52:55], a[160:163], v[128:131]
ds_read_b64_tr_b16 a[64:65], v9 offset:24704
v_mfma_f32_16x16x32_bf16 v[156:159], a[52:55], a[164:167], v[156:159]
v_mfma_f32_16x16x32_bf16 v[72:75], a[52:55], a[152:155], v[72:75]
ds_read_b64_tr_b16 a[66:67], v9 offset:26240
v_mfma_f32_16x16x32_bf16 v[160:163], a[184:187], a[88:91], v[160:163]
buffer_load_dwordx4 v6, s[12:15], s96 offen  lds
v_mfma_f32_16x16x32_bf16 v[164:167], a[188:191], a[88:91], v[164:167]
s_mov_b32 s97, 4128768
ds_read_b64_tr_b16 a[68:69], v10 offset:24704
s_add_u32 m0, s81, 126976
v_mfma_f32_16x16x32_bf16 v[176:179], a[192:195], a[88:91], v[176:179]
ds_read_b64_tr_b16 a[70:71], v10 offset:26240
v_mfma_f32_16x16x32_bf16 v[180:183], a[196:199], a[88:91], v[180:183]
ds_read_b128 a[180:183], v7 offset:38912
v_mfma_f32_16x16x32_bf16 v[188:191], a[196:199], a[92:95], v[188:191]
v_mfma_f32_16x16x32_bf16 v[184:187], a[192:195], a[92:95], v[184:187]
ds_read_b64_tr_b16 a[72:73], v9 offset:24832
v_mfma_f32_16x16x32_bf16 v[172:175], a[188:191], a[92:95], v[172:175]
buffer_load_dwordx4 v3, s[8:11], s97 offen  lds
v_mfma_f32_16x16x32_bf16 v[168:171], a[184:187], a[92:95], v[168:171]
s_add_u32 m0, s81, 128000
ds_read_b64_tr_b16 a[74:75], v9 offset:26368
v_mfma_f32_16x16x32_bf16 v[192:195], a[184:187], a[96:99], v[192:195]
Lpad5:
s_cbranch_execz Lpadback0
s_nop 0
ds_read_b64_tr_b16 a[76:77], v10 offset:24832
v_mfma_f32_16x16x32_bf16 v[196:199], a[188:191], a[96:99], v[196:199]
ds_read_b64_tr_b16 a[78:79], v10 offset:26368
v_mfma_f32_16x16x32_bf16 v[208:211], a[192:195], a[96:99], v[208:211]
v_mfma_f32_16x16x32_bf16 v[212:215], a[196:199], a[96:99], v[212:215]
buffer_load_dwordx4 v4, s[8:11], s97 offen  lds
v_mfma_f32_16x16x32_bf16 v[220:223], a[196:199], a[100:103], v[220:223]
s_add_u32 m0, s81, 129024
ds_read_b64_tr_b16 a[56:57], v9 offset:24576
ds_read_b64_tr_b16 a[58:59], v9 offset:26112
v_mfma_f32_16x16x32_bf16 v[216:219], a[192:195], a[100:103], v[216:219]
s_nop 0
v_mfma_f32_16x16x32_bf16 v[204:207], a[188:191], a[100:103], v[204:207]
ds_read_b64_tr_b16 a[60:61], v10 offset:24576
v_mfma_f32_16x16x32_bf16 v[200:203], a[184:187], a[100:103], v[200:203]
v_mfma_f32_16x16x32_bf16 v[224:227], a[80:83], a[184:187], v[224:227]
ds_read_b64_tr_b16 a[62:63], v10 offset:26112
v_mfma_f32_16x16x32_bf16 v[232:235], a[80:83], a[188:191], v[232:235]
buffer_load_dwordx4 v5, s[8:11], s97 offen  lds
v_mfma_f32_16x16x32_bf16 v[240:243], a[80:83], a[192:195], v[240:243]
v_mfma_f32_16x16x32_bf16 v[248:251], a[80:83], a[196:199], v[248:251]
v_mfma_f32_16x16x32_bf16 v[252:255], a[84:87], a[196:199], v[252:255]
v_mfma_f32_16x16x32_bf16 v[244:247], a[84:87], a[192:195], v[244:247]
v_mfma_f32_16x16x32_bf16 v[236:239], a[84:87], a[188:191], v[236:239]
s_waitcnt vmcnt(20) lgkmcnt(0)
v_mfma_f32_16x16x32_bf16 v[228:231], a[84:87], a[184:187], v[228:231]
s_barrier
v_mfma_f32_16x16x32_bf16 v[76:79], a[0:3], a[172:175], v[76:79]
s_add_u32 m0, s73, 24576
ds_read_b128 a[184:187], v8 offset:32768
s_mov_b32 s93, 132736
v_mfma_f32_16x16x32_bf16 v[104:107], a[0:3], a[176:179], v[104:107]
buffer_load_dwordx4 v2, s[4:7], s93 offen  lds
v_mfma_f32_16x16x32_bf16 v[132:135], a[0:3], a[180:183], v[132:135]
s_add_u32 m0, s73, 28672
ds_read_b64_tr_b16 a[28:29], v13 offset:49152
s_mov_b32 s94, 198272
v_mfma_f32_16x16x32_bf16 v[48:51], a[0:3], a[168:171], v[48:51]
s_cmp_eq_u32 s99, 2
s_cselect_b32 s92, 0, s100
ds_read_b64_tr_b16 a[30:31], v13 offset:51200
s_add_u32 s3, s92, s71
v_mfma_f32_16x16x32_bf16 v[52:55], a[4:7], a[168:171], v[52:55]
buffer_load_dword a255, v28, s[16:19], s3 offen
v_mfma_f32_16x16x32_bf16 v[136:139], a[4:7], a[180:183], v[136:139]
s_getpc_b64 s[64:65]
Lpc0:
ds_read_b64_tr_b16 a[32:33], v14 offset:49152
s_add_u32 s64, s64, Lbub-Lpc0
s_addc_u32 s65, s65, 0
v_mfma_f32_16x16x32_bf16 v[108:111], a[4:7], a[176:179], v[108:111]
buffer_load_dwordx4 v2, s[4:7], s94 offen  lds
v_mfma_f32_16x16x32_bf16 v[80:83], a[4:7], a[172:175], v[80:83]
s_add_u32 m0, s82, 81920
ds_read_b64_tr_b16 a[34:35], v14 offset:51200
ds_read_b64_tr_b16 a[36:37], v15 offset:49152
v_mfma_f32_16x16x32_bf16 v[84:87], a[8:11], a[172:175], v[84:87]
s_mov_b32 s95, 5963776
s_mov_b32 s66, Lcode_end-Lbub
s_mov_b32 s67, 0x20000
v_mfma_f32_16x16x32_bf16 v[112:115], a[8:11], a[176:179], v[112:115]
s_mul_i32 s3, s101, 384
ds_read_b64_tr_b16 a[38:39], v15 offset:51200
v_lshlrev_b32 v12, 7, v0
v_mfma_f32_16x16x32_bf16 v[140:143], a[8:11], a[180:183], v[140:143]
ds_read_b128 a[188:191], v8 offset:34816
v_cmp_gt_u32 vcc, 3, v0
s_nop 1
v_cndmask_b32 v12, v47, v12, vcc
v_mfma_f32_16x16x32_bf16 v[56:59], a[8:11], a[168:171], v[56:59]
v_mfma_f32_16x16x32_bf16 v[60:63], a[12:15], a[168:171], v[60:63]
buffer_load_dwordx4 v6, s[12:15], s95 offen  lds
v_mfma_f32_16x16x32_bf16 v[144:147], a[12:15], a[180:183], v[144:147]
s_add_u32 m0, s82, 83968
ds_read_b64_tr_b16 a[40:41], v16 offset:49152
ds_read_b64_tr_b16 a[42:43], v16 offset:51200
v_mfma_f32_16x16x32_bf16 v[116:119], a[12:15], a[176:179], v[116:119]
buffer_load_dword a255, v12, s[64:67], s3 offen
v_mfma_f32_16x16x32_bf16 v[88:91], a[12:15], a[172:175], v[88:91]
s_mov_b32 s96, 5992448
ds_read_b64_tr_b16 a[44:45], v17 offset:49152
v_mfma_f32_16x16x32_bf16 v[92:95], a[16:19], a[172:175], v[92:95]
ds_read_b64_tr_b16 a[46:47], v17 offset:51200
v_mfma_f32_16x16x32_bf16 v[120:123], a[16:19], a[176:179], v[120:123]
buffer_load_dwordx4 v6, s[12:15], s96 offen  lds
v_mfma_f32_16x16x32_bf16 v[148:151], a[16:19], a[180:183], v[148:151]
s_add_u32 m0, s82, 90112
ds_read_b64_tr_b16 a[48:49], v18 offset:49152
s_mov_b32 s97, 6078464
v_mfma_f32_16x16x32_bf16 v[64:67], a[16:19], a[168:171], v[64:67]
ds_read_b64_tr_b16 a[50:51], v18 offset:51200
v_mfma_f32_16x16x32_bf16 v[68:71], a[20:23], a[168:171], v[68:71]
v_mfma_f32_16x16x32_bf16 v[152:155], a[20:23], a[180:183], v[152:155]
ds_read_b128 a[192:195], v8 offset:36864
v_mfma_f32_16x16x32_bf16 v[124:127], a[20:23], a[176:179], v[124:127]
ds_read_b64_tr_b16 a[52:53], v19 offset:49152
v_mfma_f32_16x16x32_bf16 v[96:99], a[20:23], a[172:175], v[96:99]
buffer_load_dwordx4 v6, s[12:15], s97 offen  lds
v_mfma_f32_16x16x32_bf16 v[100:103], a[24:27], a[172:175], v[100:103]
s_add_u32 m0, s82, 92160
ds_read_b64_tr_b16 a[54:55], v19 offset:51200
s_mov_b32 s93, 6107136
v_mfma_f32_16x16x32_bf16 v[128:131], a[24:27], a[176:179], v[128:131]
ds_read_b64_tr_b16 a[88:89], v9 offset:36992
v_mfma_f32_16x16x32_bf16 v[156:159], a[24:27], a[180:183], v[156:159]
v_mfma_f32_16x16x32_bf16 v[72:75], a[24:27], a[168:171], v[72:75]
ds_read_b64_tr_b16 a[90:91], v9 offset:38528
v_mfma_f32_16x16x32_bf16 v[160:163], a[104:107], a[64:67], v[160:163]
buffer_load_dwordx4 v6, s[12:15], s93 offen  lds
v_mfma_f32_16x16x32_bf16 v[164:167], a[108:111], a[64:67], v[164:167]
s_mov_b32 s94, 4325376
ds_read_b64_tr_b16 a[92:93], v10 offset:36992
s_add_u32 m0, s81, 139264
v_mfma_f32_16x16x32_bf16 v[176:179], a[112:115], a[64:67], v[176:179]
ds_read_b64_tr_b16 a[94:95], v10 offset:38528
v_mfma_f32_16x16x32_bf16 v[180:183], a[116:119], a[64:67], v[180:183]
ds_read_b128 a[196:199], v8 offset:38912
v_mfma_f32_16x16x32_bf16 v[188:191], a[116:119], a[68:71], v[188:191]
v_mfma_f32_16x16x32_bf16 v[184:187], a[112:115], a[68:71], v[184:187]
ds_read_b64_tr_b16 a[96:97], v9 offset:37120
v_mfma_f32_16x16x32_bf16 v[172:175], a[108:111], a[68:71], v[172:175]
buffer_load_dwordx4 v3, s[8:11], s94 offen  lds
v_mfma_f32_16x16x32_bf16 v[168:171], a[104:107], a[68:71], v[168:171]
s_add_u32 m0, s81, 140288
ds_read_b64_tr_b16 a[98:99], v9 offset:38656
v_mfma_f32_16x16x32_bf16 v[192:195], a[104:107], a[72:75], v[192:195]
ds_read_b64_tr_b16 a[100:101], v10 offset:37120
v_mfma_f32_16x16x32_bf16 v[196:199], a[108:111], a[72:75], v[196:199]
ds_read_b64_tr_b16 a[102:103], v10 offset:38656
v_mfma_f32_16x16x32_bf16 v[208:211], a[112:115], a[72:75], v[208:211]
v_mfma_f32_16x16x32_bf16 v[212:215], a[116:119], a[72:75], v[212:215]
buffer_load_dwordx4 v4, s[8:11], s94 offen  lds
v_mfma_f32_16x16x32_bf16 v[220:223], a[116:119], a[76:79], v[220:223]
s_add_u32 m0, s81, 141312
ds_read_b64_tr_b16 a[80:81], v9 offset:36864
ds_read_b64_tr_b16 a[82:83], v9 offset:38400
v_mfma_f32_16x16x32_bf16 v[216:219], a[112:115], a[76:79], v[216:219]
v_mfma_f32_16x16x32_bf16 v[204:207], a[108:111], a[76:79], v[204:207]
ds_read_b64_tr_b16 a[84:85], v10 offset:36864
v_mfma_f32_16x16x32_bf16 v[200:203], a[104:107], a[76:79], v[200:203]
v_mfma_f32_16x16x32_bf16 v[224:227], a[56:59], a[104:107], v[224:227]
ds_read_b64_tr_b16 a[86:87], v10 offset:38400
v_mfma_f32_16x16x32_bf16 v[232:235], a[56:59], a[108:111], v[232:235]
buffer_load_dwordx4 v5, s[8:11], s94 offen  lds
v_mfma_f32_16x16x32_bf16 v[240:243], a[56:59], a[112:115], v[240:243]
v_mfma_f32_16x16x32_bf16 v[248:251], a[56:59], a[116:119], v[248:251]
v_mfma_f32_16x16x32_bf16 v[252:255], a[60:63], a[116:119], v[252:255]
v_mfma_f32_16x16x32_bf16 v[244:247], a[60:63], a[112:115], v[244:247]
v_mfma_f32_16x16x32_bf16 v[236:239], a[60:63], a[108:111], v[236:239]
s_waitcnt vmcnt(21) lgkmcnt(0)
v_mfma_f32_16x16x32_bf16 v[228:231], a[60:63], a[104:107], v[228:231]
s_barrier
v_mfma_f32_16x16x32_bf16 v[76:79], a[28:31], a[188:191], v[76:79]
s_add_u32 m0, s73, 32768
ds_read_b128 a[104:107], v7 offset:0
s_mov_b32 s95, 1792
v_mfma_f32_16x16x32_bf16 v[104:107], a[28:31], a[192:195], v[104:107]
buffer_load_dwordx4 v2, s[4:7], s95 offen  lds
v_mfma_f32_16x16x32_bf16 v[132:135], a[28:31], a[196:199], v[132:135]
s_add_u32 m0, s73, 36864
ds_read_b64_tr_b16 a[0:1], v13 offset:0
s_mov_b32 s96, 67328
v_mfma_f32_16x16x32_bf16 v[48:51], a[28:31], a[184:187], v[48:51]
s_cmp_eq_u32 s99, 3
s_cselect_b32 s92, 0, s100
ds_read_b64_tr_b16 a[2:3], v13 offset:2048
s_add_u32 s3, s92, s71
v_mfma_f32_16x16x32_bf16 v[52:55], a[32:35], a[184:187], v[52:55]
buffer_load_dword a255, v28, s[16:19], s3 offen
v_mfma_f32_16x16x32_bf16 v[136:139], a[32:35], a[196:199], v[136:139]
ds_read_b64_tr_b16 a[4:5], v14 offset:0
v_and_b32 v43, 1, v0
v_mfma_f32_16x16x32_bf16 v[108:111], a[32:35], a[192:195], v[108:111]
buffer_load_dwordx4 v2, s[4:7], s96 offen  lds
v_mfma_f32_16x16x32_bf16 v[80:83], a[32:35], a[188:191], v[80:83]
s_add_u32 m0, s82, 98304
ds_read_b64_tr_b16 a[6:7], v14 offset:2048
ds_read_b64_tr_b16 a[8:9], v15 offset:0
v_mfma_f32_16x16x32_bf16 v[84:87], a[36:39], a[188:191], v[84:87]
s_mov_b32 s97, 6193152
v_lshlrev_b32 v43, 7, v43
v_mfma_f32_16x16x32_bf16 v[112:115], a[36:39], a[192:195], v[112:115]
buffer_load_dword v42, v43, s[32:35], 0 offen sc1
v_mfma_f32_16x16x32_bf16 v[140:143], a[36:39], a[196:199], v[140:143]
s_nop 0
ds_read_b64_tr_b16 a[10:11], v15 offset:2048
ds_read_b128 a[108:111], v7 offset:2048
v_mfma_f32_16x16x32_bf16 v[56:59], a[36:39], a[184:187], v[56:59]
v_mfma_f32_16x16x32_bf16 v[60:63], a[40:43], a[184:187], v[60:63]
buffer_load_dwordx4 v6, s[12:15], s97 offen  lds
v_mfma_f32_16x16x32_bf16 v[144:147], a[40:43], a[196:199], v[144:147]
s_add_u32 m0, s82, 100352
ds_read_b64_tr_b16 a[12:13], v16 offset:0
ds_read_b64_tr_b16 a[14:15], v16 offset:2048
v_mfma_f32_16x16x32_bf16 v[116:119], a[40:43], a[192:195], v[116:119]
s_mov_b32 s93, 6221824
v_mfma_f32_16x16x32_bf16 v[88:91], a[40:43], a[188:191], v[88:91]
ds_read_b64_tr_b16 a[16:17], v17 offset:0
v_mfma_f32_16x16x32_bf16 v[92:95], a[44:47], a[188:191], v[92:95]
ds_read_b64_tr_b16 a[18:19], v17 offset:2048
v_mfma_f32_16x16x32_bf16 v[120:123], a[44:47], a[192:195], v[120:123]
buffer_load_dwordx4 v6, s[12:15], s93 offen  lds
v_mfma_f32_16x16x32_bf16 v[148:151], a[44:47], a[196:199], v[148:151]
s_add_u32 m0, s82, 106496
ds_read_b64_tr_b16 a[20:21], v18 offset:0
s_mov_b32 s94, 6307840
v_mfma_f32_16x16x32_bf16 v[64:67], a[44:47], a[184:187], v[64:67]
ds_read_b64_tr_b16 a[22:23], v18 offset:2048
v_mfma_f32_16x16x32_bf16 v[68:71], a[48:51], a[184:187], v[68:71]
v_mfma_f32_16x16x32_bf16 v[152:155], a[48:51], a[196:199], v[152:155]
ds_read_b128 a[112:115], v7 offset:4096
v_mfma_f32_16x16x32_bf16 v[124:127], a[48:51], a[192:195], v[124:127]
ds_read_b64_tr_b16 a[24:25], v19 offset:0
v_mfma_f32_16x16x32_bf16 v[96:99], a[48:51], a[188:191], v[96:99]
buffer_load_dwordx4 v6, s[12:15], s94 offen  lds
v_mfma_f32_16x16x32_bf16 v[100:103], a[52:55], a[188:191], v[100:103]
s_add_u32 m0, s82, 108544
ds_read_b64_tr_b16 a[26:27], v19 offset:2048
s_mov_b32 s95, 6336512
v_mfma_f32_16x16x32_bf16 v[128:131], a[52:55], a[192:195], v[128:131]
ds_read_b64_tr_b16 a[64:65], v9 offset:128
v_mfma_f32_16x16x32_bf16 v[156:159], a[52:55], a[196:199], v[156:159]
v_mfma_f32_16x16x32_bf16 v[72:75], a[52:55], a[184:187], v[72:75]
ds_read_b64_tr_b16 a[66:67], v9 offset:1664
v_mfma_f32_16x16x32_bf16 v[160:163], a[120:123], a[88:91], v[160:163]
buffer_load_dwordx4 v6, s[12:15], s95 offen  lds
v_mfma_f32_16x16x32_bf16 v[164:167], a[124:127], a[88:91], v[164:167]
s_mov_b32 s96, 4521984
ds_read_b64_tr_b16 a[68:69], v10 offset:128
s_add_u32 m0, s81, 151552
v_mfma_f32_16x16x32_bf16 v[176:179], a[128:131], a[88:91], v[176:179]
ds_read_b64_tr_b16 a[70:71], v10 offset:1664
v_mfma_f32_16x16x32_bf16 v[180:183], a[132:135], a[88:91], v[180:183]
ds_read_b128 a[116:119], v7 offset:6144
v_mfma_f32_16x16x32_bf16 v[188:191], a[132:135], a[92:95], v[188:191]
v_mfma_f32_16x16x32_bf16 v[184:187], a[128:131], a[92:95], v[184:187]
ds_read_b64_tr_b16 a[72:73], v9 offset:256
v_mfma_f32_16x16x32_bf16 v[172:175], a[124:127], a[92:95], v[172:175]
buffer_load_dwordx4 v3, s[8:11], s96 offen  lds
v_mfma_f32_16x16x32_bf16 v[168:171], a[120:123], a[92:95], v[168:171]
s_add_u32 m0, s81, 152576
ds_read_b64_tr_b16 a[74:75], v9 offset:1792
v_mfma_f32_16x16x32_bf16 v[192:195], a[120:123], a[96:99], v[192:195]
ds_read_b64_tr_b16 a[76:77], v10 offset:256
v_mfma_f32_16x16x32_bf16 v[196:199], a[124:127], a[96:99], v[196:199]
ds_read_b64_tr_b16 a[78:79], v10 offset:1792
v_mfma_f32_16x16x32_bf16 v[208:211], a[128:131], a[96:99], v[208:211]
v_mfma_f32_16x16x32_bf16 v[212:215], a[132:135], a[96:99], v[212:215]
buffer_load_dwordx4 v4, s[8:11], s96 offen  lds
v_mfma_f32_16x16x32_bf16 v[220:223], a[132:135], a[100:103], v[220:223]
s_add_u32 m0, s81, 153600
ds_read_b64_tr_b16 a[56:57], v9 offset:0
ds_read_b64_tr_b16 a[58:59], v9 offset:1536
v_mfma_f32_16x16x32_bf16 v[216:219], a[128:131], a[100:103], v[216:219]
v_mfma_f32_16x16x32_bf16 v[204:207], a[124:127], a[100:103], v[204:207]
ds_read_b64_tr_b16 a[60:61], v10 offset:0
v_mfma_f32_16x16x32_bf16 v[200:203], a[120:123], a[100:103], v[200:203]
v_mfma_f32_16x16x32_bf16 v[224:227], a[80:83], a[120:123], v[224:227]
ds_read_b64_tr_b16 a[62:63], v10 offset:1536
v_mfma_f32_16x16x32_bf16 v[232:235], a[80:83], a[124:127], v[232:235]
buffer_load_dwordx4 v5, s[8:11], s96 offen  lds
v_mfma_f32_16x16x32_bf16 v[240:243], a[80:83], a[128:131], v[240:243]
v_mfma_f32_16x16x32_bf16 v[248:251], a[80:83], a[132:135], v[248:251]
v_mfma_f32_16x16x32_bf16 v[252:255], a[84:87], a[132:135], v[252:255]
v_mfma_f32_16x16x32_bf16 v[244:247], a[84:87], a[128:131], v[244:247]
v_mfma_f32_16x16x32_bf16 v[236:239], a[84:87], a[124:127], v[236:239]
s_waitcnt vmcnt(22) lgkmcnt(0)
v_mfma_f32_16x16x32_bf16 v[228:231], a[84:87], a[120:123], v[228:231]
s_barrier
Lu24:
v_mfma_f32_16x16x32_bf16 v[76:79], a[0:3], a[108:111], v[76:79]
s_add_u32 m0, s73, 40960
ds_read_b128 a[120:123], v8 offset:0
s_mov_b32 s97, 132864
v_mfma_f32_16x16x32_bf16 v[104:107], a[0:3], a[112:115], v[104:107]
buffer_load_dwordx4 v2, s[4:7], s97 offen  lds
v_mfma_f32_16x16x32_bf16 v[132:135], a[0:3], a[116:119], v[132:135]
s_add_u32 m0, s73, 45056
ds_read_b64_tr_b16 a[28:29], v13 offset:16384
s_mov_b32 s93, 198400
v_mfma_f32_16x16x32_bf16 v[48:51], a[0:3], a[104:107], v[48:51]
s_cmp_eq_u32 s99, 4
s_cselect_b32 s92, 0, s100
ds_read_b64_tr_b16 a[30:31], v13 offset:18432
s_add_u32 s3, s92, s71
v_mfma_f32_16x16x32_bf16 v[52:55], a[4:7], a[104:107], v[52:55]
buffer_load_dword a255, v28, s[16:19], s3 offen
v_mfma_f32_16x16x32_bf16 v[136:139], a[4:7], a[116:119], v[136:139]
s_nop 0
ds_read_b64_tr_b16 a[32:33], v14 offset:16384
v_mfma_f32_16x16x32_bf16 v[108:111], a[4:7], a[112:115], v[108:111]
buffer_load_dwordx4 v2, s[4:7], s93 offen  lds
v_mfma_f32_16x16x32_bf16 v[80:83], a[4:7], a[108:111], v[80:83]
s_add_u32 m0, s82, 49152
ds_read_b64_tr_b16 a[34:35], v14 offset:18432
ds_read_b64_tr_b16 a[36:37], v15 offset:16384
v_mfma_f32_16x16x32_bf16 v[84:87], a[8:11], a[108:111], v[84:87]
s_mov_b32 s94, 6422528
v_mfma_f32_16x16x32_bf16 v[112:115], a[8:11], a[112:115], v[112:115]
ds_read_b64_tr_b16 a[38:39], v15 offset:18432
v_mfma_f32_16x16x32_bf16 v[140:143], a[8:11], a[116:119], v[140:143]
ds_read_b128 a[124:127], v8 offset:2048
v_mfma_f32_16x16x32_bf16 v[56:59], a[8:11], a[104:107], v[56:59]
v_mfma_f32_16x16x32_bf16 v[60:63], a[12:15], a[104:107], v[60:63]
buffer_load_dwordx4 v6, s[12:15], s94 offen  lds
v_mfma_f32_16x16x32_bf16 v[144:147], a[12:15], a[116:119], v[144:147]
s_add_u32 m0, s82, 51200
ds_read_b64_tr_b16 a[40:41], v16 offset:16384
ds_read_b64_tr_b16 a[42:43], v16 offset:18432
v_mfma_f32_16x16x32_bf16 v[116:119], a[12:15], a[112:115], v[116:119]
s_mov_b32 s95, 6451200
v_mfma_f32_16x16x32_bf16 v[88:91], a[12:15], a[108:111], v[88:91]
ds_read_b64_tr_b16 a[44:45], v17 offset:16384
v_mfma_f32_16x16x32_bf16 v[92:95], a[16:19], a[108:111], v[92:95]
ds_read_b64_tr_b16 a[46:47], v17 offset:18432
v_mfma_f32_16x16x32_bf16 v[120:123], a[16:19], a[112:115], v[120:123]
buffer_load_dwordx4 v6, s[12:15], s95 offen  lds
v_mfma_f32_16x16x32_bf16 v[148:151], a[16:19], a[116:119], v[148:151]
s_add_u32 m0, s82, 57344
ds_read_b64_tr_b16 a[48:49], v18 offset:16384
s_mov_b32 s96, 6537216
v_mfma_f32_16x16x32_bf16 v[64:67], a[16:19], a[104:107], v[64:67]
ds_read_b64_tr_b16 a[50:51], v18 offset:18432
v_mfma_f32_16x16x32_bf16 v[68:71], a[20:23], a[104:107], v[68:71]
v_mfma_f32_16x16x32_bf16 v[152:155], a[20:23], a[116:119], v[152:155]
ds_read_b128 a[128:131], v8 offset:4096
v_mfma_f32_16x16x32_bf16 v[124:127], a[20:23], a[112:115], v[124:127]
ds_read_b64_tr_b16 a[52:53], v19 offset:16384
v_mfma_f32_16x16x32_bf16 v[96:99], a[20:23], a[108:111], v[96:99]
buffer_load_dwordx4 v6, s[12:15], s96 offen  lds
v_mfma_f32_16x16x32_bf16 v[100:103], a[24:27], a[108:111], v[100:103]
s_add_u32 m0, s82, 59392
ds_read_b64_tr_b16 a[54:55], v19 offset:18432
s_mov_b32 s97, 6565888
v_mfma_f32_16x16x32_bf16 v[128:131], a[24:27], a[112:115], v[128:131]
ds_read_b64_tr_b16 a[88:89], v9 offset:12416
v_mfma_f32_16x16x32_bf16 v[156:159], a[24:27], a[116:119], v[156:159]
v_mfma_f32_16x16x32_bf16 v[72:75], a[24:27], a[104:107], v[72:75]
ds_read_b64_tr_b16 a[90:91], v9 offset:13952
v_mfma_f32_16x16x32_bf16 v[160:163], a[136:139], a[64:67], v[160:163]
buffer_load_dwordx4 v6, s[12:15], s97 offen  lds
v_mfma_f32_16x16x32_bf16 v[164:167], a[140:143], a[64:67], v[164:167]
s_mov_b32 s93, 4718592
ds_read_b64_tr_b16 a[92:93], v10 offset:12416
s_add_u32 m0, s81, 114688
v_mfma_f32_16x16x32_bf16 v[176:179], a[144:147], a[64:67], v[176:179]
ds_read_b64_tr_b16 a[94:95], v10 offset:13952
v_mfma_f32_16x16x32_bf16 v[180:183], a[148:151], a[64:67], v[180:183]
ds_read_b128 a[132:135], v8 offset:6144
v_mfma_f32_16x16x32_bf16 v[188:191], a[148:151], a[68:71], v[188:191]
v_mfma_f32_16x16x32_bf16 v[184:187], a[144:147], a[68:71], v[184:187]
ds_read_b64_tr_b16 a[96:97], v9 offset:12544
v_mfma_f32_16x16x32_bf16 v[172:175], a[140:143], a[68:71], v[172:175]
buffer_load_dwordx4 v3, s[8:11], s93 offen  lds
v_mfma_f32_16x16x32_bf16 v[168:171], a[136:139], a[68:71], v[168:171]
s_add_u32 m0, s81, 115712
ds_read_b64_tr_b16 a[98:99], v9 offset:14080
v_mfma_f32_16x16x32_bf16 v[192:195], a[136:139], a[72:75], v[192:195]
ds_read_b64_tr_b16 a[100:101], v10 offset:12544
v_mfma_f32_16x16x32_bf16 v[196:199], a[140:143], a[72:75], v[196:199]
ds_read_b64_tr_b16 a[102:103], v10 offset:14080
v_mfma_f32_16x16x32_bf16 v[208:211], a[144:147], a[72:75], v[208:211]
v_mfma_f32_16x16x32_bf16 v[212:215], a[148:151], a[72:75], v[212:215]
buffer_load_dwordx4 v4, s[8:11], s93 offen  lds
v_mfma_f32_16x16x32_bf16 v[220:223], a[148:151], a[76:79], v[220:223]
s_add_u32 m0, s81, 116736
ds_read_b64_tr_b16 a[80:81], v9 offset:12288
ds_read_b64_tr_b16 a[82:83], v9 offset:13824
v_mfma_f32_16x16x32_bf16 v[216:219], a[144:147], a[76:79], v[216:219]
s_nop 0
v_mfma_f32_16x16x32_bf16 v[204:207], a[140:143], a[76:79], v[204:207]
ds_read_b64_tr_b16 a[84:85], v10 offset:12288
v_mfma_f32_16x16x32_bf16 v[200:203], a[136:139], a[76:79], v[200:203]
v_mfma_f32_16x16x32_bf16 v[224:227], a[56:59], a[136:139], v[224:227]
ds_read_b64_tr_b16 a[86:87], v10 offset:13824
v_mfma_f32_16x16x32_bf16 v[232:235], a[56:59], a[140:143], v[232:235]
buffer_load_dwordx4 v5, s[8:11], s93 offen  lds
v_mfma_f32_16x16x32_bf16 v[240:243], a[56:59], a[144:147], v[240:243]
v_mfma_f32_16x16x32_bf16 v[248:251], a[56:59], a[148:151], v[248:251]
v_mfma_f32_16x16x32_bf16 v[252:255], a[60:63], a[148:151], v[252:255]
v_mfma_f32_16x16x32_bf16 v[244:247], a[60:63], a[144:147], v[244:247]
v_mfma_f32_16x16x32_bf16 v[236:239], a[60:63], a[140:143], v[236:239]
s_waitcnt vmcnt(21) lgkmcnt(0)
v_mfma_f32_16x16x32_bf16 v[228:231], a[60:63], a[136:139], v[228:231]
s_barrier
v_mfma_f32_16x16x32_bf16 v[76:79], a[28:31], a[124:127], v[76:79]
s_add_u32 m0, s73, 0
ds_read_b128 a[136:139], v7 offset:16384
s_mov_b32 s94, 1920
v_mfma_f32_16x16x32_bf16 v[104:107], a[28:31], a[128:131], v[104:107]
buffer_load_dwordx4 v2, s[4:7], s94 offen  lds
v_mfma_f32_16x16x32_bf16 v[132:135], a[28:31], a[132:135], v[132:135]
s_add_u32 m0, s73, 4096
ds_read_b64_tr_b16 a[0:1], v13 offset:32768
s_mov_b32 s95, 67456
v_mfma_f32_16x16x32_bf16 v[48:51], a[28:31], a[120:123], v[48:51]
s_cmp_eq_u32 s99, 5
s_cselect_b32 s92, 0, s100
ds_read_b64_tr_b16 a[2:3], v13 offset:34816
s_add_u32 s3, s92, s71
v_mfma_f32_16x16x32_bf16 v[52:55], a[32:35], a[120:123], v[52:55]
buffer_load_dword a255, v28, s[16:19], s3 offen
v_mfma_f32_16x16x32_bf16 v[136:139], a[32:35], a[132:135], v[136:139]
s_nop 0
ds_read_b64_tr_b16 a[4:5], v14 offset:32768
v_mfma_f32_16x16x32_bf16 v[108:111], a[32:35], a[128:131], v[108:111]
buffer_load_dwordx4 v2, s[4:7], s95 offen  lds
v_mfma_f32_16x16x32_bf16 v[80:83], a[32:35], a[124:127], v[80:83]
s_add_u32 m0, s82, 65536
ds_read_b64_tr_b16 a[6:7], v14 offset:34816
ds_read_b64_tr_b16 a[8:9], v15 offset:32768
v_mfma_f32_16x16x32_bf16 v[84:87], a[36:39], a[124:127], v[84:87]
s_mov_b32 s96, 6651904
v_mfma_f32_16x16x32_bf16 v[112:115], a[36:39], a[128:131], v[112:115]
ds_read_b64_tr_b16 a[10:11], v15 offset:34816
v_mfma_f32_16x16x32_bf16 v[140:143], a[36:39], a[132:135], v[140:143]
ds_read_b128 a[140:143], v7 offset:18432
v_mfma_f32_16x16x32_bf16 v[56:59], a[36:39], a[120:123], v[56:59]
v_mfma_f32_16x16x32_bf16 v[60:63], a[40:43], a[120:123], v[60:63]
buffer_load_dwordx4 v6, s[12:15], s96 offen  lds
v_mfma_f32_16x16x32_bf16 v[144:147], a[40:43], a[132:135], v[144:147]
s_add_u32 m0, s82, 67584
ds_read_b64_tr_b16 a[12:13], v16 offset:32768
ds_read_b64_tr_b16 a[14:15], v16 offset:34816
v_mfma_f32_16x16x32_bf16 v[116:119], a[40:43], a[128:131], v[116:119]
s_mov_b32 s97, 6680576
v_mfma_f32_16x16x32_bf16 v[88:91], a[40:43], a[124:127], v[88:91]
ds_read_b64_tr_b16 a[16:17], v17 offset:32768
v_mfma_f32_16x16x32_bf16 v[92:95], a[44:47], a[124:127], v[92:95]
ds_read_b64_tr_b16 a[18:19], v17 offset:34816
v_mfma_f32_16x16x32_bf16 v[120:123], a[44:47], a[128:131], v[120:123]
buffer_load_dwordx4 v6, s[12:15], s97 offen  lds
v_mfma_f32_16x16x32_bf16 v[148:151], a[44:47], a[132:135], v[148:151]
s_add_u32 m0, s82, 73728
ds_read_b64_tr_b16 a[20:21], v18 offset:32768
s_mov_b32 s93, 6766592
v_mfma_f32_16x16x32_bf16 v[64:67], a[44:47], a[120:123], v[64:67]
ds_read_b64_tr_b16 a[22:23], v18 offset:34816
v_mfma_f32_16x16x32_bf16 v[68:71], a[48:51], a[120:123], v[68:71]
v_mfma_f32_16x16x32_bf16 v[152:155], a[48:51], a[132:135], v[152:155]
ds_read_b128 a[144:147], v7 offset:20480
v_mfma_f32_16x16x32_bf16 v[124:127], a[48:51], a[128:131], v[124:127]
ds_read_b64_tr_b16 a[24:25], v19 offset:32768
v_mfma_f32_16x16x32_bf16 v[96:99], a[48:51], a[124:127], v[96:99]
buffer_load_dwordx4 v6, s[12:15], s93 offen  lds
v_mfma_f32_16x16x32_bf16 v[100:103], a[52:55], a[124:127], v[100:103]
s_add_u32 m0, s82, 75776
ds_read_b64_tr_b16 a[26:27], v19 offset:34816
s_mov_b32 s94, 6795264
v_mfma_f32_16x16x32_bf16 v[128:131], a[52:55], a[128:131], v[128:131]
ds_read_b64_tr_b16 a[64:65], v9 offset:24704
v_mfma_f32_16x16x32_bf16 v[156:159], a[52:55], a[132:135], v[156:159]
v_mfma_f32_16x16x32_bf16 v[72:75], a[52:55], a[120:123], v[72:75]
ds_read_b64_tr_b16 a[66:67], v9 offset:26240
v_mfma_f32_16x16x32_bf16 v[160:163], a[152:155], a[88:91], v[160:163]
buffer_load_dwordx4 v6, s[12:15], s94 offen  lds
v_mfma_f32_16x16x32_bf16 v[164:167], a[156:159], a[88:91], v[164:167]
s_mov_b32 s95, 4915200
ds_read_b64_tr_b16 a[68:69], v10 offset:24704
s_add_u32 m0, s81, 126976
v_mfma_f32_16x16x32_bf16 v[176:179], a[160:163], a[88:91], v[176:179]
ds_read_b64_tr_b16 a[70:71], v10 offset:26240
v_mfma_f32_16x16x32_bf16 v[180:183], a[164:167], a[88:91], v[180:183]
ds_read_b128 a[148:151], v7 offset:22528
v_mfma_f32_16x16x32_bf16 v[188:191], a[164:167], a[92:95], v[188:191]
v_mfma_f32_16x16x32_bf16 v[184:187], a[160:163], a[92:95], v[184:187]
ds_read_b64_tr_b16 a[72:73], v9 offset:24832
v_mfma_f32_16x16x32_bf16 v[172:175], a[156:159], a[92:95], v[172:175]
buffer_load_dwordx4 v3, s[8:11], s95 offen  lds
v_mfma_f32_16x16x32_bf16 v[168:171], a[152:155], a[92:95], v[168:171]
s_add_u32 m0, s81, 128000
ds_read_b64_tr_b16 a[74:75], v9 offset:26368
v_mfma_f32_16x16x32_bf16 v[192:195], a[152:155], a[96:99], v[192:195]
ds_read_b64_tr_b16 a[76:77], v10 offset:24832
v_mfma_f32_16x16x32_bf16 v[196:199], a[156:159], a[96:99], v[196:199]
ds_read_b64_tr_b16 a[78:79], v10 offset:26368
v_mfma_f32_16x16x32_bf16 v[208:211], a[160:163], a[96:99], v[208:211]
v_mfma_f32_16x16x32_bf16 v[212:215], a[164:167], a[96:99], v[212:215]
buffer_load_dwordx4 v4, s[8:11], s95 offen  lds
v_mfma_f32_16x16x32_bf16 v[220:223], a[164:167], a[100:103], v[220:223]
s_add_u32 m0, s81, 129024
ds_read_b64_tr_b16 a[56:57], v9 offset:24576
ds_read_b64_tr_b16 a[58:59], v9 offset:26112
v_mfma_f32_16x16x32_bf16 v[216:219], a[160:163], a[100:103], v[216:219]
s_nop 0
v_mfma_f32_16x16x32_bf16 v[204:207], a[156:159], a[100:103], v[204:207]
ds_read_b64_tr_b16 a[60:61], v10 offset:24576
v_mfma_f32_16x16x32_bf16 v[200:203], a[152:155], a[100:103], v[200:203]
v_mfma_f32_16x16x32_bf16 v[224:227], a[80:83], a[152:155], v[224:227]
ds_read_b64_tr_b16 a[62:63], v10 offset:26112
v_mfma_f32_16x16x32_bf16 v[232:235], a[80:83], a[156:159], v[232:235]
buffer_load_dwordx4 v5, s[8:11], s95 offen  lds
v_mfma_f32_16x16x32_bf16 v[240:243], a[80:83], a[160:163], v[240:243]
v_mfma_f32_16x16x32_bf16 v[248:251], a[80:83], a[164:167], v[248:251]
v_mfma_f32_16x16x32_bf16 v[252:255], a[84:87], a[164:167], v[252:255]
v_mfma_f32_16x16x32_bf16 v[244:247], a[84:87], a[160:163], v[244:247]
v_mfma_f32_16x16x32_bf16 v[236:239], a[84:87], a[156:159], v[236:239]
s_waitcnt vmcnt(20) lgkmcnt(0)
v_mfma_f32_16x16x32_bf16 v[228:231], a[84:87], a[152:155], v[228:231]
s_barrier
v_mfma_f32_16x16x32_bf16 v[76:79], a[0:3], a[140:143], v[76:79]
s_add_u32 m0, s73, 8192
ds_read_b128 a[152:155], v8 offset:16384
s_mov_b32 s96, 132992
v_mfma_f32_16x16x32_bf16 v[104:107], a[0:3], a[144:147], v[104:107]
buffer_load_dwordx4 v2, s[4:7], s96 offen  lds
v_mfma_f32_16x16x32_bf16 v[132:135], a[0:3], a[148:151], v[132:135]
s_add_u32 m0, s73, 12288
ds_read_b64_tr_b16 a[28:29], v13 offset:49152
s_mov_b32 s97, 198528
v_mfma_f32_16x16x32_bf16 v[48:51], a[0:3], a[136:139], v[48:51]
s_cmp_eq_u32 s99, 6
s_cselect_b32 s92, 0, s100
ds_read_b64_tr_b16 a[30:31], v13 offset:51200
s_add_u32 s3, s92, s71
v_mfma_f32_16x16x32_bf16 v[52:55], a[4:7], a[136:139], v[52:55]
buffer_load_dword a255, v28, s[16:19], s3 offen
v_mfma_f32_16x16x32_bf16 v[136:139], a[4:7], a[148:151], v[136:139]
s_movk_i32 s45, 128
ds_read_b64_tr_b16 a[32:33], v14 offset:49152
s_nop 0
v_mfma_f32_16x16x32_bf16 v[108:111], a[4:7], a[144:147], v[108:111]
buffer_load_dwordx4 v2, s[4:7], s97 offen  lds
v_mfma_f32_16x16x32_bf16 v[80:83], a[4:7], a[140:143], v[80:83]
s_add_u32 m0, s82, 81920
ds_read_b64_tr_b16 a[34:35], v14 offset:51200
ds_read_b64_tr_b16 a[36:37], v15 offset:49152
v_mfma_f32_16x16x32_bf16 v[84:87], a[8:11], a[140:143], v[84:87]
s_mov_b32 s93, 6881280
v_cmp_gt_u32 vcc, s45, v42
s_nop 3
s_cbranch_vccz Lret1
s_mov_b32 s47, 0
Lslow1_l:
s_sleep 8
buffer_load_dword v42, v43, s[32:35], 0 offen sc1
s_add_u32 s47, s47, 1
s_waitcnt vmcnt(0)
v_cmp_gt_u32 vcc, s45, v42
s_cmp_gt_u32 s47, 0x40000
s_cbranch_scc1 Lret1
s_nop 3
s_cbranch_vccnz Lslow1_l
Lret1:
v_lshrrev_b32 v45, 4, v0
Lpad6:
s_cbranch_execz Lpadback0
s_nop 0
v_mfma_f32_16x16x32_bf16 v[112:115], a[8:11], a[144:147], v[112:115]
ds_read_b64_tr_b16 a[38:39], v15 offset:51200
v_lshlrev_b32 v45, 3, v45
v_mfma_f32_16x16x32_bf16 v[140:143], a[8:11], a[148:151], v[140:143]
ds_read_b128 a[156:159], v8 offset:18432
v_and_b32 v44, 3, v0
v_mfma_f32_16x16x32_bf16 v[56:59], a[8:11], a[136:139], v[56:59]
v_lshl_add_u32 v45, v44, 5, v45
v_mfma_f32_16x16x32_bf16 v[60:63], a[12:15], a[136:139], v[60:63]
buffer_load_dwordx4 v6, s[12:15], s93 offen  lds
v_mfma_f32_16x16x32_bf16 v[144:147], a[12:15], a[148:151], v[144:147]
s_add_u32 m0, s82, 83968
ds_read_b64_tr_b16 a[40:41], v16 offset:49152
ds_read_b64_tr_b16 a[42:43], v16 offset:51200
v_mfma_f32_16x16x32_bf16 v[116:119], a[12:15], a[144:147], v[116:119]
buffer_load_dwordx2 v[42:43], v45, s[40:43], s39 offen
v_mfma_f32_16x16x32_bf16 v[88:91], a[12:15], a[140:143], v[88:91]
s_mov_b32 s94, 6909952
ds_read_b64_tr_b16 a[44:45], v17 offset:49152
v_mfma_f32_16x16x32_bf16 v[92:95], a[16:19], a[140:143], v[92:95]
ds_read_b64_tr_b16 a[46:47], v17 offset:51200
v_mfma_f32_16x16x32_bf16 v[120:123], a[16:19], a[144:147], v[120:123]
buffer_load_dwordx4 v6, s[12:15], s94 offen  lds
v_mfma_f32_16x16x32_bf16 v[148:151], a[16:19], a[148:151], v[148:151]
s_add_u32 m0, s82, 90112
ds_read_b64_tr_b16 a[48:49], v18 offset:49152
s_mov_b32 s95, 6995968
v_mfma_f32_16x16x32_bf16 v[64:67], a[16:19], a[136:139], v[64:67]
ds_read_b64_tr_b16 a[50:51], v18 offset:51200
v_mfma_f32_16x16x32_bf16 v[68:71], a[20:23], a[136:139], v[68:71]
v_mfma_f32_16x16x32_bf16 v[152:155], a[20:23], a[148:151], v[152:155]
ds_read_b128 a[160:163], v8 offset:20480
v_mfma_f32_16x16x32_bf16 v[124:127], a[20:23], a[144:147], v[124:127]
ds_read_b64_tr_b16 a[52:53], v19 offset:49152
v_mfma_f32_16x16x32_bf16 v[96:99], a[20:23], a[140:143], v[96:99]
buffer_load_dwordx4 v6, s[12:15], s95 offen  lds
v_mfma_f32_16x16x32_bf16 v[100:103], a[24:27], a[140:143], v[100:103]
s_add_u32 m0, s82, 92160
ds_read_b64_tr_b16 a[54:55], v19 offset:51200
s_mov_b32 s96, 7024640
v_mfma_f32_16x16x32_bf16 v[128:131], a[24:27], a[144:147], v[128:131]
ds_read_b64_tr_b16 a[88:89], v9 offset:36992
v_mfma_f32_16x16x32_bf16 v[156:159], a[24:27], a[148:151], v[156:159]
v_mfma_f32_16x16x32_bf16 v[72:75], a[24:27], a[136:139], v[72:75]
ds_read_b64_tr_b16 a[90:91], v9 offset:38528
v_mfma_f32_16x16x32_bf16 v[160:163], a[168:171], a[64:67], v[160:163]
buffer_load_dwordx4 v6, s[12:15], s96 offen  lds
v_mfma_f32_16x16x32_bf16 v[164:167], a[172:175], a[64:67], v[164:167]
s_mov_b32 s97, 5111808
ds_read_b64_tr_b16 a[92:93], v10 offset:36992
s_add_u32 m0, s81, 139264
v_mfma_f32_16x16x32_bf16 v[176:179], a[176:179], a[64:67], v[176:179]
ds_read_b64_tr_b16 a[94:95], v10 offset:38528
v_mfma_f32_16x16x32_bf16 v[180:183], a[180:183], a[64:67], v[180:183]
ds_read_b128 a[164:167], v8 offset:22528
v_mfma_f32_16x16x32_bf16 v[188:191], a[180:183], a[68:71], v[188:191]
v_mfma_f32_16x16x32_bf16 v[184:187], a[176:179], a[68:71], v[184:187]
ds_read_b64_tr_b16 a[96:97], v9 offset:37120
v_mfma_f32_16x16x32_bf16 v[172:175], a[172:175], a[68:71], v[172:175]
buffer_load_dwordx4 v3, s[8:11], s97 offen  lds
v_mfma_f32_16x16x32_bf16 v[168:171], a[168:171], a[68:71], v[168:171]
s_add_u32 m0, s81, 140288
ds_read_b64_tr_b16 a[98:99], v9 offset:38656
v_mfma_f32_16x16x32_bf16 v[192:195], a[168:171], a[72:75], v[192:195]
ds_read_b64_tr_b16 a[100:101], v10 offset:37120
v_mfma_f32_16x16x32_bf16 v[196:199], a[172:175], a[72:75], v[196:199]
ds_read_b64_tr_b16 a[102:103], v10 offset:38656
v_mfma_f32_16x16x32_bf16 v[208:211], a[176:179], a[72:75], v[208:211]
v_mfma_f32_16x16x32_bf16 v[212:215], a[180:183], a[72:75], v[212:215]
buffer_load_dwordx4 v4, s[8:11], s97 offen  lds
v_mfma_f32_16x16x32_bf16 v[220:223], a[180:183], a[76:79], v[220:223]
s_add_u32 m0, s81, 141312
ds_read_b64_tr_b16 a[80:81], v9 offset:36864
ds_read_b64_tr_b16 a[82:83], v9 offset:38400
v_mfma_f32_16x16x32_bf16 v[216:219], a[176:179], a[76:79], v[216:219]
v_mfma_f32_16x16x32_bf16 v[204:207], a[172:175], a[76:79], v[204:207]
ds_read_b64_tr_b16 a[84:85], v10 offset:36864
v_mfma_f32_16x16x32_bf16 v[200:203], a[168:171], a[76:79], v[200:203]
v_mfma_f32_16x16x32_bf16 v[224:227], a[56:59], a[168:171], v[224:227]
ds_read_b64_tr_b16 a[86:87], v10 offset:38400
v_mfma_f32_16x16x32_bf16 v[232:235], a[56:59], a[172:175], v[232:235]
buffer_load_dwordx4 v5, s[8:11], s97 offen  lds
v_mfma_f32_16x16x32_bf16 v[240:243], a[56:59], a[176:179], v[240:243]
v_mfma_f32_16x16x32_bf16 v[248:251], a[56:59], a[180:183], v[248:251]
v_mfma_f32_16x16x32_bf16 v[252:255], a[60:63], a[180:183], v[252:255]
v_mfma_f32_16x16x32_bf16 v[244:247], a[60:63], a[176:179], v[244:247]
v_mfma_f32_16x16x32_bf16 v[236:239], a[60:63], a[172:175], v[236:239]
s_waitcnt vmcnt(21) lgkmcnt(0)
v_mfma_f32_16x16x32_bf16 v[228:231], a[60:63], a[168:171], v[228:231]
s_barrier
v_mfma_f32_16x16x32_bf16 v[76:79], a[28:31], a[156:159], v[76:79]
s_add_u32 m0, s82, 98304
ds_read_b128 a[168:171], v7 offset:32768
s_mov_b32 s93, 7110656
v_mfma_f32_16x16x32_bf16 v[104:107], a[28:31], a[160:163], v[104:107]
buffer_load_dwordx4 v6, s[12:15], s93 offen  lds
v_mfma_f32_16x16x32_bf16 v[132:135], a[28:31], a[164:167], v[132:135]
s_add_u32 m0, s82, 100352
ds_read_b64_tr_b16 a[0:1], v13 offset:0
s_mov_b32 s94, 7139328
v_mfma_f32_16x16x32_bf16 v[48:51], a[28:31], a[152:155], v[48:51]
s_cmp_eq_u32 s99, 7
s_cselect_b32 s92, 0, s100
ds_read_b64_tr_b16 a[2:3], v13 offset:2048
s_add_u32 s3, s92, s71
v_mfma_f32_16x16x32_bf16 v[52:55], a[32:35], a[152:155], v[52:55]
buffer_load_dword a255, v28, s[16:19], s3 offen
v_mfma_f32_16x16x32_bf16 v[136:139], a[32:35], a[164:167], v[136:139]
s_cmp_eq_u32 s72, 0
s_cselect_b32 s42, 0, s100
ds_read_b64_tr_b16 a[4:5], v14 offset:0
v_lshrrev_b32 v20, 2, v0
v_mfma_f32_16x16x32_bf16 v[108:111], a[32:35], a[160:163], v[108:111]
ds_read_b64_tr_b16 a[6:7], v14 offset:2048
v_lshlrev_b32 v20, 7, v20
v_mfma_f32_16x16x32_bf16 v[80:83], a[32:35], a[156:159], v[80:83]
ds_read_b64_tr_b16 a[8:9], v15 offset:0
v_and_b32 v21, 3, v0
v_mfma_f32_16x16x32_bf16 v[84:87], a[36:39], a[156:159], v[84:87]
buffer_load_dwordx4 v6, s[12:15], s94 offen  lds
v_mfma_f32_16x16x32_bf16 v[112:115], a[36:39], a[160:163], v[112:115]
s_add_u32 m0, s82, 106496
ds_read_b64_tr_b16 a[10:11], v15 offset:2048
s_mov_b32 s95, 7225344
v_mfma_f32_16x16x32_bf16 v[140:143], a[36:39], a[164:167], v[140:143]
ds_read_b128 a[172:175], v7 offset:34816
v_lshl_add_u32 v20, v21, 2, v20
v_mfma_f32_16x16x32_bf16 v[56:59], a[36:39], a[152:155], v[56:59]
s_lshl_b32 s50, s77, 11
s_add_u32 s51, s50, s42
v_add_u32 v25, s51, v20
v_mfma_f32_16x16x32_bf16 v[60:63], a[40:43], a[152:155], v[60:63]
ds_read_b64_tr_b16 a[12:13], v16 offset:0
v_accvgpr_write_b32 a228, v25
v_mfma_f32_16x16x32_bf16 v[144:147], a[40:43], a[164:167], v[144:147]
s_lshl_b32 s51, s75, 11
ds_read_b64_tr_b16 a[14:15], v16 offset:2048
s_add_u32 s51, s51, s42
v_mfma_f32_16x16x32_bf16 v[116:119], a[40:43], a[160:163], v[116:119]
v_add_u32 v25, s51, v20
v_accvgpr_write_b32 a229, v25
v_mfma_f32_16x16x32_bf16 v[88:91], a[40:43], a[156:159], v[88:91]
buffer_load_dwordx4 v6, s[12:15], s95 offen  lds
v_mfma_f32_16x16x32_bf16 v[92:95], a[44:47], a[156:159], v[92:95]
s_add_u32 m0, s82, 108544
ds_read_b64_tr_b16 a[16:17], v17 offset:0
ds_read_b64_tr_b16 a[18:19], v17 offset:2048
v_mfma_f32_16x16x32_bf16 v[120:123], a[44:47], a[160:163], v[120:123]
s_mov_b32 s96, 7254016
s_lshl_b32 s51, s76, 10
s_add_u32 s50, s50, s51
v_mfma_f32_16x16x32_bf16 v[148:151], a[44:47], a[164:167], v[148:151]
ds_read_b64_tr_b16 a[20:21], v18 offset:0
v_and_b32 v20, 0x3ff, v20
v_mfma_f32_16x16x32_bf16 v[64:67], a[44:47], a[152:155], v[64:67]
ds_read_b64_tr_b16 a[22:23], v18 offset:2048
v_add_u32 v25, s50, v20
v_mfma_f32_16x16x32_bf16 v[68:71], a[48:51], a[152:155], v[68:71]
v_accvgpr_write_b32 a230, v25
v_add_u32 v25, s42, v25
v_mfma_f32_16x16x32_bf16 v[152:155], a[48:51], a[164:167], v[152:155]
ds_read_b128 a[176:179], v7 offset:36864
v_accvgpr_write_b32 a231, v25
v_mfma_f32_16x16x32_bf16 v[124:127], a[48:51], a[160:163], v[124:127]
s_lshl_b32 s51, s77, 2
ds_read_b64_tr_b16 a[24:25], v19 offset:0
s_add_u32 s51, s51, s72
v_mfma_f32_16x16x32_bf16 v[96:99], a[48:51], a[156:159], v[96:99]
buffer_load_dwordx4 v6, s[12:15], s96 offen  lds
v_mfma_f32_16x16x32_bf16 v[100:103], a[52:55], a[156:159], v[100:103]
s_mov_b32 s97, 5308416
ds_read_b64_tr_b16 a[26:27], v19 offset:2048
s_add_u32 m0, s81, 151552
v_mfma_f32_16x16x32_bf16 v[128:131], a[52:55], a[160:163], v[128:131]
s_mul_i32 s50, s51, 294912
ds_read_b64_tr_b16 a[64:65], v9 offset:128
v_add_u32 v25, s50, v1
v_mfma_f32_16x16x32_bf16 v[156:159], a[52:55], a[164:167], v[156:159]
v_accvgpr_write_b32 a232, v25
v_add_u32 v25, 147456, v25
v_mfma_f32_16x16x32_bf16 v[72:75], a[52:55], a[152:155], v[72:75]
ds_read_b64_tr_b16 a[66:67], v9 offset:1664
v_accvgpr_write_b32 a233, v25
v_mfma_f32_16x16x32_bf16 v[160:163], a[184:187], a[88:91], v[160:163]
ds_read_b64_tr_b16 a[68:69], v10 offset:128
v_lshrrev_b32 v20, 4, v0
v_mfma_f32_16x16x32_bf16 v[164:167], a[188:191], a[88:91], v[164:167]
v_and_b32 v21, 15, v0
v_lshlrev_b32 v22, 11, v21
v_mfma_f32_16x16x32_bf16 v[176:179], a[192:195], a[88:91], v[176:179]
buffer_load_dwordx4 v3, s[8:11], s97 offen  lds
v_mfma_f32_16x16x32_bf16 v[180:183], a[196:199], a[88:91], v[180:183]
s_add_u32 m0, s81, 152576
ds_read_b64_tr_b16 a[70:71], v10 offset:1664
ds_read_b128 a[180:183], v7 offset:38912
v_mfma_f32_16x16x32_bf16 v[188:191], a[196:199], a[92:95], v[188:191]
v_and_b32 v23, 1, v20
v_lshl_add_u32 v22, v23, 5, v22
v_mfma_f32_16x16x32_bf16 v[184:187], a[192:195], a[92:95], v[184:187]
ds_read_b64_tr_b16 a[72:73], v9 offset:256
v_lshrrev_b32 v23, 1, v20
v_mfma_f32_16x16x32_bf16 v[172:175], a[188:191], a[92:95], v[172:175]
ds_read_b64_tr_b16 a[74:75], v9 offset:1792
v_lshl_add_u32 v22, v23, 4, v22
v_mfma_f32_16x16x32_bf16 v[168:171], a[184:187], a[92:95], v[168:171]
s_lshl_b32 s50, s51, 16
s_add_u32 s50, s50, s39
v_add_u32 v25, s50, v22
v_mfma_f32_16x16x32_bf16 v[192:195], a[184:187], a[96:99], v[192:195]
s_nop 0
ds_read_b64_tr_b16 a[76:77], v10 offset:256
v_accvgpr_write_b32 a234, v25
v_mfma_f32_16x16x32_bf16 v[196:199], a[188:191], a[96:99], v[196:199]
buffer_load_dwordx4 v4, s[8:11], s97 offen  lds
v_mfma_f32_16x16x32_bf16 v[208:211], a[192:195], a[96:99], v[208:211]
s_add_u32 m0, s81, 153600
ds_read_b64_tr_b16 a[78:79], v10 offset:1792
s_mul_i32 s50, s83, 81920
v_mfma_f32_16x16x32_bf16 v[212:215], a[196:199], a[96:99], v[212:215]
s_add_u32 s50, s50, 27262976
ds_read_b64_tr_b16 a[56:57], v9 offset:0
v_lshrrev_b32 v22, 3, v0
v_mfma_f32_16x16x32_bf16 v[220:223], a[196:199], a[100:103], v[220:223]
ds_read_b64_tr_b16 a[58:59], v9 offset:1536
v_and_b32 v23, 7, v0
v_mfma_f32_16x16x32_bf16 v[216:219], a[192:195], a[100:103], v[216:219]
v_mul_u32_u24 v25, 5120, v22
v_lshl_add_u32 v25, v23, 4, v25
v_mfma_f32_16x16x32_bf16 v[204:207], a[188:191], a[100:103], v[204:207]
ds_read_b64_tr_b16 a[60:61], v10 offset:0
v_add_u32 v25, s50, v25
v_mfma_f32_16x16x32_bf16 v[200:203], a[184:187], a[100:103], v[200:203]
v_accvgpr_write_b32 a235, v25
v_min_u32 v22, 1, v22
v_mfma_f32_16x16x32_bf16 v[224:227], a[80:83], a[184:187], v[224:227]
ds_read_b64_tr_b16 a[62:63], v10 offset:1536
v_lshlrev_b32 v22, 30, v22
v_mfma_f32_16x16x32_bf16 v[232:235], a[80:83], a[188:191], v[232:235]
buffer_load_dwordx4 v5, s[8:11], s97 offen  lds
v_mfma_f32_16x16x32_bf16 v[240:243], a[80:83], a[192:195], v[240:243]
v_add_u32 v25, v22, v1
v_accvgpr_write_b32 a236, v25
v_mfma_f32_16x16x32_bf16 v[248:251], a[80:83], a[196:199], v[248:251]
v_and_b32 v22, 1, v0
v_lshlrev_b32 v22, 6, v22
v_mfma_f32_16x16x32_bf16 v[252:255], a[84:87], a[196:199], v[252:255]
v_lshl_add_u32 v22, v20, 4, v22
v_lshrrev_b32 v23, 1, v21
v_mfma_f32_16x16x32_bf16 v[244:247], a[84:87], a[192:195], v[244:247]
v_add_u32 v23, s79, v23
v_min_u32 v23, 1, v23
v_mfma_f32_16x16x32_bf16 v[236:239], a[84:87], a[188:191], v[236:239]
s_waitcnt vmcnt(19) lgkmcnt(0)
v_lshl_add_u32 v25, v23, 30, v22
v_accvgpr_write_b32 a237, v25
v_mfma_f32_16x16x32_bf16 v[228:231], a[84:87], a[184:187], v[228:231]
s_barrier
v_lshrrev_b32 v21, 2, v21
v_lshl_add_u32 v21, v20, 2, v21
Lu28:
v_mfma_f32_16x16x32_bf16 v[76:79], a[0:3], a[172:175], v[76:79]
s_mov_b32 s93, 5505024
ds_read_b128 a[184:187], v8 offset:32768
s_add_u32 m0, s81, 114688
v_mfma_f32_16x16x32_bf16 v[104:107], a[0:3], a[176:179], v[104:107]
buffer_load_dwordx4 v3, s[8:11], s93 offen  lds
v_mfma_f32_16x16x32_bf16 v[132:135], a[0:3], a[180:183], v[132:135]
s_add_u32 m0, s81, 115712
ds_read_b64_tr_b16 a[28:29], v13 offset:16384
v_and_b32 v22, 3, v0
v_mfma_f32_16x16x32_bf16 v[48:51], a[0:3], a[168:171], v[48:51]
s_nop 0
ds_read_b64_tr_b16 a[30:31], v13 offset:18432
v_lshlrev_b32 v22, 3, v22
v_mfma_f32_16x16x32_bf16 v[52:55], a[4:7], a[168:171], v[52:55]
ds_read_b64_tr_b16 a[32:33], v14 offset:16384
v_lshl_add_u32 v22, v21, 8, v22
v_mfma_f32_16x16x32_bf16 v[136:139], a[4:7], a[180:183], v[136:139]
v_and_b32 v21, 7, v21
s_lshl_b32 s51, s76, 2
v_mfma_f32_16x16x32_bf16 v[108:111], a[4:7], a[176:179], v[108:111]
ds_read_b64_tr_b16 a[34:35], v14 offset:18432
v_xor_b32 v21, s51, v21
v_mfma_f32_16x16x32_bf16 v[80:83], a[4:7], a[172:175], v[80:83]
ds_read_b64_tr_b16 a[36:37], v15 offset:16384
v_xor_b32 v25, 0, v21
v_mfma_f32_16x16x32_bf16 v[84:87], a[8:11], a[172:175], v[84:87]
v_lshl_add_u32 v25, v25, 5, v22
v_accvgpr_write_b32 a238, v25
v_mfma_f32_16x16x32_bf16 v[112:115], a[8:11], a[176:179], v[112:115]
ds_read_b64_tr_b16 a[38:39], v15 offset:18432
v_xor_b32 v25, 1, v21
v_mfma_f32_16x16x32_bf16 v[140:143], a[8:11], a[180:183], v[140:143]
ds_read_b128 a[188:191], v8 offset:34816
v_lshl_add_u32 v25, v25, 5, v22
v_mfma_f32_16x16x32_bf16 v[56:59], a[8:11], a[168:171], v[56:59]
v_accvgpr_write_b32 a239, v25
v_xor_b32 v25, 2, v21
v_mfma_f32_16x16x32_bf16 v[60:63], a[12:15], a[168:171], v[60:63]
ds_read_b64_tr_b16 a[40:41], v16 offset:16384
v_lshl_add_u32 v25, v25, 5, v22
v_mfma_f32_16x16x32_bf16 v[144:147], a[12:15], a[180:183], v[144:147]
ds_read_b64_tr_b16 a[42:43], v16 offset:18432
v_accvgpr_write_b32 a240, v25
v_mfma_f32_16x16x32_bf16 v[116:119], a[12:15], a[176:179], v[116:119]
v_xor_b32 v25, 3, v21
v_lshl_add_u32 v25, v25, 5, v22
v_mfma_f32_16x16x32_bf16 v[88:91], a[12:15], a[172:175], v[88:91]
ds_read_b64_tr_b16 a[44:45], v17 offset:16384
v_accvgpr_write_b32 a241, v25
v_mfma_f32_16x16x32_bf16 v[92:95], a[16:19], a[172:175], v[92:95]
ds_read_b64_tr_b16 a[46:47], v17 offset:18432
v_xor_b32 v25, 4, v21
v_mfma_f32_16x16x32_bf16 v[120:123], a[16:19], a[176:179], v[120:123]
v_lshl_add_u32 v25, v25, 5, v22
v_accvgpr_write_b32 a242, v25
v_mfma_f32_16x16x32_bf16 v[148:151], a[16:19], a[180:183], v[148:151]
ds_read_b64_tr_b16 a[48:49], v18 offset:16384
v_xor_b32 v25, 5, v21
v_mfma_f32_16x16x32_bf16 v[64:67], a[16:19], a[168:171], v[64:67]
ds_read_b64_tr_b16 a[50:51], v18 offset:18432
v_lshl_add_u32 v25, v25, 5, v22
v_mfma_f32_16x16x32_bf16 v[68:71], a[20:23], a[168:171], v[68:71]
v_accvgpr_write_b32 a243, v25
v_xor_b32 v25, 6, v21
v_mfma_f32_16x16x32_bf16 v[152:155], a[20:23], a[180:183], v[152:155]
ds_read_b128 a[192:195], v8 offset:36864
v_lshl_add_u32 v25, v25, 5, v22
v_mfma_f32_16x16x32_bf16 v[124:127], a[20:23], a[176:179], v[124:127]
ds_read_b64_tr_b16 a[52:53], v19 offset:16384
v_accvgpr_write_b32 a244, v25
v_mfma_f32_16x16x32_bf16 v[96:99], a[20:23], a[172:175], v[96:99]
buffer_load_dwordx4 v4, s[8:11], s93 offen  lds
v_mfma_f32_16x16x32_bf16 v[100:103], a[24:27], a[172:175], v[100:103]
s_add_u32 m0, s81, 116736
ds_read_b64_tr_b16 a[54:55], v19 offset:18432
v_xor_b32 v25, 7, v21
v_mfma_f32_16x16x32_bf16 v[128:131], a[24:27], a[176:179], v[128:131]
ds_read_b64_tr_b16 a[88:89], v9 offset:12416
v_lshl_add_u32 v25, v25, 5, v22
v_mfma_f32_16x16x32_bf16 v[156:159], a[24:27], a[180:183], v[156:159]
v_accvgpr_write_b32 a245, v25
s_cmp_eq_u32 s84, 0
s_cselect_b32 s57, 0, s100
v_mfma_f32_16x16x32_bf16 v[72:75], a[24:27], a[168:171], v[72:75]
ds_read_b64_tr_b16 a[90:91], v9 offset:13952
v_mfma_f32_16x16x32_bf16 v[160:163], a[104:107], a[64:67], v[160:163]
ds_read_b64_tr_b16 a[92:93], v10 offset:12416
v_mfma_f32_16x16x32_bf16 v[164:167], a[108:111], a[64:67], v[164:167]
v_mfma_f32_16x16x32_bf16 v[176:179], a[112:115], a[64:67], v[176:179]
ds_read_b64_tr_b16 a[94:95], v10 offset:13952
v_mfma_f32_16x16x32_bf16 v[180:183], a[116:119], a[64:67], v[180:183]
ds_read_b128 a[196:199], v8 offset:38912
v_mfma_f32_16x16x32_bf16 v[188:191], a[116:119], a[68:71], v[188:191]
v_mfma_f32_16x16x32_bf16 v[184:187], a[112:115], a[68:71], v[184:187]
ds_read_b64_tr_b16 a[96:97], v9 offset:12544
v_mfma_f32_16x16x32_bf16 v[172:175], a[108:111], a[68:71], v[172:175]
ds_read_b64_tr_b16 a[98:99], v9 offset:14080
v_mfma_f32_16x16x32_bf16 v[168:171], a[104:107], a[68:71], v[168:171]
v_mfma_f32_16x16x32_bf16 v[192:195], a[104:107], a[72:75], v[192:195]
ds_read_b64_tr_b16 a[100:101], v10 offset:12544
v_mfma_f32_16x16x32_bf16 v[196:199], a[108:111], a[72:75], v[196:199]
ds_read_b64_tr_b16 a[102:103], v10 offset:14080
v_mfma_f32_16x16x32_bf16 v[208:211], a[112:115], a[72:75], v[208:211]
v_mfma_f32_16x16x32_bf16 v[212:215], a[116:119], a[72:75], v[212:215]
ds_read_b64_tr_b16 a[80:81], v9 offset:12288
v_mfma_f32_16x16x32_bf16 v[220:223], a[116:119], a[76:79], v[220:223]
ds_read_b64_tr_b16 a[82:83], v9 offset:13824
v_mfma_f32_16x16x32_bf16 v[216:219], a[112:115], a[76:79], v[216:219]
v_mfma_f32_16x16x32_bf16 v[204:207], a[108:111], a[76:79], v[204:207]
ds_read_b64_tr_b16 a[84:85], v10 offset:12288
v_mfma_f32_16x16x32_bf16 v[200:203], a[104:107], a[76:79], v[200:203]
v_mfma_f32_16x16x32_bf16 v[224:227], a[56:59], a[104:107], v[224:227]
ds_read_b64_tr_b16 a[86:87], v10 offset:13824
v_mfma_f32_16x16x32_bf16 v[232:235], a[56:59], a[108:111], v[232:235]
buffer_load_dwordx4 v5, s[8:11], s93 offen  lds
v_mfma_f32_16x16x32_bf16 v[240:243], a[56:59], a[112:115], v[240:243]
v_mfma_f32_16x16x32_bf16 v[248:251], a[56:59], a[116:119], v[248:251]
v_mfma_f32_16x16x32_bf16 v[252:255], a[60:63], a[116:119], v[252:255]
v_mfma_f32_16x16x32_bf16 v[244:247], a[60:63], a[112:115], v[244:247]
v_mfma_f32_16x16x32_bf16 v[236:239], a[60:63], a[108:111], v[236:239]
s_waitcnt vmcnt(11) lgkmcnt(0)
v_mfma_f32_16x16x32_bf16 v[228:231], a[60:63], a[104:107], v[228:231]
s_barrier
v_mfma_f32_16x16x32_bf16 v[76:79], a[28:31], a[188:191], v[76:79]
s_mov_b32 s94, 5701632
ds_read_b128 a[104:107], v7 offset:0
s_add_u32 m0, s81, 126976
v_mfma_f32_16x16x32_bf16 v[104:107], a[28:31], a[192:195], v[104:107]
buffer_load_dwordx4 v3, s[8:11], s94 offen  lds
v_mfma_f32_16x16x32_bf16 v[132:135], a[28:31], a[196:199], v[132:135]
s_add_u32 m0, s81, 128000
ds_read_b64_tr_b16 a[0:1], v13 offset:32768
v_mfma_f32_16x16x32_bf16 v[48:51], a[28:31], a[184:187], v[48:51]
ds_read_b64_tr_b16 a[2:3], v13 offset:34816
v_mfma_f32_16x16x32_bf16 v[52:55], a[32:35], a[184:187], v[52:55]
ds_read_b64_tr_b16 a[4:5], v14 offset:32768
v_mfma_f32_16x16x32_bf16 v[136:139], a[32:35], a[196:199], v[136:139]
v_mfma_f32_16x16x32_bf16 v[108:111], a[32:35], a[192:195], v[108:111]
ds_read_b64_tr_b16 a[6:7], v14 offset:34816
v_mfma_f32_16x16x32_bf16 v[80:83], a[32:35], a[188:191], v[80:83]
ds_read_b64_tr_b16 a[8:9], v15 offset:32768
v_mfma_f32_16x16x32_bf16 v[84:87], a[36:39], a[188:191], v[84:87]
buffer_load_dwordx4 v4, s[8:11], s94 offen  lds
v_mfma_f32_16x16x32_bf16 v[112:115], a[36:39], a[192:195], v[112:115]
s_add_u32 m0, s81, 129024
ds_read_b64_tr_b16 a[10:11], v15 offset:34816
v_mfma_f32_16x16x32_bf16 v[140:143], a[36:39], a[196:199], v[140:143]
ds_read_b128 a[108:111], v7 offset:2048
v_mfma_f32_16x16x32_bf16 v[56:59], a[36:39], a[184:187], v[56:59]
v_mfma_f32_16x16x32_bf16 v[60:63], a[40:43], a[184:187], v[60:63]
ds_read_b64_tr_b16 a[12:13], v16 offset:32768
v_mfma_f32_16x16x32_bf16 v[144:147], a[40:43], a[196:199], v[144:147]
ds_read_b64_tr_b16 a[14:15], v16 offset:34816
v_mfma_f32_16x16x32_bf16 v[116:119], a[40:43], a[192:195], v[116:119]
v_mfma_f32_16x16x32_bf16 v[88:91], a[40:43], a[188:191], v[88:91]
buffer_load_dwordx4 v5, s[8:11], s94 offen  lds
v_mfma_f32_16x16x32_bf16 v[92:95], a[44:47], a[188:191], v[92:95]
s_add_u32 s95, s48, 0
ds_read_b64_tr_b16 a[16:17], v17 offset:32768
ds_read_b64_tr_b16 a[18:19], v17 offset:34816
v_mfma_f32_16x16x32_bf16 v[120:123], a[44:47], a[192:195], v[120:123]
s_add_u32 m0, s82, 16384
v_mfma_f32_16x16x32_bf16 v[148:151], a[44:47], a[196:199], v[148:151]
ds_read_b64_tr_b16 a[20:21], v18 offset:32768
v_mfma_f32_16x16x32_bf16 v[64:67], a[44:47], a[184:187], v[64:67]
ds_read_b64_tr_b16 a[22:23], v18 offset:34816
v_mfma_f32_16x16x32_bf16 v[68:71], a[48:51], a[184:187], v[68:71]
v_mfma_f32_16x16x32_bf16 v[152:155], a[48:51], a[196:199], v[152:155]
ds_read_b128 a[112:115], v7 offset:4096
v_mfma_f32_16x16x32_bf16 v[124:127], a[48:51], a[192:195], v[124:127]
ds_read_b64_tr_b16 a[24:25], v19 offset:32768
v_mfma_f32_16x16x32_bf16 v[96:99], a[48:51], a[188:191], v[96:99]
buffer_load_dwordx4 v34, s[16:19], s95 offen lds
v_mfma_f32_16x16x32_bf16 v[100:103], a[52:55], a[188:191], v[100:103]
s_add_u32 m0, s82, 18432
ds_read_b64_tr_b16 a[26:27], v19 offset:34816
v_mfma_f32_16x16x32_bf16 v[128:131], a[52:55], a[192:195], v[128:131]
ds_read_b64_tr_b16 a[64:65], v9 offset:24704
v_mfma_f32_16x16x32_bf16 v[156:159], a[52:55], a[196:199], v[156:159]
v_mfma_f32_16x16x32_bf16 v[72:75], a[52:55], a[184:187], v[72:75]
ds_read_b64_tr_b16 a[66:67], v9 offset:26240
v_mfma_f32_16x16x32_bf16 v[160:163], a[120:123], a[88:91], v[160:163]
ds_read_b64_tr_b16 a[68:69], v10 offset:24704
v_mfma_f32_16x16x32_bf16 v[164:167], a[124:127], a[88:91], v[164:167]
s_nop 0
v_mfma_f32_16x16x32_bf16 v[176:179], a[128:131], a[88:91], v[176:179]
buffer_load_dwordx4 v35, s[16:19], s95 offen lds
v_mfma_f32_16x16x32_bf16 v[180:183], a[132:135], a[88:91], v[180:183]
s_add_u32 s96, s48, 262144
ds_read_b64_tr_b16 a[70:71], v10 offset:26240
ds_read_b128 a[116:119], v7 offset:6144
v_mfma_f32_16x16x32_bf16 v[188:191], a[132:135], a[92:95], v[188:191]
s_add_u32 m0, s82, 24576
v_mfma_f32_16x16x32_bf16 v[184:187], a[128:131], a[92:95], v[184:187]
ds_read_b64_tr_b16 a[72:73], v9 offset:24832
v_mfma_f32_16x16x32_bf16 v[172:175], a[124:127], a[92:95], v[172:175]
ds_read_b64_tr_b16 a[74:75], v9 offset:26368
v_mfma_f32_16x16x32_bf16 v[168:171], a[120:123], a[92:95], v[168:171]
v_mfma_f32_16x16x32_bf16 v[192:195], a[120:123], a[96:99], v[192:195]
ds_read_b64_tr_b16 a[76:77], v10 offset:24832
v_mfma_f32_16x16x32_bf16 v[196:199], a[124:127], a[96:99], v[196:199]
buffer_load_dwordx4 v34, s[16:19], s96 offen lds
v_mfma_f32_16x16x32_bf16 v[208:211], a[128:131], a[96:99], v[208:211]
s_add_u32 m0, s82, 26624
ds_read_b64_tr_b16 a[78:79], v10 offset:26368
v_mfma_f32_16x16x32_bf16 v[212:215], a[132:135], a[96:99], v[212:215]
ds_read_b64_tr_b16 a[56:57], v9 offset:24576
v_mfma_f32_16x16x32_bf16 v[220:223], a[132:135], a[100:103], v[220:223]
ds_read_b64_tr_b16 a[58:59], v9 offset:26112
v_mfma_f32_16x16x32_bf16 v[216:219], a[128:131], a[100:103], v[216:219]
v_mfma_f32_16x16x32_bf16 v[204:207], a[124:127], a[100:103], v[204:207]
ds_read_b64_tr_b16 a[60:61], v10 offset:24576
v_mfma_f32_16x16x32_bf16 v[200:203], a[120:123], a[100:103], v[200:203]
v_mfma_f32_16x16x32_bf16 v[224:227], a[80:83], a[120:123], v[224:227]
ds_read_b64_tr_b16 a[62:63], v10 offset:26112
v_mfma_f32_16x16x32_bf16 v[232:235], a[80:83], a[124:127], v[232:235]
buffer_load_dwordx4 v35, s[16:19], s96 offen lds
v_mfma_f32_16x16x32_bf16 v[240:243], a[80:83], a[128:131], v[240:243]
v_mfma_f32_16x16x32_bf16 v[248:251], a[80:83], a[132:135], v[248:251]
v_mfma_f32_16x16x32_bf16 v[252:255], a[84:87], a[132:135], v[252:255]
v_mfma_f32_16x16x32_bf16 v[244:247], a[84:87], a[128:131], v[244:247]
v_mfma_f32_16x16x32_bf16 v[236:239], a[84:87], a[124:127], v[236:239]
s_waitcnt vmcnt(10) lgkmcnt(0)
v_mfma_f32_16x16x32_bf16 v[228:231], a[84:87], a[120:123], v[228:231]
s_barrier
v_mfma_f32_16x16x32_bf16 v[76:79], a[0:3], a[108:111], v[76:79]
s_mov_b32 s97, 5898240
ds_read_b128 a[120:123], v8 offset:0
s_add_u32 m0, s81, 139264
v_mfma_f32_16x16x32_bf16 v[104:107], a[0:3], a[112:115], v[104:107]
buffer_load_dwordx4 v3, s[8:11], s97 offen  lds
v_mfma_f32_16x16x32_bf16 v[132:135], a[0:3], a[116:119], v[132:135]
s_add_u32 m0, s81, 140288
ds_read_b64_tr_b16 a[28:29], v13 offset:49152
v_mfma_f32_16x16x32_bf16 v[48:51], a[0:3], a[104:107], v[48:51]
ds_read_b64_tr_b16 a[30:31], v13 offset:51200
v_mfma_f32_16x16x32_bf16 v[52:55], a[4:7], a[104:107], v[52:55]
ds_read_b64_tr_b16 a[32:33], v14 offset:49152
v_mfma_f32_16x16x32_bf16 v[136:139], a[4:7], a[116:119], v[136:139]
v_mfma_f32_16x16x32_bf16 v[108:111], a[4:7], a[112:115], v[108:111]
ds_read_b64_tr_b16 a[34:35], v14 offset:51200
v_mfma_f32_16x16x32_bf16 v[80:83], a[4:7], a[108:111], v[80:83]
ds_read_b64_tr_b16 a[36:37], v15 offset:49152
v_mfma_f32_16x16x32_bf16 v[84:87], a[8:11], a[108:111], v[84:87]
buffer_load_dwordx4 v4, s[8:11], s97 offen  lds
v_mfma_f32_16x16x32_bf16 v[112:115], a[8:11], a[112:115], v[112:115]
s_add_u32 m0, s81, 141312
ds_read_b64_tr_b16 a[38:39], v15 offset:51200
v_mfma_f32_16x16x32_bf16 v[140:143], a[8:11], a[116:119], v[140:143]
ds_read_b128 a[124:127], v8 offset:2048
v_mfma_f32_16x16x32_bf16 v[56:59], a[8:11], a[104:107], v[56:59]
v_mfma_f32_16x16x32_bf16 v[60:63], a[12:15], a[104:107], v[60:63]
ds_read_b64_tr_b16 a[40:41], v16 offset:49152
v_mfma_f32_16x16x32_bf16 v[144:147], a[12:15], a[116:119], v[144:147]
ds_read_b64_tr_b16 a[42:43], v16 offset:51200
v_mfma_f32_16x16x32_bf16 v[116:119], a[12:15], a[112:115], v[116:119]
v_mfma_f32_16x16x32_bf16 v[88:91], a[12:15], a[108:111], v[88:91]
buffer_load_dwordx4 v5, s[8:11], s97 offen  lds
v_mfma_f32_16x16x32_bf16 v[92:95], a[16:19], a[108:111], v[92:95]
s_add_u32 s93, s48, 458752
ds_read_b64_tr_b16 a[44:45], v17 offset:49152
ds_read_b64_tr_b16 a[46:47], v17 offset:51200
v_mfma_f32_16x16x32_bf16 v[120:123], a[16:19], a[112:115], v[120:123]
s_add_u32 m0, s82, 32768
v_mfma_f32_16x16x32_bf16 v[148:151], a[16:19], a[116:119], v[148:151]
ds_read_b64_tr_b16 a[48:49], v18 offset:49152
v_mfma_f32_16x16x32_bf16 v[64:67], a[16:19], a[104:107], v[64:67]
ds_read_b64_tr_b16 a[50:51], v18 offset:51200
v_mfma_f32_16x16x32_bf16 v[68:71], a[20:23], a[104:107], v[68:71]
v_mfma_f32_16x16x32_bf16 v[152:155], a[20:23], a[116:119], v[152:155]
ds_read_b128 a[128:131], v8 offset:4096
v_mfma_f32_16x16x32_bf16 v[124:127], a[20:23], a[112:115], v[124:127]
ds_read_b64_tr_b16 a[52:53], v19 offset:49152
v_mfma_f32_16x16x32_bf16 v[96:99], a[20:23], a[108:111], v[96:99]
buffer_load_dwordx4 v34, s[16:19], s93 offen lds
v_mfma_f32_16x16x32_bf16 v[100:103], a[24:27], a[108:111], v[100:103]
s_add_u32 m0, s82, 34816
ds_read_b64_tr_b16 a[54:55], v19 offset:51200
v_mfma_f32_16x16x32_bf16 v[128:131], a[24:27], a[112:115], v[128:131]
ds_read_b64_tr_b16 a[88:89], v9 offset:36992
v_mfma_f32_16x16x32_bf16 v[156:159], a[24:27], a[116:119], v[156:159]
Lpad7:
s_cbranch_execz Lpadback0
s_nop 0
v_mfma_f32_16x16x32_bf16 v[72:75], a[24:27], a[104:107], v[72:75]
ds_read_b64_tr_b16 a[90:91], v9 offset:38528
v_mfma_f32_16x16x32_bf16 v[160:163], a[136:139], a[64:67], v[160:163]
ds_read_b64_tr_b16 a[92:93], v10 offset:36992
v_mfma_f32_16x16x32_bf16 v[164:167], a[140:143], a[64:67], v[164:167]
v_mfma_f32_16x16x32_bf16 v[176:179], a[144:147], a[64:67], v[176:179]
buffer_load_dwordx4 v35, s[16:19], s93 offen lds
v_mfma_f32_16x16x32_bf16 v[180:183], a[148:151], a[64:67], v[180:183]
s_add_u32 s94, s48, 720896
ds_read_b64_tr_b16 a[94:95], v10 offset:38528
ds_read_b128 a[132:135], v8 offset:6144
v_mfma_f32_16x16x32_bf16 v[188:191], a[148:151], a[68:71], v[188:191]
s_add_u32 m0, s82, 40960
v_mfma_f32_16x16x32_bf16 v[184:187], a[144:147], a[68:71], v[184:187]
ds_read_b64_tr_b16 a[96:97], v9 offset:37120
v_mfma_f32_16x16x32_bf16 v[172:175], a[140:143], a[68:71], v[172:175]
ds_read_b64_tr_b16 a[98:99], v9 offset:38656
v_mfma_f32_16x16x32_bf16 v[168:171], a[136:139], a[68:71], v[168:171]
v_mfma_f32_16x16x32_bf16 v[192:195], a[136:139], a[72:75], v[192:195]
ds_read_b64_tr_b16 a[100:101], v10 offset:37120
v_mfma_f32_16x16x32_bf16 v[196:199], a[140:143], a[72:75], v[196:199]
buffer_load_dwordx4 v34, s[16:19], s94 offen lds
v_mfma_f32_16x16x32_bf16 v[208:211], a[144:147], a[72:75], v[208:211]
s_add_u32 m0, s82, 43008
ds_read_b64_tr_b16 a[102:103], v10 offset:38656
v_mfma_f32_16x16x32_bf16 v[212:215], a[148:151], a[72:75], v[212:215]
ds_read_b64_tr_b16 a[80:81], v9 offset:36864
v_mfma_f32_16x16x32_bf16 v[220:223], a[148:151], a[76:79], v[220:223]
ds_read_b64_tr_b16 a[82:83], v9 offset:38400
v_mfma_f32_16x16x32_bf16 v[216:219], a[144:147], a[76:79], v[216:219]
v_mfma_f32_16x16x32_bf16 v[204:207], a[140:143], a[76:79], v[204:207]
ds_read_b64_tr_b16 a[84:85], v10 offset:36864
v_mfma_f32_16x16x32_bf16 v[200:203], a[136:139], a[76:79], v[200:203]
v_mfma_f32_16x16x32_bf16 v[224:227], a[56:59], a[136:139], v[224:227]
ds_read_b64_tr_b16 a[86:87], v10 offset:38400
v_mfma_f32_16x16x32_bf16 v[232:235], a[56:59], a[140:143], v[232:235]
buffer_load_dwordx4 v35, s[16:19], s94 offen lds
v_mfma_f32_16x16x32_bf16 v[240:243], a[56:59], a[144:147], v[240:243]
v_mfma_f32_16x16x32_bf16 v[248:251], a[56:59], a[148:151], v[248:251]
v_mfma_f32_16x16x32_bf16 v[252:255], a[60:63], a[148:151], v[252:255]
v_mfma_f32_16x16x32_bf16 v[244:247], a[60:63], a[144:147], v[244:247]
v_mfma_f32_16x16x32_bf16 v[236:239], a[60:63], a[140:143], v[236:239]
s_waitcnt vmcnt(14) lgkmcnt(0)
v_mfma_f32_16x16x32_bf16 v[228:231], a[60:63], a[136:139], v[228:231]
s_barrier
v_mfma_f32_16x16x32_bf16 v[76:79], a[28:31], a[124:127], v[76:79]
s_mov_b32 s95, 6094848
ds_read_b64_tr_b16 a[64:65], v9 offset:128
s_add_u32 m0, s81, 151552
v_mfma_f32_16x16x32_bf16 v[104:107], a[28:31], a[128:131], v[104:107]
buffer_load_dwordx4 v3, s[8:11], s95 offen  lds
v_mfma_f32_16x16x32_bf16 v[132:135], a[28:31], a[132:135], v[132:135]
s_add_u32 m0, s81, 152576
v_mfma_f32_16x16x32_bf16 v[48:51], a[28:31], a[120:123], v[48:51]
v_mfma_f32_16x16x32_bf16 v[52:55], a[32:35], a[120:123], v[52:55]
ds_read_b64_tr_b16 a[66:67], v9 offset:1664
v_mfma_f32_16x16x32_bf16 v[136:139], a[32:35], a[132:135], v[136:139]
v_mfma_f32_16x16x32_bf16 v[108:111], a[32:35], a[128:131], v[108:111]
v_mfma_f32_16x16x32_bf16 v[80:83], a[32:35], a[124:127], v[80:83]
v_mfma_f32_16x16x32_bf16 v[84:87], a[36:39], a[124:127], v[84:87]
buffer_load_dwordx4 v4, s[8:11], s95 offen  lds
v_mfma_f32_16x16x32_bf16 v[112:115], a[36:39], a[128:131], v[112:115]
s_add_u32 m0, s81, 153600
ds_read_b64_tr_b16 a[68:69], v10 offset:128
v_mfma_f32_16x16x32_bf16 v[140:143], a[36:39], a[132:135], v[140:143]
v_mfma_f32_16x16x32_bf16 v[56:59], a[36:39], a[120:123], v[56:59]
v_mfma_f32_16x16x32_bf16 v[60:63], a[40:43], a[120:123], v[60:63]
ds_read_b64_tr_b16 a[70:71], v10 offset:1664
v_mfma_f32_16x16x32_bf16 v[144:147], a[40:43], a[132:135], v[144:147]
v_mfma_f32_16x16x32_bf16 v[116:119], a[40:43], a[128:131], v[116:119]
v_mfma_f32_16x16x32_bf16 v[88:91], a[40:43], a[124:127], v[88:91]
buffer_load_dwordx4 v5, s[8:11], s95 offen  lds
v_mfma_f32_16x16x32_bf16 v[92:95], a[44:47], a[124:127], v[92:95]
s_add_u32 s96, s48, 917504
ds_read_b64_tr_b16 a[72:73], v9 offset:256
s_add_u32 m0, s82, 49152
v_mfma_f32_16x16x32_bf16 v[120:123], a[44:47], a[128:131], v[120:123]
v_mfma_f32_16x16x32_bf16 v[148:151], a[44:47], a[132:135], v[148:151]
v_mfma_f32_16x16x32_bf16 v[64:67], a[44:47], a[120:123], v[64:67]
v_mfma_f32_16x16x32_bf16 v[68:71], a[48:51], a[120:123], v[68:71]
ds_read_b64_tr_b16 a[74:75], v9 offset:1792
v_mfma_f32_16x16x32_bf16 v[152:155], a[48:51], a[132:135], v[152:155]
v_mfma_f32_16x16x32_bf16 v[124:127], a[48:51], a[128:131], v[124:127]
v_mfma_f32_16x16x32_bf16 v[96:99], a[48:51], a[124:127], v[96:99]
buffer_load_dwordx4 v34, s[16:19], s96 offen lds
v_mfma_f32_16x16x32_bf16 v[100:103], a[52:55], a[124:127], v[100:103]
s_add_u32 m0, s82, 51200
ds_read_b64_tr_b16 a[76:77], v10 offset:256
v_mfma_f32_16x16x32_bf16 v[128:131], a[52:55], a[128:131], v[128:131]
v_mfma_f32_16x16x32_bf16 v[156:159], a[52:55], a[132:135], v[156:159]
v_mfma_f32_16x16x32_bf16 v[72:75], a[52:55], a[120:123], v[72:75]
v_mfma_f32_16x16x32_bf16 v[160:163], a[152:155], a[88:91], v[160:163]
ds_read_b64_tr_b16 a[78:79], v10 offset:1792
v_mfma_f32_16x16x32_bf16 v[164:167], a[156:159], a[88:91], v[164:167]
v_mfma_f32_16x16x32_bf16 v[176:179], a[160:163], a[88:91], v[176:179]
buffer_load_dwordx4 v35, s[16:19], s96 offen lds
v_mfma_f32_16x16x32_bf16 v[180:183], a[164:167], a[88:91], v[180:183]
s_add_u32 s97, s48, 1179648
s_add_u32 m0, s82, 57344
v_mfma_f32_16x16x32_bf16 v[188:191], a[164:167], a[92:95], v[188:191]
ds_read_b64_tr_b16 a[56:57], v9 offset:0
v_mfma_f32_16x16x32_bf16 v[184:187], a[160:163], a[92:95], v[184:187]
v_mfma_f32_16x16x32_bf16 v[172:175], a[156:159], a[92:95], v[172:175]
v_mfma_f32_16x16x32_bf16 v[168:171], a[152:155], a[92:95], v[168:171]
v_mfma_f32_16x16x32_bf16 v[192:195], a[152:155], a[96:99], v[192:195]
ds_read_b64_tr_b16 a[58:59], v9 offset:1536
v_mfma_f32_16x16x32_bf16 v[196:199], a[156:159], a[96:99], v[196:199]
buffer_load_dwordx4 v34, s[16:19], s97 offen lds
v_mfma_f32_16x16x32_bf16 v[208:211], a[160:163], a[96:99], v[208:211]
s_add_u32 m0, s82, 59392
v_mfma_f32_16x16x32_bf16 v[212:215], a[164:167], a[96:99], v[212:215]
v_mfma_f32_16x16x32_bf16 v[220:223], a[164:167], a[100:103], v[220:223]
ds_read_b64_tr_b16 a[60:61], v10 offset:0
v_mfma_f32_16x16x32_bf16 v[216:219], a[160:163], a[100:103], v[216:219]
v_mfma_f32_16x16x32_bf16 v[204:207], a[156:159], a[100:103], v[204:207]
v_mfma_f32_16x16x32_bf16 v[200:203], a[152:155], a[100:103], v[200:203]
v_mfma_f32_16x16x32_bf16 v[224:227], a[80:83], a[152:155], v[224:227]
ds_read_b64_tr_b16 a[62:63], v10 offset:1536
v_mfma_f32_16x16x32_bf16 v[232:235], a[80:83], a[156:159], v[232:235]
buffer_load_dwordx4 v35, s[16:19], s97 offen lds
v_mfma_f32_16x16x32_bf16 v[240:243], a[80:83], a[160:163], v[240:243]
v_mfma_f32_16x16x32_bf16 v[248:251], a[80:83], a[164:167], v[248:251]
v_mfma_f32_16x16x32_bf16 v[252:255], a[84:87], a[164:167], v[252:255]
v_mfma_f32_16x16x32_bf16 v[244:247], a[84:87], a[160:163], v[244:247]
v_mfma_f32_16x16x32_bf16 v[236:239], a[84:87], a[156:159], v[236:239]
s_waitcnt vmcnt(18) lgkmcnt(0)
v_mfma_f32_16x16x32_bf16 v[228:231], a[84:87], a[152:155], v[228:231]
s_barrier
Lu32:
v_mfma_f32_16x16x32_bf16 v[160:163], a[168:171], a[64:67], v[160:163]
s_add_u32 s93, s48, 1376256
ds_read_b64_tr_b16 a[88:89], v9 offset:12416
s_add_u32 m0, s82, 65536
v_mov_b32 v21, 0xbdd2d3e8
v_mfma_f32_16x16x32_bf16 v[164:167], a[172:175], a[64:67], v[164:167]
buffer_load_dwordx4 v34, s[16:19], s93 offen lds
ds_read_b64_tr_b16 a[90:91], v9 offset:13952
v_mfma_f32_16x16x32_bf16 v[176:179], a[176:179], a[64:67], v[176:179]
s_add_u32 m0, s82, 67584
ds_read_b64_tr_b16 a[92:93], v10 offset:12416
v_mul_f32 v13, v48, v48
v_mul_f32 v14, v49, v49
v_mfma_f32_16x16x32_bf16 v[180:183], a[180:183], a[64:67], v[180:183]
v_mul_f32 v15, v50, v50
v_mul_f32 v16, v51, v51
v_fmaak_f32 v13, v21, v13, 0xc0135761
v_mfma_f32_16x16x32_bf16 v[188:191], a[180:183], a[68:71], v[188:191]
buffer_load_dwordx4 v35, s[16:19], s93 offen lds
ds_read_b64_tr_b16 a[94:95], v10 offset:13952
v_mfma_f32_16x16x32_bf16 v[184:187], a[176:179], a[68:71], v[184:187]
s_add_u32 s94, s48, 1638400
ds_read_b64_tr_b16 a[96:97], v9 offset:12544
s_add_u32 m0, s82, 73728
v_fmaak_f32 v14, v21, v14, 0xc0135761
v_mfma_f32_16x16x32_bf16 v[172:175], a[172:175], a[68:71], v[172:175]
v_fmaak_f32 v15, v21, v15, 0xc0135761
v_fmaak_f32 v16, v21, v16, 0xc0135761
v_mul_f32 v13, v13, v48
v_mfma_f32_16x16x32_bf16 v[168:171], a[168:171], a[68:71], v[168:171]
ds_read_b64_tr_b16 a[98:99], v9 offset:14080
v_exp_f32 v13, v13
v_mfma_f32_16x16x32_bf16 v[192:195], a[168:171], a[72:75], v[192:195]
buffer_load_dwordx4 v34, s[16:19], s94 offen lds
ds_read_b64_tr_b16 a[100:101], v10 offset:12544
v_mfma_f32_16x16x32_bf16 v[196:199], a[172:175], a[72:75], v[196:199]
s_add_u32 m0, s82, 75776
v_mul_f32 v14, v14, v49
v_exp_f32 v14, v14
v_mfma_f32_16x16x32_bf16 v[208:211], a[176:179], a[72:75], v[208:211]
ds_read_b64_tr_b16 a[102:103], v10 offset:14080
v_mul_f32 v15, v15, v50
v_mul_f32 v16, v16, v51
v_mfma_f32_16x16x32_bf16 v[212:215], a[180:183], a[72:75], v[212:215]
buffer_load_dwordx4 v35, s[16:19], s94 offen lds
ds_read_b64_tr_b16 a[80:81], v9 offset:12288
v_mfma_f32_16x16x32_bf16 v[220:223], a[180:183], a[76:79], v[220:223]
s_add_u32 s95, s48, 1835008
s_add_u32 m0, s82, 81920
v_exp_f32 v15, v15
v_mfma_f32_16x16x32_bf16 v[216:219], a[176:179], a[76:79], v[216:219]
ds_read_b64_tr_b16 a[82:83], v9 offset:13824
v_exp_f32 v16, v16
v_mfma_f32_16x16x32_bf16 v[204:207], a[172:175], a[76:79], v[204:207]
ds_read_b64_tr_b16 a[84:85], v10 offset:12288
v_add_f32 v13, 1.0, v13
v_add_f32 v14, 1.0, v14
v_mfma_f32_16x16x32_bf16 v[200:203], a[168:171], a[76:79], v[200:203]
buffer_load_dwordx4 v34, s[16:19], s95 offen lds
s_add_u32 m0, s82, 83968
v_mfma_f32_16x16x32_bf16 v[224:227], a[56:59], a[168:171], v[224:227]
ds_read_b64_tr_b16 a[86:87], v10 offset:13824
v_rcp_f32 v13, v13
v_mfma_f32_16x16x32_bf16 v[232:235], a[56:59], a[172:175], v[232:235]
v_rcp_f32 v14, v14
v_add_f32 v15, 1.0, v15
v_mfma_f32_16x16x32_bf16 v[240:243], a[56:59], a[176:179], v[240:243]
v_rcp_f32 v15, v15
v_add_f32 v16, 1.0, v16
v_mfma_f32_16x16x32_bf16 v[248:251], a[56:59], a[180:183], v[248:251]
buffer_load_dwordx4 v35, s[16:19], s95 offen lds
v_mul_f32 v48, v48, v13
v_mfma_f32_16x16x32_bf16 v[252:255], a[60:63], a[180:183], v[252:255]
v_rcp_f32 v16, v16
v_mul_f32 v49, v49, v14
v_mfma_f32_16x16x32_bf16 v[244:247], a[60:63], a[176:179], v[244:247]
v_mul_f32 v50, v50, v15
v_mul_f32 v51, v51, v16
v_mul_f32 v17, v52, v52
v_mfma_f32_16x16x32_bf16 v[236:239], a[60:63], a[172:175], v[236:239]
s_waitcnt vmcnt(17) lgkmcnt(0)
v_mul_f32 v18, v53, v53
v_mul_f32 v19, v54, v54
v_mul_f32 v20, v55, v55
v_mfma_f32_16x16x32_bf16 v[228:231], a[60:63], a[168:171], v[228:231]
s_barrier
v_fmaak_f32 v17, v21, v17, 0xc0135761
v_fmaak_f32 v18, v21, v18, 0xc0135761
v_fmaak_f32 v19, v21, v19, 0xc0135761
v_mfma_f32_16x16x32_bf16 v[160:163], a[184:187], a[88:91], v[160:163]
s_add_u32 s96, s48, 2097152
ds_read_b64_tr_b16 a[64:65], v9 offset:24704
s_add_u32 m0, s82, 90112
v_fmaak_f32 v20, v21, v20, 0xc0135761
v_mfma_f32_16x16x32_bf16 v[164:167], a[188:191], a[88:91], v[164:167]
buffer_load_dwordx4 v34, s[16:19], s96 offen lds
ds_read_b64_tr_b16 a[66:67], v9 offset:26240
v_mfma_f32_16x16x32_bf16 v[176:179], a[192:195], a[88:91], v[176:179]
s_add_u32 m0, s82, 92160
ds_read_b64_tr_b16 a[68:69], v10 offset:24704
v_mul_f32 v17, v17, v52
v_mul_f32 v18, v18, v53
v_mfma_f32_16x16x32_bf16 v[180:183], a[196:199], a[88:91], v[180:183]
v_exp_f32 v17, v17
v_mul_f32 v19, v19, v54
v_mfma_f32_16x16x32_bf16 v[188:191], a[196:199], a[92:95], v[188:191]
buffer_load_dwordx4 v35, s[16:19], s96 offen lds
ds_read_b64_tr_b16 a[70:71], v10 offset:26240
v_mfma_f32_16x16x32_bf16 v[184:187], a[192:195], a[92:95], v[184:187]
s_add_u32 s97, s48, 2293760
ds_read_b64_tr_b16 a[72:73], v9 offset:24832
s_add_u32 m0, s82, 98304
v_mul_f32 v20, v20, v55
v_mfma_f32_16x16x32_bf16 v[172:175], a[188:191], a[92:95], v[172:175]
v_exp_f32 v18, v18
v_add_f32 v17, 1.0, v17
v_mfma_f32_16x16x32_bf16 v[168:171], a[184:187], a[92:95], v[168:171]
ds_read_b64_tr_b16 a[74:75], v9 offset:26368
v_exp_f32 v19, v19
v_mfma_f32_16x16x32_bf16 v[192:195], a[184:187], a[96:99], v[192:195]
buffer_load_dwordx4 v34, s[16:19], s97 offen lds
ds_read_b64_tr_b16 a[76:77], v10 offset:24832
v_mfma_f32_16x16x32_bf16 v[196:199], a[188:191], a[96:99], v[196:199]
s_add_u32 m0, s82, 100352
v_exp_f32 v20, v20
v_add_f32 v18, 1.0, v18
v_mfma_f32_16x16x32_bf16 v[208:211], a[192:195], a[96:99], v[208:211]
ds_read_b64_tr_b16 a[78:79], v10 offset:26368
v_rcp_f32 v17, v17
v_mfma_f32_16x16x32_bf16 v[212:215], a[196:199], a[96:99], v[212:215]
buffer_load_dwordx4 v35, s[16:19], s97 offen lds
ds_read_b64_tr_b16 a[56:57], v9 offset:24576
v_mfma_f32_16x16x32_bf16 v[220:223], a[196:199], a[100:103], v[220:223]
s_add_u32 s93, s48, 2555904
s_add_u32 m0, s82, 106496
v_rcp_f32 v18, v18
v_mfma_f32_16x16x32_bf16 v[216:219], a[192:195], a[100:103], v[216:219]
ds_read_b64_tr_b16 a[58:59], v9 offset:26112
v_add_f32 v19, 1.0, v19
v_add_f32 v20, 1.0, v20
v_mfma_f32_16x16x32_bf16 v[204:207], a[188:191], a[100:103], v[204:207]
ds_read_b64_tr_b16 a[60:61], v10 offset:24576
v_rcp_f32 v19, v19
v_mfma_f32_16x16x32_bf16 v[200:203], a[184:187], a[100:103], v[200:203]
buffer_load_dwordx4 v34, s[16:19], s93 offen lds
s_add_u32 m0, s82, 108544
v_mfma_f32_16x16x32_bf16 v[224:227], a[80:83], a[184:187], v[224:227]
ds_read_b64_tr_b16 a[62:63], v10 offset:26112
v_rcp_f32 v20, v20
v_mfma_f32_16x16x32_bf16 v[232:235], a[80:83], a[188:191], v[232:235]
v_mul_f32 v52, v52, v17
v_mul_f32 v53, v53, v18
v_mul_f32 v54, v54, v19
v_mfma_f32_16x16x32_bf16 v[240:243], a[80:83], a[192:195], v[240:243]
v_mul_f32 v55, v55, v20
v_cvt_pk_bf16_f32 v48, v48, v49
v_cvt_pk_bf16_f32 v49, v50, v51
v_mfma_f32_16x16x32_bf16 v[248:251], a[80:83], a[196:199], v[248:251]
buffer_load_dwordx4 v35, s[16:19], s93 offen lds
v_cvt_pk_bf16_f32 v50, v52, v53
v_mfma_f32_16x16x32_bf16 v[252:255], a[84:87], a[196:199], v[252:255]
v_cvt_pk_bf16_f32 v51, v54, v55
v_mul_f32 v13, v76, v76
v_mul_f32 v14, v77, v77
v_mfma_f32_16x16x32_bf16 v[244:247], a[84:87], a[192:195], v[244:247]
buffer_store_dwordx4 v[48:51], v32, s[24:27], 0 offen offset:0 sc1
v_mul_f32 v15, v78, v78
v_mfma_f32_16x16x32_bf16 v[236:239], a[84:87], a[188:191], v[236:239]
s_waitcnt vmcnt(17) lgkmcnt(0)
v_mul_f32 v16, v79, v79
v_fmaak_f32 v13, v21, v13, 0xc0135761
v_fmaak_f32 v14, v21, v14, 0xc0135761
v_mfma_f32_16x16x32_bf16 v[228:231], a[84:87], a[184:187], v[228:231]
s_barrier
v_fmaak_f32 v15, v21, v15, 0xc0135761
v_fmaak_f32 v16, v21, v16, 0xc0135761
v_mul_f32 v13, v13, v76
v_mfma_f32_16x16x32_bf16 v[160:163], a[104:107], a[64:67], v[160:163]
ds_read_b64_tr_b16 a[88:89], v9 offset:36992
v_exp_f32 v13, v13
v_mfma_f32_16x16x32_bf16 v[164:167], a[108:111], a[64:67], v[164:167]
ds_read_b64_tr_b16 a[90:91], v9 offset:38528
v_mul_f32 v14, v14, v77
v_mul_f32 v15, v15, v78
v_mfma_f32_16x16x32_bf16 v[176:179], a[112:115], a[64:67], v[176:179]
ds_read_b64_tr_b16 a[92:93], v10 offset:36992
v_exp_f32 v14, v14
v_mfma_f32_16x16x32_bf16 v[180:183], a[116:119], a[64:67], v[180:183]
v_exp_f32 v15, v15
v_mul_f32 v16, v16, v79
v_mfma_f32_16x16x32_bf16 v[188:191], a[116:119], a[68:71], v[188:191]
ds_read_b64_tr_b16 a[94:95], v10 offset:38528
v_exp_f32 v16, v16
v_mfma_f32_16x16x32_bf16 v[184:187], a[112:115], a[68:71], v[184:187]
ds_read_b64_tr_b16 a[96:97], v9 offset:37120
v_add_f32 v13, 1.0, v13
v_add_f32 v14, 1.0, v14
v_mfma_f32_16x16x32_bf16 v[172:175], a[108:111], a[68:71], v[172:175]
v_rcp_f32 v13, v13
v_add_f32 v15, 1.0, v15
v_mfma_f32_16x16x32_bf16 v[168:171], a[104:107], a[68:71], v[168:171]
ds_read_b64_tr_b16 a[98:99], v9 offset:38656
v_rcp_f32 v14, v14
v_mfma_f32_16x16x32_bf16 v[192:195], a[104:107], a[72:75], v[192:195]
ds_read_b64_tr_b16 a[100:101], v10 offset:37120
v_rcp_f32 v15, v15
v_mfma_f32_16x16x32_bf16 v[196:199], a[108:111], a[72:75], v[196:199]
v_add_f32 v16, 1.0, v16
v_rcp_f32 v16, v16
v_mfma_f32_16x16x32_bf16 v[208:211], a[112:115], a[72:75], v[208:211]
ds_read_b64_tr_b16 a[102:103], v10 offset:38656
v_mul_f32 v76, v76, v13
v_mul_f32 v77, v77, v14
v_mfma_f32_16x16x32_bf16 v[212:215], a[116:119], a[72:75], v[212:215]
ds_read_b64_tr_b16 a[80:81], v9 offset:36864
v_mul_f32 v78, v78, v15
v_mul_f32 v79, v79, v16
v_mfma_f32_16x16x32_bf16 v[220:223], a[116:119], a[76:79], v[220:223]
v_mul_f32 v17, v80, v80
v_mul_f32 v18, v81, v81
v_mul_f32 v19, v82, v82
v_mfma_f32_16x16x32_bf16 v[216:219], a[112:115], a[76:79], v[216:219]
ds_read_b64_tr_b16 a[82:83], v9 offset:38400
v_mul_f32 v20, v83, v83
v_fmaak_f32 v17, v21, v17, 0xc0135761
v_mfma_f32_16x16x32_bf16 v[204:207], a[108:111], a[76:79], v[204:207]
ds_read_b64_tr_b16 a[84:85], v10 offset:36864
v_fmaak_f32 v18, v21, v18, 0xc0135761
v_fmaak_f32 v19, v21, v19, 0xc0135761
v_mfma_f32_16x16x32_bf16 v[200:203], a[104:107], a[76:79], v[200:203]
v_fmaak_f32 v20, v21, v20, 0xc0135761
v_mul_f32 v17, v17, v80
v_mul_f32 v18, v18, v81
v_mfma_f32_16x16x32_bf16 v[224:227], a[56:59], a[104:107], v[224:227]
ds_read_b64_tr_b16 a[86:87], v10 offset:38400
v_exp_f32 v17, v17
v_mfma_f32_16x16x32_bf16 v[232:235], a[56:59], a[108:111], v[232:235]
v_exp_f32 v18, v18
v_mul_f32 v19, v19, v82
v_mfma_f32_16x16x32_bf16 v[240:243], a[56:59], a[112:115], v[240:243]
v_exp_f32 v19, v19
v_mul_f32 v20, v20, v83
v_mfma_f32_16x16x32_bf16 v[248:251], a[56:59], a[116:119], v[248:251]
v_exp_f32 v20, v20
v_add_f32 v17, 1.0, v17
v_mfma_f32_16x16x32_bf16 v[252:255], a[60:63], a[116:119], v[252:255]
v_rcp_f32 v17, v17
v_add_f32 v18, 1.0, v18
v_mfma_f32_16x16x32_bf16 v[244:247], a[60:63], a[112:115], v[244:247]
v_rcp_f32 v18, v18
v_add_f32 v19, 1.0, v19
v_mfma_f32_16x16x32_bf16 v[236:239], a[60:63], a[108:111], v[236:239]
s_waitcnt lgkmcnt(0)
v_rcp_f32 v19, v19
v_add_f32 v20, 1.0, v20
v_mfma_f32_16x16x32_bf16 v[228:231], a[60:63], a[104:107], v[228:231]
s_barrier
v_rcp_f32 v20, v20
v_mul_f32 v80, v80, v17
v_mfma_f32_16x16x32_bf16 v[160:163], a[120:123], a[88:91], v[160:163]
v_mul_f32 v81, v81, v18
v_mul_f32 v82, v82, v19
v_mul_f32 v83, v83, v20
v_mfma_f32_16x16x32_bf16 v[164:167], a[124:127], a[88:91], v[164:167]
v_cvt_pk_bf16_f32 v76, v76, v77
v_cvt_pk_bf16_f32 v77, v78, v79
v_cvt_pk_bf16_f32 v78, v80, v81
v_mfma_f32_16x16x32_bf16 v[176:179], a[128:131], a[88:91], v[176:179]
v_cvt_pk_bf16_f32 v79, v82, v83
v_mul_f32 v13, v104, v104
v_mul_f32 v14, v105, v105
v_mfma_f32_16x16x32_bf16 v[180:183], a[132:135], a[88:91], v[180:183]
buffer_store_dwordx4 v[76:79], v32, s[24:27], s36 offen offset:0 sc1
v_mul_f32 v15, v106, v106
v_mfma_f32_16x16x32_bf16 v[188:191], a[132:135], a[92:95], v[188:191]
v_mul_f32 v16, v107, v107
v_fmaak_f32 v13, v21, v13, 0xc0135761
v_fmaak_f32 v14, v21, v14, 0xc0135761
v_mfma_f32_16x16x32_bf16 v[184:187], a[128:131], a[92:95], v[184:187]
v_fmaak_f32 v15, v21, v15, 0xc0135761
v_fmaak_f32 v16, v21, v16, 0xc0135761
v_mul_f32 v13, v13, v104
v_mfma_f32_16x16x32_bf16 v[172:175], a[124:127], a[92:95], v[172:175]
v_exp_f32 v13, v13
v_mul_f32 v14, v14, v105
v_mfma_f32_16x16x32_bf16 v[168:171], a[120:123], a[92:95], v[168:171]
v_exp_f32 v14, v14
v_mul_f32 v15, v15, v106
v_mfma_f32_16x16x32_bf16 v[192:195], a[120:123], a[96:99], v[192:195]
v_exp_f32 v15, v15
v_mul_f32 v16, v16, v107
v_mfma_f32_16x16x32_bf16 v[196:199], a[124:127], a[96:99], v[196:199]
v_exp_f32 v16, v16
v_add_f32 v13, 1.0, v13
v_mfma_f32_16x16x32_bf16 v[208:211], a[128:131], a[96:99], v[208:211]
v_rcp_f32 v13, v13
v_add_f32 v14, 1.0, v14
v_mfma_f32_16x16x32_bf16 v[212:215], a[132:135], a[96:99], v[212:215]
v_rcp_f32 v14, v14
v_add_f32 v15, 1.0, v15
v_mfma_f32_16x16x32_bf16 v[220:223], a[132:135], a[100:103], v[220:223]
v_rcp_f32 v15, v15
v_add_f32 v16, 1.0, v16
v_mfma_f32_16x16x32_bf16 v[216:219], a[128:131], a[100:103], v[216:219]
v_rcp_f32 v16, v16
v_mul_f32 v104, v104, v13
v_mfma_f32_16x16x32_bf16 v[204:207], a[124:127], a[100:103], v[204:207]
v_mul_f32 v105, v105, v14
v_mul_f32 v106, v106, v15
v_mul_f32 v107, v107, v16
v_mfma_f32_16x16x32_bf16 v[200:203], a[120:123], a[100:103], v[200:203]
v_mul_f32 v17, v108, v108
v_mul_f32 v18, v109, v109
v_mul_f32 v19, v110, v110
v_mfma_f32_16x16x32_bf16 v[224:227], a[80:83], a[120:123], v[224:227]
v_mul_f32 v20, v111, v111
v_fmaak_f32 v17, v21, v17, 0xc0135761
v_fmaak_f32 v18, v21, v18, 0xc0135761
v_mfma_f32_16x16x32_bf16 v[232:235], a[80:83], a[124:127], v[232:235]
v_fmaak_f32 v19, v21, v19, 0xc0135761
v_fmaak_f32 v20, v21, v20, 0xc0135761
v_mul_f32 v17, v17, v108
v_mfma_f32_16x16x32_bf16 v[240:243], a[80:83], a[128:131], v[240:243]
v_exp_f32 v17, v17
v_mul_f32 v18, v18, v109
v_mfma_f32_16x16x32_bf16 v[248:251], a[80:83], a[132:135], v[248:251]
v_exp_f32 v18, v18
v_mul_f32 v19, v19, v110
v_mfma_f32_16x16x32_bf16 v[252:255], a[84:87], a[132:135], v[252:255]
v_exp_f32 v19, v19
v_mul_f32 v20, v20, v111
v_mfma_f32_16x16x32_bf16 v[244:247], a[84:87], a[128:131], v[244:247]
v_exp_f32 v20, v20
v_add_f32 v17, 1.0, v17
v_mfma_f32_16x16x32_bf16 v[236:239], a[84:87], a[124:127], v[236:239]
s_nop 0
v_rcp_f32 v17, v17
v_add_f32 v18, 1.0, v18
v_mfma_f32_16x16x32_bf16 v[228:231], a[84:87], a[120:123], v[228:231]
s_barrier
v_rcp_f32 v18, v18
v_add_f32 v19, 1.0, v19
v_add_f32 v20, 1.0, v20
v_rcp_f32 v19, v19
v_rcp_f32 v20, v20
v_mul_f32 v108, v108, v17
v_mul_f32 v109, v109, v18
v_mul_f32 v110, v110, v19
v_mul_f32 v111, v111, v20
v_cvt_pk_bf16_f32 v104, v104, v105
v_cvt_pk_bf16_f32 v105, v106, v107
v_cvt_pk_bf16_f32 v106, v108, v109
v_cvt_pk_bf16_f32 v107, v110, v111
buffer_store_dwordx4 v[104:107], v32, s[24:27], s37 offen offset:0 sc1
Lbub:
v_mov_b32 v28, 0
v_mov_b32 v8, 0xc0135761
v_mov_b32 v9, v8
v_mov_b32 v10, 0xbdd2d3e8
v_mov_b32 v11, v10
v_mov_b32 v4, 0x3f800000
v_mov_b32 v5, v4
v_mov_b32 v2, 0x3fb8aa3b
v_mov_b32 v3, v2
v_mov_b32 v6, 0x358637bd
v_mov_b32 v7, v6
s_add_u32 s94, s48, 2752512
s_add_u32 m0, s82, 114688
s_nop 0
buffer_load_dwordx4 v34, s[16:19], s94 offen lds
s_add_u32 m0, s82, 116736
s_nop 0
buffer_load_dwordx4 v35, s[16:19], s94 offen lds
s_add_u32 s95, s48, 3014656
s_add_u32 m0, s82, 122880
s_nop 0
buffer_load_dwordx4 v34, s[16:19], s95 offen lds
s_add_u32 m0, s82, 124928
s_nop 0
buffer_load_dwordx4 v35, s[16:19], s95 offen lds
s_add_u32 s96, s48, 3211264
s_add_u32 m0, s82, 0
s_nop 0
buffer_load_dwordx4 v34, s[16:19], s96 offen lds
s_add_u32 m0, s82, 2048
s_nop 0
buffer_load_dwordx4 v35, s[16:19], s96 offen lds
v_pk_mul_f32 v[14:15], v[132:133], v[132:133]
v_pk_mul_f32 v[16:17], v[134:135], v[134:135]
v_pk_mul_f32 v[18:19], v[136:137], v[136:137]
v_pk_mul_f32 v[20:21], v[138:139], v[138:139]
v_pk_fma_f32 v[14:15], v[14:15], v[10:11], v[8:9]
v_pk_fma_f32 v[16:17], v[16:17], v[10:11], v[8:9]
v_pk_fma_f32 v[18:19], v[18:19], v[10:11], v[8:9]
v_pk_fma_f32 v[20:21], v[20:21], v[10:11], v[8:9]
v_pk_mul_f32 v[14:15], v[14:15], v[132:133]
v_pk_mul_f32 v[16:17], v[16:17], v[134:135]
v_pk_mul_f32 v[18:19], v[18:19], v[136:137]
v_pk_mul_f32 v[20:21], v[20:21], v[138:139]
v_exp_f32 v14, v14
v_exp_f32 v15, v15
v_exp_f32 v16, v16
v_exp_f32 v17, v17
v_exp_f32 v18, v18
v_exp_f32 v19, v19
v_exp_f32 v20, v20
v_exp_f32 v21, v21
v_pk_add_f32 v[14:15], v[14:15], v[4:5]
v_pk_add_f32 v[16:17], v[16:17], v[4:5]
v_pk_add_f32 v[18:19], v[18:19], v[4:5]
v_pk_add_f32 v[20:21], v[20:21], v[4:5]
v_rcp_f32 v14, v14
v_rcp_f32 v15, v15
v_rcp_f32 v16, v16
v_rcp_f32 v17, v17
v_rcp_f32 v18, v18
v_rcp_f32 v19, v19
v_rcp_f32 v20, v20
v_rcp_f32 v21, v21
v_pk_mul_f32 v[132:133], v[132:133], v[14:15]
v_pk_mul_f32 v[134:135], v[134:135], v[16:17]
v_pk_mul_f32 v[136:137], v[136:137], v[18:19]
v_pk_mul_f32 v[138:139], v[138:139], v[20:21]
v_cvt_pk_bf16_f32 v132, v132, v133
v_cvt_pk_bf16_f32 v133, v134, v135
v_cvt_pk_bf16_f32 v134, v136, v137
v_cvt_pk_bf16_f32 v135, v138, v139
buffer_store_dwordx4 v[132:135], v32, s[24:27], s38 offen offset:0 sc1
v_pk_mul_f32 v[14:15], v[56:57], v[56:57]
v_pk_mul_f32 v[16:17], v[58:59], v[58:59]
v_pk_mul_f32 v[18:19], v[60:61], v[60:61]
v_pk_mul_f32 v[20:21], v[62:63], v[62:63]
v_pk_fma_f32 v[14:15], v[14:15], v[10:11], v[8:9]
v_pk_fma_f32 v[16:17], v[16:17], v[10:11], v[8:9]
v_pk_fma_f32 v[18:19], v[18:19], v[10:11], v[8:9]
v_pk_fma_f32 v[20:21], v[20:21], v[10:11], v[8:9]
v_pk_mul_f32 v[14:15], v[14:15], v[56:57]
v_pk_mul_f32 v[16:17], v[16:17], v[58:59]
v_pk_mul_f32 v[18:19], v[18:19], v[60:61]
v_pk_mul_f32 v[20:21], v[20:21], v[62:63]
v_exp_f32 v14, v14
v_exp_f32 v15, v15
v_exp_f32 v16, v16
v_exp_f32 v17, v17
v_exp_f32 v18, v18
v_exp_f32 v19, v19
v_exp_f32 v20, v20
v_exp_f32 v21, v21
v_pk_add_f32 v[14:15], v[14:15], v[4:5]
v_pk_add_f32 v[16:17], v[16:17], v[4:5]
v_pk_add_f32 v[18:19], v[18:19], v[4:5]
v_pk_add_f32 v[20:21], v[20:21], v[4:5]
v_rcp_f32 v14, v14
v_rcp_f32 v15, v15
v_rcp_f32 v16, v16
v_rcp_f32 v17, v17
v_rcp_f32 v18, v18
v_rcp_f32 v19, v19
v_rcp_f32 v20, v20
v_rcp_f32 v21, v21
v_pk_mul_f32 v[56:57], v[56:57], v[14:15]
v_pk_mul_f32 v[58:59], v[58:59], v[16:17]
v_pk_mul_f32 v[60:61], v[60:61], v[18:19]
v_pk_mul_f32 v[62:63], v[62:63], v[20:21]
v_cvt_pk_bf16_f32 v56, v56, v57
v_cvt_pk_bf16_f32 v57, v58, v59
v_cvt_pk_bf16_f32 v58, v60, v61
v_cvt_pk_bf16_f32 v59, v62, v63
buffer_store_dwordx4 v[56:59], v32, s[24:27], 0 offen offset:1024 sc1
v_pk_mul_f32 v[14:15], v[84:85], v[84:85]
v_pk_mul_f32 v[16:17], v[86:87], v[86:87]
v_pk_mul_f32 v[18:19], v[88:89], v[88:89]
v_pk_mul_f32 v[20:21], v[90:91], v[90:91]
v_pk_fma_f32 v[14:15], v[14:15], v[10:11], v[8:9]
v_pk_fma_f32 v[16:17], v[16:17], v[10:11], v[8:9]
v_pk_fma_f32 v[18:19], v[18:19], v[10:11], v[8:9]
v_pk_fma_f32 v[20:21], v[20:21], v[10:11], v[8:9]
v_pk_mul_f32 v[14:15], v[14:15], v[84:85]
v_pk_mul_f32 v[16:17], v[16:17], v[86:87]
v_pk_mul_f32 v[18:19], v[18:19], v[88:89]
v_pk_mul_f32 v[20:21], v[20:21], v[90:91]
v_exp_f32 v14, v14
v_exp_f32 v15, v15
v_exp_f32 v16, v16
v_exp_f32 v17, v17
v_exp_f32 v18, v18
v_exp_f32 v19, v19
v_exp_f32 v20, v20
v_exp_f32 v21, v21
v_pk_add_f32 v[14:15], v[14:15], v[4:5]
v_pk_add_f32 v[16:17], v[16:17], v[4:5]
v_pk_add_f32 v[18:19], v[18:19], v[4:5]
v_pk_add_f32 v[20:21], v[20:21], v[4:5]
Lpad8:
s_cbranch_execz Lpadback0
s_nop 0
v_rcp_f32 v14, v14
v_rcp_f32 v15, v15
v_rcp_f32 v16, v16
v_rcp_f32 v17, v17
v_rcp_f32 v18, v18
v_rcp_f32 v19, v19
v_rcp_f32 v20, v20
v_rcp_f32 v21, v21
v_pk_mul_f32 v[84:85], v[84:85], v[14:15]
v_pk_mul_f32 v[86:87], v[86:87], v[16:17]
v_pk_mul_f32 v[88:89], v[88:89], v[18:19]
v_pk_mul_f32 v[90:91], v[90:91], v[20:21]
v_cvt_pk_bf16_f32 v84, v84, v85
v_cvt_pk_bf16_f32 v85, v86, v87
v_cvt_pk_bf16_f32 v86, v88, v89
v_cvt_pk_bf16_f32 v87, v90, v91
buffer_store_dwordx4 v[84:87], v32, s[24:27], s36 offen offset:1024 sc1
v_pk_mul_f32 v[14:15], v[112:113], v[112:113]
v_pk_mul_f32 v[16:17], v[114:115], v[114:115]
v_pk_mul_f32 v[18:19], v[116:117], v[116:117]
v_pk_mul_f32 v[20:21], v[118:119], v[118:119]
v_pk_fma_f32 v[14:15], v[14:15], v[10:11], v[8:9]
v_pk_fma_f32 v[16:17], v[16:17], v[10:11], v[8:9]
v_pk_fma_f32 v[18:19], v[18:19], v[10:11], v[8:9]
v_pk_fma_f32 v[20:21], v[20:21], v[10:11], v[8:9]
v_pk_mul_f32 v[14:15], v[14:15], v[112:113]
v_pk_mul_f32 v[16:17], v[16:17], v[114:115]
v_pk_mul_f32 v[18:19], v[18:19], v[116:117]
v_pk_mul_f32 v[20:21], v[20:21], v[118:119]
v_exp_f32 v14, v14
v_exp_f32 v15, v15
v_exp_f32 v16, v16
v_exp_f32 v17, v17
v_exp_f32 v18, v18
v_exp_f32 v19, v19
v_exp_f32 v20, v20
v_exp_f32 v21, v21
v_pk_add_f32 v[14:15], v[14:15], v[4:5]
v_pk_add_f32 v[16:17], v[16:17], v[4:5]
v_pk_add_f32 v[18:19], v[18:19], v[4:5]
v_pk_add_f32 v[20:21], v[20:21], v[4:5]
v_rcp_f32 v14, v14
v_rcp_f32 v15, v15
v_rcp_f32 v16, v16
v_rcp_f32 v17, v17
v_rcp_f32 v18, v18
v_rcp_f32 v19, v19
v_rcp_f32 v20, v20
v_rcp_f32 v21, v21
v_pk_mul_f32 v[112:113], v[112:113], v[14:15]
v_pk_mul_f32 v[114:115], v[114:115], v[16:17]
v_pk_mul_f32 v[116:117], v[116:117], v[18:19]
v_pk_mul_f32 v[118:119], v[118:119], v[20:21]
v_cvt_pk_bf16_f32 v112, v112, v113
v_cvt_pk_bf16_f32 v113, v114, v115
v_cvt_pk_bf16_f32 v114, v116, v117
v_cvt_pk_bf16_f32 v115, v118, v119
buffer_store_dwordx4 v[112:115], v32, s[24:27], s37 offen offset:1024 sc1
v_pk_mul_f32 v[14:15], v[140:141], v[140:141]
v_pk_mul_f32 v[16:17], v[142:143], v[142:143]
v_pk_mul_f32 v[18:19], v[144:145], v[144:145]
v_pk_mul_f32 v[20:21], v[146:147], v[146:147]
v_pk_fma_f32 v[14:15], v[14:15], v[10:11], v[8:9]
v_pk_fma_f32 v[16:17], v[16:17], v[10:11], v[8:9]
v_pk_fma_f32 v[18:19], v[18:19], v[10:11], v[8:9]
v_pk_fma_f32 v[20:21], v[20:21], v[10:11], v[8:9]
v_pk_mul_f32 v[14:15], v[14:15], v[140:141]
v_pk_mul_f32 v[16:17], v[16:17], v[142:143]
v_pk_mul_f32 v[18:19], v[18:19], v[144:145]
v_pk_mul_f32 v[20:21], v[20:21], v[146:147]
v_exp_f32 v14, v14
v_exp_f32 v15, v15
v_exp_f32 v16, v16
v_exp_f32 v17, v17
v_exp_f32 v18, v18
v_exp_f32 v19, v19
v_exp_f32 v20, v20
v_exp_f32 v21, v21
v_pk_add_f32 v[14:15], v[14:15], v[4:5]
v_pk_add_f32 v[16:17], v[16:17], v[4:5]
v_pk_add_f32 v[18:19], v[18:19], v[4:5]
v_pk_add_f32 v[20:21], v[20:21], v[4:5]
v_rcp_f32 v14, v14
v_rcp_f32 v15, v15
v_rcp_f32 v16, v16
v_rcp_f32 v17, v17
v_rcp_f32 v18, v18
v_rcp_f32 v19, v19
v_rcp_f32 v20, v20
v_rcp_f32 v21, v21
v_pk_mul_f32 v[140:141], v[140:141], v[14:15]
v_pk_mul_f32 v[142:143], v[142:143], v[16:17]
v_pk_mul_f32 v[144:145], v[144:145], v[18:19]
v_pk_mul_f32 v[146:147], v[146:147], v[20:21]
v_cvt_pk_bf16_f32 v140, v140, v141
v_cvt_pk_bf16_f32 v141, v142, v143
v_cvt_pk_bf16_f32 v142, v144, v145
v_cvt_pk_bf16_f32 v143, v146, v147
buffer_store_dwordx4 v[140:143], v32, s[24:27], s38 offen offset:1024 sc1
s_waitcnt vmcnt(4)
buffer_store_dword v29, v27, s[24:27], s85 offen sc1
v_pk_mul_f32 v[14:15], v[72:73], v[72:73]
v_pk_mul_f32 v[16:17], v[74:75], v[74:75]
v_pk_mul_f32 v[18:19], v[100:101], v[100:101]
v_pk_mul_f32 v[20:21], v[102:103], v[102:103]
v_pk_fma_f32 v[14:15], v[14:15], v[10:11], v[8:9]
v_pk_fma_f32 v[16:17], v[16:17], v[10:11], v[8:9]
v_pk_fma_f32 v[18:19], v[18:19], v[10:11], v[8:9]
v_pk_fma_f32 v[20:21], v[20:21], v[10:11], v[8:9]
v_pk_mul_f32 v[14:15], v[14:15], v[72:73]
v_pk_mul_f32 v[16:17], v[16:17], v[74:75]
v_pk_mul_f32 v[18:19], v[18:19], v[100:101]
v_pk_mul_f32 v[20:21], v[20:21], v[102:103]
v_exp_f32 v14, v14
v_exp_f32 v15, v15
v_exp_f32 v16, v16
v_exp_f32 v17, v17
v_exp_f32 v18, v18
v_exp_f32 v19, v19
v_exp_f32 v20, v20
v_exp_f32 v21, v21
v_pk_add_f32 v[14:15], v[14:15], v[4:5]
v_pk_add_f32 v[16:17], v[16:17], v[4:5]
v_pk_add_f32 v[18:19], v[18:19], v[4:5]
v_pk_add_f32 v[20:21], v[20:21], v[4:5]
v_rcp_f32 v14, v14
v_rcp_f32 v15, v15
v_rcp_f32 v16, v16
v_rcp_f32 v17, v17
v_rcp_f32 v18, v18
v_rcp_f32 v19, v19
v_rcp_f32 v20, v20
v_rcp_f32 v21, v21
v_pk_mul_f32 v[72:73], v[72:73], v[14:15]
v_pk_mul_f32 v[74:75], v[74:75], v[16:17]
v_pk_mul_f32 v[100:101], v[100:101], v[18:19]
v_pk_mul_f32 v[102:103], v[102:103], v[20:21]
v_cvt_pk_bf16_f32 v72, v72, v73
v_cvt_pk_bf16_f32 v73, v74, v75
ds_write_b64 v40, v[72:73] offset:0
v_cvt_pk_bf16_f32 v100, v100, v101
v_cvt_pk_bf16_f32 v101, v102, v103
ds_write_b64 v40, v[100:101] offset:1024
v_pk_mul_f32 v[14:15], v[128:129], v[128:129]
v_pk_mul_f32 v[16:17], v[130:131], v[130:131]
v_pk_mul_f32 v[18:19], v[156:157], v[156:157]
v_pk_mul_f32 v[20:21], v[158:159], v[158:159]
v_pk_fma_f32 v[14:15], v[14:15], v[10:11], v[8:9]
v_pk_fma_f32 v[16:17], v[16:17], v[10:11], v[8:9]
v_pk_fma_f32 v[18:19], v[18:19], v[10:11], v[8:9]
v_pk_fma_f32 v[20:21], v[20:21], v[10:11], v[8:9]
v_pk_mul_f32 v[14:15], v[14:15], v[128:129]
v_pk_mul_f32 v[16:17], v[16:17], v[130:131]
v_pk_mul_f32 v[18:19], v[18:19], v[156:157]
v_pk_mul_f32 v[20:21], v[20:21], v[158:159]
v_exp_f32 v14, v14
v_exp_f32 v15, v15
v_exp_f32 v16, v16
v_exp_f32 v17, v17
v_exp_f32 v18, v18
v_exp_f32 v19, v19
v_exp_f32 v20, v20
v_exp_f32 v21, v21
v_pk_add_f32 v[14:15], v[14:15], v[4:5]
v_pk_add_f32 v[16:17], v[16:17], v[4:5]
v_pk_add_f32 v[18:19], v[18:19], v[4:5]
v_pk_add_f32 v[20:21], v[20:21], v[4:5]
v_rcp_f32 v14, v14
v_rcp_f32 v15, v15
v_rcp_f32 v16, v16
v_rcp_f32 v17, v17
v_rcp_f32 v18, v18
v_rcp_f32 v19, v19
v_rcp_f32 v20, v20
v_rcp_f32 v21, v21
v_pk_mul_f32 v[128:129], v[128:129], v[14:15]
v_pk_mul_f32 v[130:131], v[130:131], v[16:17]
v_pk_mul_f32 v[156:157], v[156:157], v[18:19]
v_pk_mul_f32 v[158:159], v[158:159], v[20:21]
v_cvt_pk_bf16_f32 v128, v128, v129
v_cvt_pk_bf16_f32 v129, v130, v131
ds_write_b64 v40, v[128:129] offset:2048
v_cvt_pk_bf16_f32 v156, v156, v157
v_cvt_pk_bf16_f32 v157, v158, v159
ds_write_b64 v40, v[156:157] offset:3072
s_waitcnt lgkmcnt(0)
s_barrier
ds_read_b128 v[72:75], v41 offset:0
ds_read_b128 v[100:103], v41 offset:1024
v_pk_mul_f32 v[14:15], v[64:65], v[64:65]
v_pk_mul_f32 v[16:17], v[66:67], v[66:67]
v_pk_mul_f32 v[18:19], v[68:69], v[68:69]
v_pk_mul_f32 v[20:21], v[70:71], v[70:71]
v_pk_fma_f32 v[14:15], v[14:15], v[10:11], v[8:9]
v_pk_fma_f32 v[16:17], v[16:17], v[10:11], v[8:9]
v_pk_fma_f32 v[18:19], v[18:19], v[10:11], v[8:9]
v_pk_fma_f32 v[20:21], v[20:21], v[10:11], v[8:9]
v_pk_mul_f32 v[14:15], v[14:15], v[64:65]
v_pk_mul_f32 v[16:17], v[16:17], v[66:67]
v_pk_mul_f32 v[18:19], v[18:19], v[68:69]
v_pk_mul_f32 v[20:21], v[20:21], v[70:71]
v_exp_f32 v14, v14
v_exp_f32 v15, v15
v_exp_f32 v16, v16
v_exp_f32 v17, v17
v_exp_f32 v18, v18
v_exp_f32 v19, v19
v_exp_f32 v20, v20
v_exp_f32 v21, v21
v_pk_add_f32 v[14:15], v[14:15], v[4:5]
v_pk_add_f32 v[16:17], v[16:17], v[4:5]
v_pk_add_f32 v[18:19], v[18:19], v[4:5]
v_pk_add_f32 v[20:21], v[20:21], v[4:5]
v_rcp_f32 v14, v14
v_rcp_f32 v15, v15
v_rcp_f32 v16, v16
v_rcp_f32 v17, v17
v_rcp_f32 v18, v18
v_rcp_f32 v19, v19
v_rcp_f32 v20, v20
v_rcp_f32 v21, v21
v_pk_mul_f32 v[64:65], v[64:65], v[14:15]
v_pk_mul_f32 v[66:67], v[66:67], v[16:17]
v_pk_mul_f32 v[68:69], v[68:69], v[18:19]
v_pk_mul_f32 v[70:71], v[70:71], v[20:21]
v_cvt_pk_bf16_f32 v64, v64, v65
v_cvt_pk_bf16_f32 v65, v66, v67
v_cvt_pk_bf16_f32 v66, v68, v69
v_cvt_pk_bf16_f32 v67, v70, v71
buffer_store_dwordx4 v[64:67], v32, s[24:27], 0 offen offset:2048 sc1
s_waitcnt lgkmcnt(0)
buffer_store_dwordx4 v[72:75], v33, s[24:27], 0 offen sc1
buffer_store_dwordx4 v[100:103], v33, s[24:27], s36 offen sc1
v_pk_mul_f32 v[14:15], v[92:93], v[92:93]
v_pk_mul_f32 v[16:17], v[94:95], v[94:95]
v_pk_mul_f32 v[18:19], v[96:97], v[96:97]
v_pk_mul_f32 v[20:21], v[98:99], v[98:99]
v_pk_fma_f32 v[14:15], v[14:15], v[10:11], v[8:9]
v_pk_fma_f32 v[16:17], v[16:17], v[10:11], v[8:9]
v_pk_fma_f32 v[18:19], v[18:19], v[10:11], v[8:9]
v_pk_fma_f32 v[20:21], v[20:21], v[10:11], v[8:9]
v_pk_mul_f32 v[14:15], v[14:15], v[92:93]
v_pk_mul_f32 v[16:17], v[16:17], v[94:95]
v_pk_mul_f32 v[18:19], v[18:19], v[96:97]
v_pk_mul_f32 v[20:21], v[20:21], v[98:99]
v_exp_f32 v14, v14
v_exp_f32 v15, v15
v_exp_f32 v16, v16
v_exp_f32 v17, v17
v_exp_f32 v18, v18
v_exp_f32 v19, v19
v_exp_f32 v20, v20
v_exp_f32 v21, v21
v_pk_add_f32 v[14:15], v[14:15], v[4:5]
v_pk_add_f32 v[16:17], v[16:17], v[4:5]
v_pk_add_f32 v[18:19], v[18:19], v[4:5]
v_pk_add_f32 v[20:21], v[20:21], v[4:5]
v_rcp_f32 v14, v14
v_rcp_f32 v15, v15
v_rcp_f32 v16, v16
v_rcp_f32 v17, v17
v_rcp_f32 v18, v18
v_rcp_f32 v19, v19
v_rcp_f32 v20, v20
v_rcp_f32 v21, v21
v_pk_mul_f32 v[92:93], v[92:93], v[14:15]
v_pk_mul_f32 v[94:95], v[94:95], v[16:17]
v_pk_mul_f32 v[96:97], v[96:97], v[18:19]
v_pk_mul_f32 v[98:99], v[98:99], v[20:21]
v_cvt_pk_bf16_f32 v92, v92, v93
v_cvt_pk_bf16_f32 v93, v94, v95
v_cvt_pk_bf16_f32 v94, v96, v97
v_cvt_pk_bf16_f32 v95, v98, v99
buffer_store_dwordx4 v[92:95], v32, s[24:27], s36 offen offset:2048 sc1
v_pk_mul_f32 v[14:15], v[120:121], v[120:121]
v_pk_mul_f32 v[16:17], v[122:123], v[122:123]
v_pk_mul_f32 v[18:19], v[124:125], v[124:125]
v_pk_mul_f32 v[20:21], v[126:127], v[126:127]
v_pk_fma_f32 v[14:15], v[14:15], v[10:11], v[8:9]
v_pk_fma_f32 v[16:17], v[16:17], v[10:11], v[8:9]
v_pk_fma_f32 v[18:19], v[18:19], v[10:11], v[8:9]
v_pk_fma_f32 v[20:21], v[20:21], v[10:11], v[8:9]
v_pk_mul_f32 v[14:15], v[14:15], v[120:121]
v_pk_mul_f32 v[16:17], v[16:17], v[122:123]
v_pk_mul_f32 v[18:19], v[18:19], v[124:125]
v_pk_mul_f32 v[20:21], v[20:21], v[126:127]
v_exp_f32 v14, v14
v_exp_f32 v15, v15
v_exp_f32 v16, v16
v_exp_f32 v17, v17
v_exp_f32 v18, v18
v_exp_f32 v19, v19
v_exp_f32 v20, v20
v_exp_f32 v21, v21
v_pk_add_f32 v[14:15], v[14:15], v[4:5]
v_pk_add_f32 v[16:17], v[16:17], v[4:5]
v_pk_add_f32 v[18:19], v[18:19], v[4:5]
v_pk_add_f32 v[20:21], v[20:21], v[4:5]
v_rcp_f32 v14, v14
v_rcp_f32 v15, v15
v_rcp_f32 v16, v16
v_rcp_f32 v17, v17
v_rcp_f32 v18, v18
v_rcp_f32 v19, v19
v_rcp_f32 v20, v20
v_rcp_f32 v21, v21
v_pk_mul_f32 v[120:121], v[120:121], v[14:15]
v_pk_mul_f32 v[122:123], v[122:123], v[16:17]
v_pk_mul_f32 v[124:125], v[124:125], v[18:19]
v_pk_mul_f32 v[126:127], v[126:127], v[20:21]
v_cvt_pk_bf16_f32 v120, v120, v121
v_cvt_pk_bf16_f32 v121, v122, v123
v_cvt_pk_bf16_f32 v122, v124, v125
v_cvt_pk_bf16_f32 v123, v126, v127
buffer_store_dwordx4 v[120:123], v32, s[24:27], s37 offen offset:2048 sc1
v_pk_mul_f32 v[14:15], v[148:149], v[148:149]
v_pk_mul_f32 v[16:17], v[150:151], v[150:151]
v_pk_mul_f32 v[18:19], v[152:153], v[152:153]
v_pk_mul_f32 v[20:21], v[154:155], v[154:155]
v_pk_fma_f32 v[14:15], v[14:15], v[10:11], v[8:9]
v_pk_fma_f32 v[16:17], v[16:17], v[10:11], v[8:9]
v_pk_fma_f32 v[18:19], v[18:19], v[10:11], v[8:9]
v_pk_fma_f32 v[20:21], v[20:21], v[10:11], v[8:9]
v_pk_mul_f32 v[14:15], v[14:15], v[148:149]
v_pk_mul_f32 v[16:17], v[16:17], v[150:151]
v_pk_mul_f32 v[18:19], v[18:19], v[152:153]
v_pk_mul_f32 v[20:21], v[20:21], v[154:155]
v_exp_f32 v14, v14
v_exp_f32 v15, v15
v_exp_f32 v16, v16
v_exp_f32 v17, v17
v_exp_f32 v18, v18
v_exp_f32 v19, v19
v_exp_f32 v20, v20
v_exp_f32 v21, v21
v_pk_add_f32 v[14:15], v[14:15], v[4:5]
v_pk_add_f32 v[16:17], v[16:17], v[4:5]
v_pk_add_f32 v[18:19], v[18:19], v[4:5]
v_pk_add_f32 v[20:21], v[20:21], v[4:5]
v_rcp_f32 v14, v14
v_rcp_f32 v15, v15
v_rcp_f32 v16, v16
v_rcp_f32 v17, v17
v_rcp_f32 v18, v18
v_rcp_f32 v19, v19
v_rcp_f32 v20, v20
v_rcp_f32 v21, v21
v_pk_mul_f32 v[148:149], v[148:149], v[14:15]
v_pk_mul_f32 v[150:151], v[150:151], v[16:17]
v_pk_mul_f32 v[152:153], v[152:153], v[18:19]
v_pk_mul_f32 v[154:155], v[154:155], v[20:21]
v_cvt_pk_bf16_f32 v148, v148, v149
v_cvt_pk_bf16_f32 v149, v150, v151
v_cvt_pk_bf16_f32 v150, v152, v153
v_cvt_pk_bf16_f32 v151, v154, v155
buffer_store_dwordx4 v[148:151], v32, s[24:27], s38 offen offset:2048 sc1
s_nop 0
v_mov_b32_dpp v53, v42 row_newbcast:0 row_mask:0xf bank_mask:0xf
v_mov_b32_dpp v55, v43 row_newbcast:0 row_mask:0xf bank_mask:0xf
v_mov_b32_dpp v81, v42 row_newbcast:1 row_mask:0xf bank_mask:0xf
v_mov_b32_dpp v83, v43 row_newbcast:1 row_mask:0xf bank_mask:0xf
v_mov_b32_dpp v109, v42 row_newbcast:2 row_mask:0xf bank_mask:0xf
v_mov_b32_dpp v111, v43 row_newbcast:2 row_mask:0xf bank_mask:0xf
v_mov_b32_dpp v49, v42 row_newbcast:3 row_mask:0xf bank_mask:0xf
v_mov_b32_dpp v51, v43 row_newbcast:3 row_mask:0xf bank_mask:0xf
v_lshlrev_b32 v52, 16, v53
v_and_b32 v53, 0xffff0000, v53
v_lshlrev_b32 v54, 16, v55
v_and_b32 v55, 0xffff0000, v55
v_lshlrev_b32 v80, 16, v81
v_and_b32 v81, 0xffff0000, v81
v_lshlrev_b32 v82, 16, v83
v_and_b32 v83, 0xffff0000, v83
v_lshlrev_b32 v108, 16, v109
v_and_b32 v109, 0xffff0000, v109
v_lshlrev_b32 v110, 16, v111
v_and_b32 v111, 0xffff0000, v111
v_lshlrev_b32 v48, 16, v49
v_and_b32 v49, 0xffff0000, v49
v_lshlrev_b32 v50, 16, v51
v_and_b32 v51, 0xffff0000, v51
v_accvgpr_read_b32 v24, a230
v_accvgpr_read_b32 v12, a237
v_cvt_pk_bf16_f32 v192, v192, v193
v_cvt_pk_bf16_f32 v193, v194, v195
v_cvt_pk_bf16_f32 v194, v196, v197
v_cvt_pk_bf16_f32 v195, v198, v199
v_cvt_pk_bf16_f32 v200, v200, v201
v_cvt_pk_bf16_f32 v201, v202, v203
v_cvt_pk_bf16_f32 v202, v204, v205
v_cvt_pk_bf16_f32 v203, v206, v207
v_cvt_pk_bf16_f32 v208, v208, v209
v_cvt_pk_bf16_f32 v209, v210, v211
v_cvt_pk_bf16_f32 v210, v212, v213
v_cvt_pk_bf16_f32 v211, v214, v215
v_cvt_pk_bf16_f32 v216, v216, v217
v_cvt_pk_bf16_f32 v217, v218, v219
v_cvt_pk_bf16_f32 v218, v220, v221
v_cvt_pk_bf16_f32 v219, v222, v223
v_mov_b32 v212, 0x3f803f80
v_mov_b32 v213, 0x3f803f80
v_mov_b32 v214, 0x3f803f80
v_mov_b32 v215, 0x3f803f80
v_pk_mul_f32 v[14:15], v[160:161], v[2:3]
v_pk_mul_f32 v[16:17], v[162:163], v[2:3]
v_pk_mul_f32 v[18:19], v[164:165], v[2:3]
v_pk_mul_f32 v[20:21], v[166:167], v[2:3]
v_exp_f32_e64 v14, v14 clamp
v_exp_f32_e64 v15, v15 clamp
v_exp_f32_e64 v16, v16 clamp
v_exp_f32_e64 v17, v17 clamp
v_exp_f32_e64 v18, v18 clamp
v_exp_f32_e64 v19, v19 clamp
v_exp_f32_e64 v20, v20 clamp
v_exp_f32_e64 v21, v21 clamp
v_pk_add_f32 v[160:161], v[160:161], v[4:5]
v_pk_add_f32 v[162:163], v[162:163], v[4:5]
v_pk_add_f32 v[164:165], v[164:165], v[4:5]
v_pk_add_f32 v[166:167], v[166:167], v[4:5]
v_max_f32 v160, v160, v14
v_max_f32 v161, v161, v15
v_max_f32 v162, v162, v16
v_max_f32 v163, v163, v17
v_max_f32 v164, v164, v18
v_max_f32 v165, v165, v19
v_max_f32 v166, v166, v20
v_max_f32 v167, v167, v21
v_pk_add_f32 v[160:161], v[160:161], v[6:7]
v_pk_add_f32 v[162:163], v[162:163], v[6:7]
v_pk_add_f32 v[164:165], v[164:165], v[6:7]
v_pk_add_f32 v[166:167], v[166:167], v[6:7]
v_cvt_pk_bf16_f32 v160, v160, v161
v_cvt_pk_bf16_f32 v161, v162, v163
v_cvt_pk_bf16_f32 v162, v164, v165
v_cvt_pk_bf16_f32 v163, v166, v167
v_pk_mul_f32 v[14:15], v[168:169], v[2:3]
v_pk_mul_f32 v[16:17], v[170:171], v[2:3]
v_pk_mul_f32 v[18:19], v[172:173], v[2:3]
v_pk_mul_f32 v[20:21], v[174:175], v[2:3]
v_exp_f32_e64 v14, v14 clamp
v_exp_f32_e64 v15, v15 clamp
v_exp_f32_e64 v16, v16 clamp
v_exp_f32_e64 v17, v17 clamp
v_exp_f32_e64 v18, v18 clamp
v_exp_f32_e64 v19, v19 clamp
v_exp_f32_e64 v20, v20 clamp
v_exp_f32_e64 v21, v21 clamp
v_pk_add_f32 v[168:169], v[168:169], v[4:5]
v_pk_add_f32 v[170:171], v[170:171], v[4:5]
v_pk_add_f32 v[172:173], v[172:173], v[4:5]
v_pk_add_f32 v[174:175], v[174:175], v[4:5]
v_max_f32 v168, v168, v14
v_max_f32 v169, v169, v15
v_max_f32 v170, v170, v16
v_max_f32 v171, v171, v17
v_max_f32 v172, v172, v18
v_max_f32 v173, v173, v19
v_max_f32 v174, v174, v20
v_max_f32 v175, v175, v21
v_pk_add_f32 v[168:169], v[168:169], v[6:7]
v_pk_add_f32 v[170:171], v[170:171], v[6:7]
v_pk_add_f32 v[172:173], v[172:173], v[6:7]
v_pk_add_f32 v[174:175], v[174:175], v[6:7]
v_cvt_pk_bf16_f32 v168, v168, v169
v_cvt_pk_bf16_f32 v169, v170, v171
v_cvt_pk_bf16_f32 v170, v172, v173
v_cvt_pk_bf16_f32 v171, v174, v175
v_pk_mul_f32 v[14:15], v[176:177], v[2:3]
v_pk_mul_f32 v[16:17], v[178:179], v[2:3]
v_pk_mul_f32 v[18:19], v[180:181], v[2:3]
v_pk_mul_f32 v[20:21], v[182:183], v[2:3]
v_exp_f32_e64 v14, v14 clamp
v_exp_f32_e64 v15, v15 clamp
v_exp_f32_e64 v16, v16 clamp
v_exp_f32_e64 v17, v17 clamp
v_exp_f32_e64 v18, v18 clamp
v_exp_f32_e64 v19, v19 clamp
v_exp_f32_e64 v20, v20 clamp
v_exp_f32_e64 v21, v21 clamp
v_pk_add_f32 v[176:177], v[176:177], v[4:5]
v_pk_add_f32 v[178:179], v[178:179], v[4:5]
v_pk_add_f32 v[180:181], v[180:181], v[4:5]
v_pk_add_f32 v[182:183], v[182:183], v[4:5]
v_max_f32 v176, v176, v14
v_max_f32 v177, v177, v15
v_max_f32 v178, v178, v16
v_max_f32 v179, v179, v17
v_max_f32 v180, v180, v18
v_max_f32 v181, v181, v19
v_max_f32 v182, v182, v20
v_max_f32 v183, v183, v21
v_pk_add_f32 v[176:177], v[176:177], v[6:7]
v_pk_add_f32 v[178:179], v[178:179], v[6:7]
v_pk_add_f32 v[180:181], v[180:181], v[6:7]
v_pk_add_f32 v[182:183], v[182:183], v[6:7]
v_cvt_pk_bf16_f32 v176, v176, v177
v_cvt_pk_bf16_f32 v177, v178, v179
v_cvt_pk_bf16_f32 v178, v180, v181
v_cvt_pk_bf16_f32 v179, v182, v183
v_pk_mul_f32 v[14:15], v[184:185], v[2:3]
v_pk_mul_f32 v[16:17], v[186:187], v[2:3]
v_pk_mul_f32 v[18:19], v[188:189], v[2:3]
v_pk_mul_f32 v[20:21], v[190:191], v[2:3]
v_exp_f32_e64 v14, v14 clamp
v_exp_f32_e64 v15, v15 clamp
v_exp_f32_e64 v16, v16 clamp
v_exp_f32_e64 v17, v17 clamp
v_exp_f32_e64 v18, v18 clamp
v_exp_f32_e64 v19, v19 clamp
v_exp_f32_e64 v20, v20 clamp
v_exp_f32_e64 v21, v21 clamp
v_pk_add_f32 v[184:185], v[184:185], v[4:5]
v_pk_add_f32 v[186:187], v[186:187], v[4:5]
v_pk_add_f32 v[188:189], v[188:189], v[4:5]
v_pk_add_f32 v[190:191], v[190:191], v[4:5]
v_max_f32 v184, v184, v14
v_max_f32 v185, v185, v15
v_max_f32 v186, v186, v16
v_max_f32 v187, v187, v17
v_max_f32 v188, v188, v18
v_max_f32 v189, v189, v19
v_max_f32 v190, v190, v20
v_max_f32 v191, v191, v21
v_pk_add_f32 v[184:185], v[184:185], v[6:7]
v_pk_add_f32 v[186:187], v[186:187], v[6:7]
v_pk_add_f32 v[188:189], v[188:189], v[6:7]
v_pk_add_f32 v[190:191], v[190:191], v[6:7]
v_cvt_pk_bf16_f32 v184, v184, v185
v_cvt_pk_bf16_f32 v185, v186, v187
v_cvt_pk_bf16_f32 v186, v188, v189
v_cvt_pk_bf16_f32 v187, v190, v191
s_nop 1
v_mfma_f32_16x16x32_bf16 v[96:99], v[160:163], v[212:215], 0
v_mfma_f32_16x16x32_bf16 v[60:63], v[160:163], v[192:195], 0
v_mfma_f32_16x16x32_bf16 v[88:91], v[160:163], v[200:203], 0
v_mfma_f32_16x16x32_bf16 v[124:127], v[168:171], v[212:215], 0
v_mfma_f32_16x16x32_bf16 v[116:119], v[168:171], v[192:195], 0
v_mfma_f32_16x16x32_bf16 v[68:71], v[168:171], v[200:203], 0
v_mfma_f32_16x16x32_bf16 v[96:99], v[176:179], v[212:215], v[96:99]
v_mfma_f32_16x16x32_bf16 v[60:63], v[176:179], v[208:211], v[60:63]
v_mfma_f32_16x16x32_bf16 v[88:91], v[176:179], v[216:219], v[88:91]
v_mfma_f32_16x16x32_bf16 v[124:127], v[184:187], v[212:215], v[124:127]
v_mfma_f32_16x16x32_bf16 v[116:119], v[184:187], v[208:211], v[116:119]
v_mfma_f32_16x16x32_bf16 v[68:71], v[184:187], v[216:219], v[68:71]
s_mul_i32 s50, s72, 3072
s_add_u32 s50, s50, 147456
v_add_u32 v44, s50, v1
s_xor_b32 s51, s72, 2
s_mul_i32 s51, s51, 3072
s_add_u32 s51, s51, 147456
v_add_u32 v45, s51, v1
v_and_b32 v46, 1, v0
s_cmp_eq_u32 s79, 0
s_cselect_b64 s[44:45], -1, 0
v_cmp_eq_u32 vcc, 0, v46
s_nop 1
v_cndmask_b32 v96, v124, v96, vcc
v_cndmask_b32 v97, v125, v97, vcc
v_cndmask_b32 v98, v126, v98, vcc
v_cndmask_b32 v99, v127, v99, vcc
v_cndmask_b32 v160, v60, v116, s[44:45]
v_cndmask_b32 v60, v116, v60, s[44:45]
v_cndmask_b32 v161, v61, v117, s[44:45]
v_cndmask_b32 v61, v117, v61, s[44:45]
v_cndmask_b32 v162, v62, v118, s[44:45]
v_cndmask_b32 v62, v118, v62, s[44:45]
v_cndmask_b32 v163, v63, v119, s[44:45]
v_cndmask_b32 v63, v119, v63, s[44:45]
v_cndmask_b32 v164, v88, v68, s[44:45]
v_cndmask_b32 v88, v68, v88, s[44:45]
v_cndmask_b32 v165, v89, v69, s[44:45]
v_cndmask_b32 v89, v69, v89, s[44:45]
v_cndmask_b32 v166, v90, v70, s[44:45]
v_cndmask_b32 v90, v70, v90, s[44:45]
v_cndmask_b32 v167, v91, v71, s[44:45]
v_cndmask_b32 v91, v71, v91, s[44:45]
ds_write_b128 v44, v[160:163] offset:0
ds_write_b128 v44, v[164:167] offset:1024
ds_write_b128 v44, v[96:99] offset:2048
s_waitcnt lgkmcnt(0)
s_barrier
ds_read_b128 v[168:171], v45 offset:0
ds_read_b128 v[172:175], v45 offset:1024
ds_read_b128 v[176:179], v45 offset:2048
v_pk_mul_f32 v[14:15], v[224:225], v[2:3]
v_pk_mul_f32 v[16:17], v[226:227], v[2:3]
v_pk_mul_f32 v[18:19], v[228:229], v[2:3]
v_pk_mul_f32 v[20:21], v[230:231], v[2:3]
v_exp_f32_e64 v14, v14 clamp
v_exp_f32_e64 v15, v15 clamp
v_exp_f32_e64 v16, v16 clamp
v_exp_f32_e64 v17, v17 clamp
v_exp_f32_e64 v18, v18 clamp
v_exp_f32_e64 v19, v19 clamp
v_exp_f32_e64 v20, v20 clamp
v_exp_f32_e64 v21, v21 clamp
v_pk_add_f32 v[224:225], v[224:225], v[4:5]
v_pk_add_f32 v[226:227], v[226:227], v[4:5]
v_pk_add_f32 v[228:229], v[228:229], v[4:5]
v_pk_add_f32 v[230:231], v[230:231], v[4:5]
v_max_f32 v224, v224, v14
v_max_f32 v225, v225, v15
v_max_f32 v226, v226, v16
v_max_f32 v227, v227, v17
v_max_f32 v228, v228, v18
v_max_f32 v229, v229, v19
v_max_f32 v230, v230, v20
v_max_f32 v231, v231, v21
v_pk_add_f32 v[224:225], v[224:225], v[6:7]
v_pk_add_f32 v[226:227], v[226:227], v[6:7]
v_pk_add_f32 v[228:229], v[228:229], v[6:7]
v_pk_add_f32 v[230:231], v[230:231], v[6:7]
v_cvt_pk_bf16_f32 v224, v224, v225
Lpad9:
s_cbranch_execz Lpad13
s_nop 0
v_cvt_pk_bf16_f32 v225, v226, v227
v_cvt_pk_bf16_f32 v226, v228, v229
v_cvt_pk_bf16_f32 v227, v230, v231
v_pk_mul_f32 v[14:15], v[232:233], v[2:3]
v_pk_mul_f32 v[16:17], v[234:235], v[2:3]
v_pk_mul_f32 v[18:19], v[236:237], v[2:3]
v_pk_mul_f32 v[20:21], v[238:239], v[2:3]
v_exp_f32_e64 v14, v14 clamp
v_exp_f32_e64 v15, v15 clamp
v_exp_f32_e64 v16, v16 clamp
v_exp_f32_e64 v17, v17 clamp
v_exp_f32_e64 v18, v18 clamp
v_exp_f32_e64 v19, v19 clamp
v_exp_f32_e64 v20, v20 clamp
v_exp_f32_e64 v21, v21 clamp
v_pk_add_f32 v[232:233], v[232:233], v[4:5]
v_pk_add_f32 v[234:235], v[234:235], v[4:5]
v_pk_add_f32 v[236:237], v[236:237], v[4:5]
v_pk_add_f32 v[238:239], v[238:239], v[4:5]
v_max_f32 v232, v232, v14
v_max_f32 v233, v233, v15
v_max_f32 v234, v234, v16
v_max_f32 v235, v235, v17
v_max_f32 v236, v236, v18
v_max_f32 v237, v237, v19
v_max_f32 v238, v238, v20
v_max_f32 v239, v239, v21
v_pk_add_f32 v[232:233], v[232:233], v[6:7]
v_pk_add_f32 v[234:235], v[234:235], v[6:7]
v_pk_add_f32 v[236:237], v[236:237], v[6:7]
v_pk_add_f32 v[238:239], v[238:239], v[6:7]
v_cvt_pk_bf16_f32 v228, v232, v233
v_cvt_pk_bf16_f32 v229, v234, v235
v_cvt_pk_bf16_f32 v230, v236, v237
v_cvt_pk_bf16_f32 v231, v238, v239
v_mov_b32 v40, 4
s_waitcnt vmcnt(0)
buffer_load_dword v25, v24, s[24:27], s46 offen sc1
buffer_store_dword v40, v27, s[24:27], s89 offen sc1
s_waitcnt lgkmcnt(0)
v_add_f32 v60, v60, v168
v_add_f32 v61, v61, v169
v_add_f32 v62, v62, v170
v_add_f32 v63, v63, v171
v_add_f32 v88, v88, v172
v_add_f32 v89, v89, v173
v_add_f32 v90, v90, v174
v_add_f32 v91, v91, v175
v_add_f32 v96, v96, v176
v_add_f32 v97, v97, v177
v_add_f32 v98, v98, v178
v_add_f32 v99, v99, v179
v_accvgpr_read_b32 v132, a238
v_accvgpr_read_b32 v133, a239
v_accvgpr_read_b32 v134, a240
v_accvgpr_read_b32 v135, a241
v_accvgpr_read_b32 v140, a242
v_accvgpr_read_b32 v141, a243
v_accvgpr_read_b32 v142, a244
v_accvgpr_read_b32 v143, a245
v_accvgpr_read_b32 v38, a232
v_accvgpr_read_b32 v39, a233
v_accvgpr_read_b32 v30, a228
v_accvgpr_read_b32 v147, a229
v_accvgpr_read_b32 v159, a231
v_accvgpr_read_b32 v13, a234
v_accvgpr_read_b32 v144, a235
v_accvgpr_read_b32 v146, a236
v_add_u32 v148, 0x10000, v132
v_add_u32 v149, 0x10000, v133
v_add_u32 v150, 0x10000, v134
v_add_u32 v151, 0x10000, v135
v_add_u32 v154, 0x10000, v140
v_add_u32 v155, 0x10000, v141
v_add_u32 v156, 0x10000, v142
v_add_u32 v157, 0x10000, v143
s_lshl_b32 s70, s76, 20
s_lshl_b32 s71, s76, 14
s_add_u32 s71, s71, 114688
v_and_b32 v158, 0x30, v0
s_cmp_eq_u32 s72, 0
s_cselect_b32 s64, 1, 0
s_cselect_b32 s65, 4, 0
s_nop 0
s_barrier
ds_read_b64_tr_b16 a[0:1], v132 offset:16384
ds_read_b64_tr_b16 a[2:3], v132 offset:20480
ds_read_b64_tr_b16 a[4:5], v133 offset:16384
ds_read_b64_tr_b16 a[6:7], v133 offset:20480
ds_read_b64_tr_b16 a[8:9], v134 offset:16384
ds_read_b64_tr_b16 a[10:11], v134 offset:20480
ds_read_b64_tr_b16 a[12:13], v135 offset:16384
ds_read_b64_tr_b16 a[14:15], v135 offset:20480
ds_read_b64_tr_b16 a[16:17], v140 offset:16384
ds_read_b64_tr_b16 a[18:19], v140 offset:20480
ds_read_b64_tr_b16 a[20:21], v141 offset:16384
ds_read_b64_tr_b16 a[22:23], v141 offset:20480
ds_read_b64_tr_b16 a[24:25], v142 offset:16384
ds_read_b64_tr_b16 a[26:27], v142 offset:20480
ds_read_b64_tr_b16 a[28:29], v143 offset:16384
ds_read_b64_tr_b16 a[30:31], v143 offset:20480
s_waitcnt vmcnt(1)
v_cmp_gt_u32 vcc, 1, v25
s_nop 3
s_cbranch_vccz Lret2
s_mov_b32 s47, 0
Lslow2_l:
s_sleep 8
buffer_load_dword v25, v24, s[24:27], s46 offen sc1
s_add_u32 s47, s47, 1
s_waitcnt vmcnt(0)
v_cmp_gt_u32 vcc, 1, v25
s_cmp_gt_u32 s47, 0x40000
s_cbranch_scc1 Lret2
s_nop 3
s_cbranch_vccnz Lslow2_l
Lret2:
s_add_u32 s97, s49, 0
buffer_load_dwordx4 a[64:67], v38, s[24:27], s97 offen sc1
buffer_load_dwordx4 a[68:71], v39, s[24:27], s97 offen sc1
s_add_u32 s93, s49, 4096
buffer_load_dwordx4 a[72:75], v38, s[24:27], s93 offen sc1
buffer_load_dwordx4 a[76:79], v39, s[24:27], s93 offen sc1
s_add_u32 s94, s49, 7168
buffer_load_dwordx4 a[80:83], v38, s[24:27], s94 offen sc1
buffer_load_dwordx4 a[84:87], v39, s[24:27], s94 offen sc1
s_add_u32 s95, s49, 11264
buffer_load_dwordx4 a[88:91], v38, s[24:27], s95 offen sc1
buffer_load_dwordx4 a[92:95], v39, s[24:27], s95 offen sc1
s_add_u32 s96, s49, 14336
buffer_load_dwordx4 a[96:99], v38, s[24:27], s96 offen sc1
buffer_load_dwordx4 a[100:103], v39, s[24:27], s96 offen sc1
s_add_u32 s97, s49, 18432
buffer_load_dwordx4 a[104:107], v38, s[24:27], s97 offen sc1
buffer_load_dwordx4 a[108:111], v39, s[24:27], s97 offen sc1
v_pk_mul_f32 v[14:15], v[240:241], v[2:3]
v_pk_mul_f32 v[16:17], v[242:243], v[2:3]
v_pk_mul_f32 v[18:19], v[244:245], v[2:3]
v_pk_mul_f32 v[20:21], v[246:247], v[2:3]
v_exp_f32_e64 v14, v14 clamp
v_exp_f32_e64 v15, v15 clamp
v_exp_f32_e64 v16, v16 clamp
v_exp_f32_e64 v17, v17 clamp
v_exp_f32_e64 v18, v18 clamp
v_exp_f32_e64 v19, v19 clamp
v_exp_f32_e64 v20, v20 clamp
v_exp_f32_e64 v21, v21 clamp
v_pk_add_f32 v[240:241], v[240:241], v[4:5]
v_pk_add_f32 v[242:243], v[242:243], v[4:5]
v_pk_add_f32 v[244:245], v[244:245], v[4:5]
v_pk_add_f32 v[246:247], v[246:247], v[4:5]
v_max_f32 v240, v240, v14
v_max_f32 v241, v241, v15
v_max_f32 v242, v242, v16
v_max_f32 v243, v243, v17
v_max_f32 v244, v244, v18
v_max_f32 v245, v245, v19
v_max_f32 v246, v246, v20
v_max_f32 v247, v247, v21
v_pk_add_f32 v[240:241], v[240:241], v[6:7]
v_pk_add_f32 v[242:243], v[242:243], v[6:7]
v_pk_add_f32 v[244:245], v[244:245], v[6:7]
v_pk_add_f32 v[246:247], v[246:247], v[6:7]
v_cvt_pk_bf16_f32 v232, v240, v241
v_cvt_pk_bf16_f32 v233, v242, v243
v_cvt_pk_bf16_f32 v234, v244, v245
v_cvt_pk_bf16_f32 v235, v246, v247
v_pk_mul_f32 v[14:15], v[248:249], v[2:3]
v_pk_mul_f32 v[16:17], v[250:251], v[2:3]
v_pk_mul_f32 v[18:19], v[252:253], v[2:3]
v_pk_mul_f32 v[20:21], v[254:255], v[2:3]
v_exp_f32_e64 v14, v14 clamp
v_exp_f32_e64 v15, v15 clamp
v_exp_f32_e64 v16, v16 clamp
v_exp_f32_e64 v17, v17 clamp
v_exp_f32_e64 v18, v18 clamp
v_exp_f32_e64 v19, v19 clamp
v_exp_f32_e64 v20, v20 clamp
v_exp_f32_e64 v21, v21 clamp
v_pk_add_f32 v[248:249], v[248:249], v[4:5]
v_pk_add_f32 v[250:251], v[250:251], v[4:5]
v_pk_add_f32 v[252:253], v[252:253], v[4:5]
v_pk_add_f32 v[254:255], v[254:255], v[4:5]
v_max_f32 v248, v248, v14
v_max_f32 v249, v249, v15
v_max_f32 v250, v250, v16
v_max_f32 v251, v251, v17
v_max_f32 v252, v252, v18
v_max_f32 v253, v253, v19
v_max_f32 v254, v254, v20
v_max_f32 v255, v255, v21
v_pk_add_f32 v[248:249], v[248:249], v[6:7]
v_pk_add_f32 v[250:251], v[250:251], v[6:7]
v_pk_add_f32 v[252:253], v[252:253], v[6:7]
v_pk_add_f32 v[254:255], v[254:255], v[6:7]
v_cvt_pk_bf16_f32 v236, v248, v249
v_cvt_pk_bf16_f32 v237, v250, v251
v_cvt_pk_bf16_f32 v238, v252, v253
v_cvt_pk_bf16_f32 v239, v254, v255
s_waitcnt vmcnt(10) lgkmcnt(12)
Lv0:
v_mfma_f32_16x16x32_bf16 v[160:163], a[0:3], a[64:67], v[52:55]
buffer_store_dwordx4 v[60:63], v1, s[24:27], s52 offen offset:0 sc1
ds_read_b64_tr_b16 a[32:33], v132 offset:24576
v_mfma_f32_16x16x32_bf16 v[192:195], a[0:3], a[68:71], v[52:55]
buffer_store_dwordx4 v[88:91], v1, s[24:27], s52 offen offset:1024 sc1
ds_read_b64_tr_b16 a[34:35], v132 offset:28672
v_mfma_f32_16x16x32_bf16 v[196:199], a[4:7], a[68:71], v[80:83]
buffer_store_dwordx4 v[96:99], v12, s[24:27], s53 offen sc1
ds_read_b64_tr_b16 a[36:37], v133 offset:24576
v_mfma_f32_16x16x32_bf16 v[164:167], a[4:7], a[64:67], v[80:83]
s_waitcnt lgkmcnt(11)
ds_read_b64_tr_b16 a[38:39], v133 offset:28672
s_add_u32 s93, s49, 21504
v_mfma_f32_16x16x32_bf16 v[168:171], a[8:11], a[64:67], v[108:111]
buffer_load_dwordx4 a[112:115], v38, s[24:27], s93 offen sc1
ds_read_b64_tr_b16 a[40:41], v134 offset:24576
v_mfma_f32_16x16x32_bf16 v[200:203], a[8:11], a[68:71], v[108:111]
buffer_load_dwordx4 a[116:119], v39, s[24:27], s93 offen sc1
ds_read_b64_tr_b16 a[42:43], v134 offset:28672
v_mfma_f32_16x16x32_bf16 v[204:207], a[12:15], a[68:71], v[48:51]
ds_read_b64_tr_b16 a[44:45], v135 offset:24576
v_mfma_f32_16x16x32_bf16 v[172:175], a[12:15], a[64:67], v[48:51]
s_waitcnt lgkmcnt(11)
ds_read_b64_tr_b16 a[46:47], v135 offset:28672
v_mfma_f32_16x16x32_bf16 v[176:179], a[16:19], a[64:67], 0
ds_read_b64_tr_b16 a[48:49], v140 offset:24576
v_mfma_f32_16x16x32_bf16 v[208:211], a[16:19], a[68:71], 0
ds_read_b64_tr_b16 a[50:51], v140 offset:28672
v_mfma_f32_16x16x32_bf16 v[212:215], a[20:23], a[68:71], 0
ds_read_b64_tr_b16 a[52:53], v141 offset:24576
v_mfma_f32_16x16x32_bf16 v[180:183], a[20:23], a[64:67], 0
s_waitcnt lgkmcnt(11)
ds_read_b64_tr_b16 a[54:55], v141 offset:28672
v_mfma_f32_16x16x32_bf16 v[184:187], a[24:27], a[64:67], 0
ds_read_b64_tr_b16 a[56:57], v142 offset:24576
v_mfma_f32_16x16x32_bf16 v[216:219], a[24:27], a[68:71], 0
ds_read_b64_tr_b16 a[58:59], v142 offset:28672
v_mfma_f32_16x16x32_bf16 v[220:223], a[28:31], a[68:71], 0
s_waitcnt vmcnt(13) lgkmcnt(10)
ds_read_b64_tr_b16 a[60:61], v143 offset:24576
v_mfma_f32_16x16x32_bf16 v[188:191], a[28:31], a[64:67], 0
s_barrier
ds_read_b64_tr_b16 a[62:63], v143 offset:28672
v_mfma_f32_16x16x32_bf16 v[160:163], a[32:35], a[72:75], v[160:163]
s_add_u32 s95, s49, 25600
ds_read_b64_tr_b16 a[0:1], v132 offset:32768
v_mfma_f32_16x16x32_bf16 v[192:195], a[32:35], a[76:79], v[192:195]
buffer_load_dwordx4 a[120:123], v38, s[24:27], s95 offen sc1
v_mfma_f32_16x16x32_bf16 v[196:199], a[36:39], a[76:79], v[196:199]
s_nop 0
ds_read_b64_tr_b16 a[2:3], v132 offset:36864
ds_read_b64_tr_b16 a[4:5], v133 offset:32768
v_mfma_f32_16x16x32_bf16 v[164:167], a[36:39], a[72:75], v[164:167]
s_waitcnt lgkmcnt(11)
ds_read_b64_tr_b16 a[6:7], v133 offset:36864
v_mfma_f32_16x16x32_bf16 v[168:171], a[40:43], a[72:75], v[168:171]
ds_read_b64_tr_b16 a[8:9], v134 offset:32768
v_mfma_f32_16x16x32_bf16 v[200:203], a[40:43], a[76:79], v[200:203]
buffer_load_dwordx4 a[124:127], v39, s[24:27], s95 offen sc1
v_mfma_f32_16x16x32_bf16 v[204:207], a[44:47], a[76:79], v[204:207]
s_add_u32 s94, s48, 3473408
ds_read_b64_tr_b16 a[10:11], v134 offset:36864
ds_read_b64_tr_b16 a[12:13], v135 offset:32768
v_mfma_f32_16x16x32_bf16 v[172:175], a[44:47], a[72:75], v[172:175]
s_waitcnt lgkmcnt(11)
ds_read_b64_tr_b16 a[14:15], v135 offset:36864
s_add_u32 m0, s82, 8192
v_mfma_f32_16x16x32_bf16 v[176:179], a[48:51], a[72:75], v[176:179]
s_nop 0
ds_read_b64_tr_b16 a[16:17], v140 offset:32768
v_mfma_f32_16x16x32_bf16 v[208:211], a[48:51], a[76:79], v[208:211]
buffer_load_dwordx4 v34, s[16:19], s94 offen lds
v_mfma_f32_16x16x32_bf16 v[212:215], a[52:55], a[76:79], v[212:215]
s_add_u32 m0, s82, 10240
ds_read_b64_tr_b16 a[18:19], v140 offset:36864
ds_read_b64_tr_b16 a[20:21], v141 offset:32768
v_mfma_f32_16x16x32_bf16 v[180:183], a[52:55], a[72:75], v[180:183]
s_waitcnt lgkmcnt(11)
ds_read_b64_tr_b16 a[22:23], v141 offset:36864
v_mfma_f32_16x16x32_bf16 v[184:187], a[56:59], a[72:75], v[184:187]
buffer_load_dwordx4 v35, s[16:19], s94 offen lds
v_mfma_f32_16x16x32_bf16 v[216:219], a[56:59], a[76:79], v[216:219]
s_nop 0
ds_read_b64_tr_b16 a[24:25], v142 offset:32768
ds_read_b64_tr_b16 a[26:27], v142 offset:36864
v_mfma_f32_16x16x32_bf16 v[220:223], a[60:63], a[76:79], v[220:223]
s_waitcnt vmcnt(15) lgkmcnt(10)
ds_read_b64_tr_b16 a[28:29], v143 offset:32768
v_mfma_f32_16x16x32_bf16 v[188:191], a[60:63], a[72:75], v[188:191]
s_barrier
ds_read_b64_tr_b16 a[30:31], v143 offset:36864
v_mfma_f32_16x16x32_bf16 v[160:163], a[0:3], a[80:83], v[160:163]
s_add_u32 s97, s49, 28672
ds_read_b64_tr_b16 a[32:33], v132 offset:40960
v_mfma_f32_16x16x32_bf16 v[192:195], a[0:3], a[84:87], v[192:195]
buffer_load_dwordx4 a[128:131], v38, s[24:27], s97 offen sc1
v_mfma_f32_16x16x32_bf16 v[196:199], a[4:7], a[84:87], v[196:199]
s_nop 0
ds_read_b64_tr_b16 a[34:35], v132 offset:45056
ds_read_b64_tr_b16 a[36:37], v133 offset:40960
v_mfma_f32_16x16x32_bf16 v[164:167], a[4:7], a[80:83], v[164:167]
s_waitcnt lgkmcnt(11)
ds_read_b64_tr_b16 a[38:39], v133 offset:45056
v_mfma_f32_16x16x32_bf16 v[168:171], a[8:11], a[80:83], v[168:171]
ds_read_b64_tr_b16 a[40:41], v134 offset:40960
v_mfma_f32_16x16x32_bf16 v[200:203], a[8:11], a[84:87], v[200:203]
buffer_load_dwordx4 a[132:135], v39, s[24:27], s97 offen sc1
v_mfma_f32_16x16x32_bf16 v[204:207], a[12:15], a[84:87], v[204:207]
s_add_u32 s96, s48, 65536
ds_read_b64_tr_b16 a[42:43], v134 offset:45056
ds_read_b64_tr_b16 a[44:45], v135 offset:40960
v_mfma_f32_16x16x32_bf16 v[172:175], a[12:15], a[80:83], v[172:175]
s_waitcnt lgkmcnt(11)
ds_read_b64_tr_b16 a[46:47], v135 offset:45056
s_add_u32 m0, s82, 16384
v_mfma_f32_16x16x32_bf16 v[176:179], a[16:19], a[80:83], v[176:179]
s_nop 0
ds_read_b64_tr_b16 a[48:49], v140 offset:40960
v_mfma_f32_16x16x32_bf16 v[208:211], a[16:19], a[84:87], v[208:211]
buffer_load_dwordx4 v34, s[16:19], s96 offen lds
v_mfma_f32_16x16x32_bf16 v[212:215], a[20:23], a[84:87], v[212:215]
s_add_u32 m0, s82, 18432
ds_read_b64_tr_b16 a[50:51], v140 offset:45056
ds_read_b64_tr_b16 a[52:53], v141 offset:40960
v_mfma_f32_16x16x32_bf16 v[180:183], a[20:23], a[80:83], v[180:183]
s_waitcnt lgkmcnt(11)
ds_read_b64_tr_b16 a[54:55], v141 offset:45056
v_mfma_f32_16x16x32_bf16 v[184:187], a[24:27], a[80:83], v[184:187]
buffer_load_dwordx4 v35, s[16:19], s96 offen lds
v_mfma_f32_16x16x32_bf16 v[216:219], a[24:27], a[84:87], v[216:219]
s_nop 0
ds_read_b64_tr_b16 a[56:57], v142 offset:40960
ds_read_b64_tr_b16 a[58:59], v142 offset:45056
v_mfma_f32_16x16x32_bf16 v[220:223], a[28:31], a[84:87], v[220:223]
s_waitcnt vmcnt(17) lgkmcnt(10)
ds_read_b64_tr_b16 a[60:61], v143 offset:40960
v_mfma_f32_16x16x32_bf16 v[188:191], a[28:31], a[80:83], v[188:191]
s_barrier
ds_read_b64_tr_b16 a[62:63], v143 offset:45056
v_mfma_f32_16x16x32_bf16 v[160:163], a[32:35], a[88:91], v[160:163]
s_add_u32 s94, s49, 32768
ds_read_b64_tr_b16 a[0:1], v132 offset:49152
v_mfma_f32_16x16x32_bf16 v[192:195], a[32:35], a[92:95], v[192:195]
buffer_load_dwordx4 a[136:139], v38, s[24:27], s94 offen sc1
v_mfma_f32_16x16x32_bf16 v[196:199], a[36:39], a[92:95], v[196:199]
s_nop 0
ds_read_b64_tr_b16 a[2:3], v132 offset:53248
ds_read_b64_tr_b16 a[4:5], v133 offset:49152
v_mfma_f32_16x16x32_bf16 v[164:167], a[36:39], a[88:91], v[164:167]
s_waitcnt lgkmcnt(11)
ds_read_b64_tr_b16 a[6:7], v133 offset:53248
v_mfma_f32_16x16x32_bf16 v[168:171], a[40:43], a[88:91], v[168:171]
ds_read_b64_tr_b16 a[8:9], v134 offset:49152
v_mfma_f32_16x16x32_bf16 v[200:203], a[40:43], a[92:95], v[200:203]
buffer_load_dwordx4 a[140:143], v39, s[24:27], s94 offen sc1
v_mfma_f32_16x16x32_bf16 v[204:207], a[44:47], a[92:95], v[204:207]
s_add_u32 s93, s48, 327680
ds_read_b64_tr_b16 a[10:11], v134 offset:53248
ds_read_b64_tr_b16 a[12:13], v135 offset:49152
v_mfma_f32_16x16x32_bf16 v[172:175], a[44:47], a[88:91], v[172:175]
s_waitcnt lgkmcnt(11)
ds_read_b64_tr_b16 a[14:15], v135 offset:53248
s_add_u32 m0, s82, 24576
v_mfma_f32_16x16x32_bf16 v[176:179], a[48:51], a[88:91], v[176:179]
s_nop 0
ds_read_b64_tr_b16 a[16:17], v140 offset:49152
v_mfma_f32_16x16x32_bf16 v[208:211], a[48:51], a[92:95], v[208:211]
buffer_load_dwordx4 v34, s[16:19], s93 offen lds
v_mfma_f32_16x16x32_bf16 v[212:215], a[52:55], a[92:95], v[212:215]
s_add_u32 m0, s82, 26624
ds_read_b64_tr_b16 a[18:19], v140 offset:53248
ds_read_b64_tr_b16 a[20:21], v141 offset:49152
v_mfma_f32_16x16x32_bf16 v[180:183], a[52:55], a[88:91], v[180:183]
s_waitcnt lgkmcnt(11)
ds_read_b64_tr_b16 a[22:23], v141 offset:53248
v_mfma_f32_16x16x32_bf16 v[184:187], a[56:59], a[88:91], v[184:187]
buffer_load_dwordx4 v35, s[16:19], s93 offen lds
v_mfma_f32_16x16x32_bf16 v[216:219], a[56:59], a[92:95], v[216:219]
s_nop 0
ds_read_b64_tr_b16 a[24:25], v142 offset:49152
ds_read_b64_tr_b16 a[26:27], v142 offset:53248
v_mfma_f32_16x16x32_bf16 v[220:223], a[60:63], a[92:95], v[220:223]
s_waitcnt vmcnt(19) lgkmcnt(10)
ds_read_b64_tr_b16 a[28:29], v143 offset:49152
v_mfma_f32_16x16x32_bf16 v[188:191], a[60:63], a[88:91], v[188:191]
s_barrier
ds_read_b64_tr_b16 a[30:31], v143 offset:53248
v_mfma_f32_16x16x32_bf16 v[160:163], a[0:3], a[96:99], v[160:163]
s_add_u32 s96, s49, 35840
ds_read_b64_tr_b16 a[32:33], v132 offset:57344
s_waitcnt vmcnt(14)
v_mfma_f32_16x16x32_bf16 v[192:195], a[0:3], a[100:103], v[192:195]
buffer_load_dwordx4 a[144:147], v38, s[24:27], s96 offen sc1
ds_read_b64_tr_b16 a[34:35], v132 offset:61440
v_mfma_f32_16x16x32_bf16 v[196:199], a[4:7], a[100:103], v[196:199]
buffer_store_dword v29, v27, s[24:27], s86 offen sc1
ds_read_b64_tr_b16 a[36:37], v133 offset:57344
v_mfma_f32_16x16x32_bf16 v[164:167], a[4:7], a[96:99], v[164:167]
s_waitcnt lgkmcnt(11)
ds_read_b64_tr_b16 a[38:39], v133 offset:61440
v_mfma_f32_16x16x32_bf16 v[168:171], a[8:11], a[96:99], v[168:171]
ds_read_b64_tr_b16 a[40:41], v134 offset:57344
v_mfma_f32_16x16x32_bf16 v[200:203], a[8:11], a[100:103], v[200:203]
buffer_load_dwordx4 a[148:151], v39, s[24:27], s96 offen sc1
ds_read_b64_tr_b16 a[42:43], v134 offset:61440
v_mfma_f32_16x16x32_bf16 v[204:207], a[12:15], a[100:103], v[204:207]
s_add_u32 s95, s48, 524288
ds_read_b64_tr_b16 a[44:45], v135 offset:57344
s_add_u32 m0, s82, 32768
v_mfma_f32_16x16x32_bf16 v[172:175], a[12:15], a[96:99], v[172:175]
s_waitcnt lgkmcnt(11)
ds_read_b64_tr_b16 a[46:47], v135 offset:61440
v_mfma_f32_16x16x32_bf16 v[176:179], a[16:19], a[96:99], v[176:179]
ds_read_b64_tr_b16 a[48:49], v140 offset:57344
v_mfma_f32_16x16x32_bf16 v[208:211], a[16:19], a[100:103], v[208:211]
buffer_load_dwordx4 v34, s[16:19], s95 offen lds
ds_read_b64_tr_b16 a[50:51], v140 offset:61440
v_mfma_f32_16x16x32_bf16 v[212:215], a[20:23], a[100:103], v[212:215]
s_add_u32 m0, s82, 34816
ds_read_b64_tr_b16 a[52:53], v141 offset:57344
v_mfma_f32_16x16x32_bf16 v[180:183], a[20:23], a[96:99], v[180:183]
s_waitcnt lgkmcnt(11)
ds_read_b64_tr_b16 a[54:55], v141 offset:61440
v_mfma_f32_16x16x32_bf16 v[184:187], a[24:27], a[96:99], v[184:187]
buffer_load_dwordx4 v35, s[16:19], s95 offen lds
ds_read_b64_tr_b16 a[56:57], v142 offset:57344
v_mfma_f32_16x16x32_bf16 v[216:219], a[24:27], a[100:103], v[216:219]
ds_read_b64_tr_b16 a[58:59], v142 offset:61440
v_mfma_f32_16x16x32_bf16 v[220:223], a[28:31], a[100:103], v[220:223]
s_waitcnt lgkmcnt(10)
ds_read_b64_tr_b16 a[60:61], v143 offset:57344
v_mfma_f32_16x16x32_bf16 v[188:191], a[28:31], a[96:99], v[188:191]
s_barrier
ds_read_b64_tr_b16 a[62:63], v143 offset:61440
v_mfma_f32_16x16x32_bf16 v[160:163], a[32:35], a[104:107], v[160:163]
s_add_u32 s93, s49, 39936
ds_read_b64_tr_b16 a[0:1], v148 offset:0
s_mov_b32 s46, 33030144
v_mfma_f32_16x16x32_bf16 v[192:195], a[32:35], a[108:111], v[192:195]
buffer_load_dwordx4 a[152:155], v38, s[24:27], s93 offen sc1
ds_read_b64_tr_b16 a[2:3], v148 offset:4096
v_mfma_f32_16x16x32_bf16 v[196:199], a[36:39], a[108:111], v[196:199]
buffer_load_dword v25, v30, s[24:27], s46 offen sc1
ds_read_b64_tr_b16 a[4:5], v149 offset:0
v_mfma_f32_16x16x32_bf16 v[164:167], a[36:39], a[104:107], v[164:167]
s_waitcnt lgkmcnt(11)
ds_read_b64_tr_b16 a[6:7], v149 offset:4096
v_mfma_f32_16x16x32_bf16 v[168:171], a[40:43], a[104:107], v[168:171]
s_nop 0
ds_read_b64_tr_b16 a[8:9], v150 offset:0
v_mfma_f32_16x16x32_bf16 v[200:203], a[40:43], a[108:111], v[200:203]
buffer_load_dwordx4 a[156:159], v39, s[24:27], s93 offen sc1
ds_read_b64_tr_b16 a[10:11], v150 offset:4096
v_mfma_f32_16x16x32_bf16 v[204:207], a[44:47], a[108:111], v[204:207]
s_add_u32 s97, s48, 786432
ds_read_b64_tr_b16 a[12:13], v151 offset:0
s_add_u32 m0, s82, 40960
v_mfma_f32_16x16x32_bf16 v[172:175], a[44:47], a[104:107], v[172:175]
s_waitcnt lgkmcnt(11)
ds_read_b64_tr_b16 a[14:15], v151 offset:4096
v_mfma_f32_16x16x32_bf16 v[176:179], a[48:51], a[104:107], v[176:179]
ds_read_b64_tr_b16 a[16:17], v154 offset:0
v_mfma_f32_16x16x32_bf16 v[208:211], a[48:51], a[108:111], v[208:211]
buffer_load_dwordx4 v34, s[16:19], s97 offen lds
ds_read_b64_tr_b16 a[18:19], v154 offset:4096
v_mfma_f32_16x16x32_bf16 v[212:215], a[52:55], a[108:111], v[212:215]
s_add_u32 m0, s82, 43008
ds_read_b64_tr_b16 a[20:21], v155 offset:0
v_mfma_f32_16x16x32_bf16 v[180:183], a[52:55], a[104:107], v[180:183]
s_waitcnt lgkmcnt(11)
ds_read_b64_tr_b16 a[22:23], v155 offset:4096
v_mfma_f32_16x16x32_bf16 v[184:187], a[56:59], a[104:107], v[184:187]
buffer_load_dwordx4 v35, s[16:19], s97 offen lds
ds_read_b64_tr_b16 a[24:25], v156 offset:0
v_mfma_f32_16x16x32_bf16 v[216:219], a[56:59], a[108:111], v[216:219]
ds_read_b64_tr_b16 a[26:27], v156 offset:4096
v_mfma_f32_16x16x32_bf16 v[220:223], a[60:63], a[108:111], v[220:223]
s_waitcnt vmcnt(22) lgkmcnt(10)
ds_read_b64_tr_b16 a[28:29], v157 offset:0
v_mfma_f32_16x16x32_bf16 v[188:191], a[60:63], a[104:107], v[188:191]
s_barrier
ds_read_b64_tr_b16 a[30:31], v157 offset:4096
v_mfma_f32_16x16x32_bf16 v[160:163], a[0:3], a[112:115], v[160:163]
s_add_u32 s95, s49, 43008
ds_read_b64_tr_b16 a[32:33], v148 offset:8192
v_mfma_f32_16x16x32_bf16 v[192:195], a[0:3], a[116:119], v[192:195]
buffer_load_dwordx4 a[160:163], v38, s[24:27], s95 offen sc1
v_mfma_f32_16x16x32_bf16 v[196:199], a[4:7], a[116:119], v[196:199]
s_nop 0
ds_read_b64_tr_b16 a[34:35], v148 offset:12288
ds_read_b64_tr_b16 a[36:37], v149 offset:8192
v_mfma_f32_16x16x32_bf16 v[164:167], a[4:7], a[112:115], v[164:167]
s_waitcnt lgkmcnt(11)
ds_read_b64_tr_b16 a[38:39], v149 offset:12288
v_mfma_f32_16x16x32_bf16 v[168:171], a[8:11], a[112:115], v[168:171]
ds_read_b64_tr_b16 a[40:41], v150 offset:8192
v_mfma_f32_16x16x32_bf16 v[200:203], a[8:11], a[116:119], v[200:203]
buffer_load_dwordx4 a[164:167], v39, s[24:27], s95 offen sc1
v_mfma_f32_16x16x32_bf16 v[204:207], a[12:15], a[116:119], v[204:207]
s_add_u32 s94, s48, 983040
ds_read_b64_tr_b16 a[42:43], v150 offset:12288
ds_read_b64_tr_b16 a[44:45], v151 offset:8192
v_mfma_f32_16x16x32_bf16 v[172:175], a[12:15], a[112:115], v[172:175]
s_waitcnt lgkmcnt(11)
ds_read_b64_tr_b16 a[46:47], v151 offset:12288
s_add_u32 m0, s82, 49152
v_mfma_f32_16x16x32_bf16 v[176:179], a[16:19], a[112:115], v[176:179]
s_nop 0
ds_read_b64_tr_b16 a[48:49], v154 offset:8192
v_mfma_f32_16x16x32_bf16 v[208:211], a[16:19], a[116:119], v[208:211]
buffer_load_dwordx4 v34, s[16:19], s94 offen lds
v_mfma_f32_16x16x32_bf16 v[212:215], a[20:23], a[116:119], v[212:215]
s_add_u32 m0, s82, 51200
ds_read_b64_tr_b16 a[50:51], v154 offset:12288
ds_read_b64_tr_b16 a[52:53], v155 offset:8192
v_mfma_f32_16x16x32_bf16 v[180:183], a[20:23], a[112:115], v[180:183]
s_waitcnt lgkmcnt(11)
ds_read_b64_tr_b16 a[54:55], v155 offset:12288
v_mfma_f32_16x16x32_bf16 v[184:187], a[24:27], a[112:115], v[184:187]
buffer_load_dwordx4 v35, s[16:19], s94 offen lds
v_mfma_f32_16x16x32_bf16 v[216:219], a[24:27], a[116:119], v[216:219]
s_nop 0
ds_read_b64_tr_b16 a[56:57], v156 offset:8192
ds_read_b64_tr_b16 a[58:59], v156 offset:12288
v_mfma_f32_16x16x32_bf16 v[220:223], a[28:31], a[116:119], v[220:223]
s_waitcnt vmcnt(24) lgkmcnt(10)
ds_read_b64_tr_b16 a[60:61], v157 offset:8192
v_mfma_f32_16x16x32_bf16 v[188:191], a[28:31], a[112:115], v[188:191]
s_barrier
ds_read_b64_tr_b16 a[62:63], v157 offset:12288
v_mfma_f32_16x16x32_bf16 v[160:163], a[32:35], a[120:123], v[160:163]
s_add_u32 s97, s49, 47104
ds_read_b64_tr_b16 a[0:1], v148 offset:16384
v_mfma_f32_16x16x32_bf16 v[192:195], a[32:35], a[124:127], v[192:195]
buffer_load_dwordx4 a[168:171], v38, s[24:27], s97 offen sc1
v_mfma_f32_16x16x32_bf16 v[196:199], a[36:39], a[124:127], v[196:199]
s_nop 0
ds_read_b64_tr_b16 a[2:3], v148 offset:20480
ds_read_b64_tr_b16 a[4:5], v149 offset:16384
v_mfma_f32_16x16x32_bf16 v[164:167], a[36:39], a[120:123], v[164:167]
s_waitcnt lgkmcnt(11)
ds_read_b64_tr_b16 a[6:7], v149 offset:20480
v_mfma_f32_16x16x32_bf16 v[168:171], a[40:43], a[120:123], v[168:171]
ds_read_b64_tr_b16 a[8:9], v150 offset:16384
v_mfma_f32_16x16x32_bf16 v[200:203], a[40:43], a[124:127], v[200:203]
buffer_load_dwordx4 a[172:175], v39, s[24:27], s97 offen sc1
v_mfma_f32_16x16x32_bf16 v[204:207], a[44:47], a[124:127], v[204:207]
s_add_u32 s96, s48, 1245184
ds_read_b64_tr_b16 a[10:11], v150 offset:20480
ds_read_b64_tr_b16 a[12:13], v151 offset:16384
v_mfma_f32_16x16x32_bf16 v[172:175], a[44:47], a[120:123], v[172:175]
s_waitcnt lgkmcnt(11)
ds_read_b64_tr_b16 a[14:15], v151 offset:20480
s_add_u32 m0, s82, 57344
v_mfma_f32_16x16x32_bf16 v[176:179], a[48:51], a[120:123], v[176:179]
s_nop 0
ds_read_b64_tr_b16 a[16:17], v154 offset:16384
v_mfma_f32_16x16x32_bf16 v[208:211], a[48:51], a[124:127], v[208:211]
buffer_load_dwordx4 v34, s[16:19], s96 offen lds
v_mfma_f32_16x16x32_bf16 v[212:215], a[52:55], a[124:127], v[212:215]
s_add_u32 m0, s82, 59392
ds_read_b64_tr_b16 a[18:19], v154 offset:20480
ds_read_b64_tr_b16 a[20:21], v155 offset:16384
v_mfma_f32_16x16x32_bf16 v[180:183], a[52:55], a[120:123], v[180:183]
s_waitcnt lgkmcnt(11)
ds_read_b64_tr_b16 a[22:23], v155 offset:20480
v_mfma_f32_16x16x32_bf16 v[184:187], a[56:59], a[120:123], v[184:187]
buffer_load_dwordx4 v35, s[16:19], s96 offen lds
v_mfma_f32_16x16x32_bf16 v[216:219], a[56:59], a[124:127], v[216:219]
s_nop 0
ds_read_b64_tr_b16 a[24:25], v156 offset:16384
Lpad10:
s_cbranch_execz Lpad14
s_nop 0
ds_read_b64_tr_b16 a[26:27], v156 offset:20480
v_mfma_f32_16x16x32_bf16 v[220:223], a[60:63], a[124:127], v[220:223]
s_waitcnt vmcnt(24) lgkmcnt(10)
ds_read_b64_tr_b16 a[28:29], v157 offset:16384
v_mfma_f32_16x16x32_bf16 v[188:191], a[60:63], a[120:123], v[188:191]
s_barrier
ds_read_b64_tr_b16 a[30:31], v157 offset:20480
Lv8:
v_mfma_f32_16x16x32_bf16 v[160:163], a[0:3], a[128:131], v[160:163]
s_add_u32 s94, s49, 50176
ds_read_b64_tr_b16 a[32:33], v148 offset:24576
s_waitcnt vmcnt(11)
v_cmp_gt_u32 vcc, s65, v25
s_nop 3
s_cbranch_vccz Lret3
s_mov_b32 s47, 0
Lslow3_l:
s_sleep 8
buffer_load_dword v25, v30, s[24:27], s46 offen sc1
s_add_u32 s47, s47, 1
s_waitcnt vmcnt(0)
v_cmp_gt_u32 vcc, s65, v25
s_cmp_gt_u32 s47, 0x40000
s_cbranch_scc1 Lret3
s_nop 3
s_cbranch_vccnz Lslow3_l
Lret3:
v_mfma_f32_16x16x32_bf16 v[192:195], a[0:3], a[132:135], v[192:195]
buffer_load_dwordx4 a[176:179], v38, s[24:27], s94 offen sc1
ds_read_b64_tr_b16 a[34:35], v148 offset:28672
v_mfma_f32_16x16x32_bf16 v[196:199], a[4:7], a[132:135], v[196:199]
s_mov_b32 s51, 32636928
ds_read_b64_tr_b16 a[36:37], v149 offset:24576
v_mfma_f32_16x16x32_bf16 v[164:167], a[4:7], a[128:131], v[164:167]
s_waitcnt lgkmcnt(11)
buffer_load_dword v46, v147, s[24:27], s51 offen sc1
v_mfma_f32_16x16x32_bf16 v[168:171], a[8:11], a[128:131], v[168:171]
s_nop 0
ds_read_b64_tr_b16 a[38:39], v149 offset:28672
ds_read_b64_tr_b16 a[40:41], v150 offset:24576
v_mfma_f32_16x16x32_bf16 v[200:203], a[8:11], a[132:135], v[200:203]
buffer_load_dwordx4 a[180:183], v39, s[24:27], s94 offen sc1
ds_read_b64_tr_b16 a[42:43], v150 offset:28672
v_mfma_f32_16x16x32_bf16 v[204:207], a[12:15], a[132:135], v[204:207]
s_add_u32 s93, s48, 1441792
ds_read_b64_tr_b16 a[44:45], v151 offset:24576
s_add_u32 m0, s82, 65536
v_mfma_f32_16x16x32_bf16 v[172:175], a[12:15], a[128:131], v[172:175]
s_waitcnt lgkmcnt(11)
ds_read_b64_tr_b16 a[46:47], v151 offset:28672
v_mfma_f32_16x16x32_bf16 v[176:179], a[16:19], a[128:131], v[176:179]
ds_read_b64_tr_b16 a[48:49], v154 offset:24576
v_mfma_f32_16x16x32_bf16 v[208:211], a[16:19], a[132:135], v[208:211]
buffer_load_dwordx4 v34, s[16:19], s93 offen lds
ds_read_b64_tr_b16 a[50:51], v154 offset:28672
v_mfma_f32_16x16x32_bf16 v[212:215], a[20:23], a[132:135], v[212:215]
s_add_u32 m0, s82, 67584
ds_read_b64_tr_b16 a[52:53], v155 offset:24576
v_mfma_f32_16x16x32_bf16 v[180:183], a[20:23], a[128:131], v[180:183]
s_waitcnt lgkmcnt(11)
ds_read_b64_tr_b16 a[54:55], v155 offset:28672
v_mfma_f32_16x16x32_bf16 v[184:187], a[24:27], a[128:131], v[184:187]
buffer_load_dwordx4 v35, s[16:19], s93 offen lds
ds_read_b64_tr_b16 a[56:57], v156 offset:24576
v_mfma_f32_16x16x32_bf16 v[216:219], a[24:27], a[132:135], v[216:219]
ds_read_b64_tr_b16 a[58:59], v156 offset:28672
v_mfma_f32_16x16x32_bf16 v[220:223], a[28:31], a[132:135], v[220:223]
s_waitcnt lgkmcnt(10)
ds_read_b64_tr_b16 a[60:61], v157 offset:24576
v_mfma_f32_16x16x32_bf16 v[188:191], a[28:31], a[128:131], v[188:191]
s_barrier
ds_read_b64_tr_b16 a[62:63], v157 offset:28672
v_mfma_f32_16x16x32_bf16 v[160:163], a[32:35], a[136:139], v[160:163]
s_add_u32 s96, s49, 54272
ds_read_b64_tr_b16 a[0:1], v148 offset:32768
v_mfma_f32_16x16x32_bf16 v[192:195], a[32:35], a[140:143], v[192:195]
buffer_load_dwordx4 a[184:187], v38, s[24:27], s96 offen sc1
v_mfma_f32_16x16x32_bf16 v[196:199], a[36:39], a[140:143], v[196:199]
s_nop 0
ds_read_b64_tr_b16 a[2:3], v148 offset:36864
ds_read_b64_tr_b16 a[4:5], v149 offset:32768
v_mfma_f32_16x16x32_bf16 v[164:167], a[36:39], a[136:139], v[164:167]
s_waitcnt lgkmcnt(11)
ds_read_b64_tr_b16 a[6:7], v149 offset:36864
v_mfma_f32_16x16x32_bf16 v[168:171], a[40:43], a[136:139], v[168:171]
ds_read_b64_tr_b16 a[8:9], v150 offset:32768
v_mfma_f32_16x16x32_bf16 v[200:203], a[40:43], a[140:143], v[200:203]
buffer_load_dwordx4 a[188:191], v39, s[24:27], s96 offen sc1
v_mfma_f32_16x16x32_bf16 v[204:207], a[44:47], a[140:143], v[204:207]
s_add_u32 s95, s48, 1703936
ds_read_b64_tr_b16 a[10:11], v150 offset:36864
ds_read_b64_tr_b16 a[12:13], v151 offset:32768
v_mfma_f32_16x16x32_bf16 v[172:175], a[44:47], a[136:139], v[172:175]
s_waitcnt lgkmcnt(11)
ds_read_b64_tr_b16 a[14:15], v151 offset:36864
s_add_u32 m0, s82, 73728
v_mfma_f32_16x16x32_bf16 v[176:179], a[48:51], a[136:139], v[176:179]
s_nop 0
ds_read_b64_tr_b16 a[16:17], v154 offset:32768
v_mfma_f32_16x16x32_bf16 v[208:211], a[48:51], a[140:143], v[208:211]
buffer_load_dwordx4 v34, s[16:19], s95 offen lds
v_mfma_f32_16x16x32_bf16 v[212:215], a[52:55], a[140:143], v[212:215]
s_add_u32 m0, s82, 75776
ds_read_b64_tr_b16 a[18:19], v154 offset:36864
ds_read_b64_tr_b16 a[20:21], v155 offset:32768
v_mfma_f32_16x16x32_bf16 v[180:183], a[52:55], a[136:139], v[180:183]
s_waitcnt lgkmcnt(11)
ds_read_b64_tr_b16 a[22:23], v155 offset:36864
v_mfma_f32_16x16x32_bf16 v[184:187], a[56:59], a[136:139], v[184:187]
buffer_load_dwordx4 v35, s[16:19], s95 offen lds
v_mfma_f32_16x16x32_bf16 v[216:219], a[56:59], a[140:143], v[216:219]
s_nop 0
ds_read_b64_tr_b16 a[24:25], v156 offset:32768
ds_read_b64_tr_b16 a[26:27], v156 offset:36864
v_mfma_f32_16x16x32_bf16 v[220:223], a[60:63], a[140:143], v[220:223]
s_waitcnt lgkmcnt(10)
ds_read_b64_tr_b16 a[28:29], v157 offset:32768
v_mfma_f32_16x16x32_bf16 v[188:191], a[60:63], a[136:139], v[188:191]
s_barrier
ds_read_b64_tr_b16 a[30:31], v157 offset:36864
v_mfma_f32_16x16x32_bf16 v[160:163], a[0:3], a[144:147], v[160:163]
s_add_u32 s93, s49, 1024
ds_read_b64_tr_b16 a[32:33], v148 offset:40960
v_mfma_f32_16x16x32_bf16 v[192:195], a[0:3], a[148:151], v[192:195]
buffer_load_dwordx4 a[64:67], v38, s[24:27], s93 offen sc1
v_mfma_f32_16x16x32_bf16 v[196:199], a[4:7], a[148:151], v[196:199]
s_nop 0
ds_read_b64_tr_b16 a[34:35], v148 offset:45056
ds_read_b64_tr_b16 a[36:37], v149 offset:40960
v_mfma_f32_16x16x32_bf16 v[164:167], a[4:7], a[144:147], v[164:167]
s_waitcnt lgkmcnt(11)
ds_read_b64_tr_b16 a[38:39], v149 offset:45056
v_mfma_f32_16x16x32_bf16 v[168:171], a[8:11], a[144:147], v[168:171]
ds_read_b64_tr_b16 a[40:41], v150 offset:40960
v_mfma_f32_16x16x32_bf16 v[200:203], a[8:11], a[148:151], v[200:203]
buffer_load_dwordx4 a[68:71], v39, s[24:27], s93 offen sc1
v_mfma_f32_16x16x32_bf16 v[204:207], a[12:15], a[148:151], v[204:207]
s_add_u32 s97, s48, 1900544
ds_read_b64_tr_b16 a[42:43], v150 offset:45056
ds_read_b64_tr_b16 a[44:45], v151 offset:40960
v_mfma_f32_16x16x32_bf16 v[172:175], a[12:15], a[144:147], v[172:175]
s_waitcnt lgkmcnt(11)
ds_read_b64_tr_b16 a[46:47], v151 offset:45056
s_add_u32 m0, s82, 81920
v_mfma_f32_16x16x32_bf16 v[176:179], a[16:19], a[144:147], v[176:179]
s_nop 0
ds_read_b64_tr_b16 a[48:49], v154 offset:40960
v_mfma_f32_16x16x32_bf16 v[208:211], a[16:19], a[148:151], v[208:211]
buffer_load_dwordx4 v34, s[16:19], s97 offen lds
v_mfma_f32_16x16x32_bf16 v[212:215], a[20:23], a[148:151], v[212:215]
s_add_u32 m0, s82, 83968
ds_read_b64_tr_b16 a[50:51], v154 offset:45056
ds_read_b64_tr_b16 a[52:53], v155 offset:40960
v_mfma_f32_16x16x32_bf16 v[180:183], a[20:23], a[144:147], v[180:183]
s_waitcnt lgkmcnt(11)
ds_read_b64_tr_b16 a[54:55], v155 offset:45056
v_mfma_f32_16x16x32_bf16 v[184:187], a[24:27], a[144:147], v[184:187]
buffer_load_dwordx4 v35, s[16:19], s97 offen lds
v_mfma_f32_16x16x32_bf16 v[216:219], a[24:27], a[148:151], v[216:219]
s_nop 0
ds_read_b64_tr_b16 a[56:57], v156 offset:40960
ds_read_b64_tr_b16 a[58:59], v156 offset:45056
v_mfma_f32_16x16x32_bf16 v[220:223], a[28:31], a[148:151], v[220:223]
s_waitcnt vmcnt(23) lgkmcnt(10)
ds_read_b64_tr_b16 a[60:61], v157 offset:40960
v_mfma_f32_16x16x32_bf16 v[188:191], a[28:31], a[144:147], v[188:191]
s_barrier
ds_read_b64_tr_b16 a[62:63], v157 offset:45056
v_mfma_f32_16x16x32_bf16 v[160:163], a[32:35], a[152:155], v[160:163]
s_add_u32 s95, s49, 5120
ds_read_b64_tr_b16 a[0:1], v148 offset:49152
v_and_b32 v44, 15, v0
v_lshlrev_b32 v44, 4, v44
v_mfma_f32_16x16x32_bf16 v[192:195], a[32:35], a[156:159], v[192:195]
buffer_load_dwordx4 a[72:75], v38, s[24:27], s95 offen sc1
ds_read_b64_tr_b16 a[2:3], v148 offset:53248
v_mfma_f32_16x16x32_bf16 v[196:199], a[36:39], a[156:159], v[196:199]
s_lshl_b32 s44, s84, 8
ds_read_b64_tr_b16 a[4:5], v149 offset:49152
s_add_u32 s44, s44, 31727616
s_waitcnt vmcnt(12)
v_mfma_f32_16x16x32_bf16 v[164:167], a[36:39], a[152:155], v[164:167]
s_waitcnt lgkmcnt(11)
buffer_load_dwordx4 v[136:139], v44, s[24:27], s44 offen sc1
v_mfma_f32_16x16x32_bf16 v[168:171], a[40:43], a[152:155], v[168:171]
s_lshl_b32 s45, s80, 3
ds_read_b64_tr_b16 a[6:7], v149 offset:53248
ds_read_b64_tr_b16 a[8:9], v150 offset:49152
s_add_u32 s44, s44, s45
v_mfma_f32_16x16x32_bf16 v[200:203], a[40:43], a[156:159], v[200:203]
buffer_load_dwordx4 a[76:79], v39, s[24:27], s95 offen sc1
ds_read_b64_tr_b16 a[10:11], v150 offset:53248
v_mfma_f32_16x16x32_bf16 v[204:207], a[44:47], a[156:159], v[204:207]
buffer_load_dwordx2 v[22:23], v44, s[24:27], s44 offen sc1
ds_read_b64_tr_b16 a[12:13], v151 offset:49152
v_mfma_f32_16x16x32_bf16 v[172:175], a[44:47], a[152:155], v[172:175]
s_waitcnt lgkmcnt(11)
ds_read_b64_tr_b16 a[14:15], v151 offset:53248
s_add_u32 s94, s48, 2162688
s_add_u32 m0, s82, 90112
v_mfma_f32_16x16x32_bf16 v[176:179], a[48:51], a[152:155], v[176:179]
ds_read_b64_tr_b16 a[16:17], v154 offset:49152
v_cmp_gt_u32 vcc, s64, v46
s_nop 3
s_cbranch_vccz Lret4
s_mov_b32 s47, 0
Lslow4_l:
s_sleep 8
buffer_load_dword v46, v147, s[24:27], s51 offen sc1
s_add_u32 s47, s47, 1
s_waitcnt vmcnt(0)
v_cmp_gt_u32 vcc, s64, v46
s_cmp_gt_u32 s47, 0x40000
s_cbranch_scc1 Lret4
s_nop 3
s_cbranch_vccnz Lslow4_l
Lret4:
v_mfma_f32_16x16x32_bf16 v[208:211], a[48:51], a[156:159], v[208:211]
buffer_load_dwordx4 v34, s[16:19], s94 offen lds
ds_read_b64_tr_b16 a[18:19], v154 offset:53248
v_mfma_f32_16x16x32_bf16 v[212:215], a[52:55], a[156:159], v[212:215]
s_add_u32 m0, s82, 92160
ds_read_b64_tr_b16 a[20:21], v155 offset:49152
v_mfma_f32_16x16x32_bf16 v[180:183], a[52:55], a[152:155], v[180:183]
s_waitcnt lgkmcnt(11)
ds_read_b64_tr_b16 a[22:23], v155 offset:53248
v_mfma_f32_16x16x32_bf16 v[184:187], a[56:59], a[152:155], v[184:187]
buffer_load_dwordx4 v35, s[16:19], s94 offen lds
ds_read_b64_tr_b16 a[24:25], v156 offset:49152
v_mfma_f32_16x16x32_bf16 v[216:219], a[56:59], a[156:159], v[216:219]
ds_read_b64_tr_b16 a[26:27], v156 offset:53248
v_mfma_f32_16x16x32_bf16 v[220:223], a[60:63], a[156:159], v[220:223]
s_waitcnt lgkmcnt(10)
ds_read_b64_tr_b16 a[28:29], v157 offset:49152
v_mfma_f32_16x16x32_bf16 v[188:191], a[60:63], a[152:155], v[188:191]
s_barrier
ds_read_b64_tr_b16 a[30:31], v157 offset:53248
v_mfma_f32_16x16x32_bf16 v[160:163], a[0:3], a[160:163], v[160:163]
s_add_u32 s96, s49, 8192
ds_read_b64_tr_b16 a[32:33], v148 offset:57344
s_lshl_b32 s50, s84, 7
s_add_u32 s3, s50, 0
v_mfma_f32_16x16x32_bf16 v[192:195], a[0:3], a[164:167], v[192:195]
buffer_load_dwordx4 a[80:83], v38, s[24:27], s96 offen sc1
ds_read_b64_tr_b16 a[34:35], v148 offset:61440
v_mfma_f32_16x16x32_bf16 v[196:199], a[4:7], a[164:167], v[196:199]
buffer_load_dwordx4 v[48:51], v144, s[24:27], s3 offen sc1
ds_read_b64_tr_b16 a[36:37], v149 offset:57344
v_mfma_f32_16x16x32_bf16 v[164:167], a[4:7], a[160:163], v[164:167]
s_waitcnt lgkmcnt(11)
ds_read_b64_tr_b16 a[38:39], v149 offset:61440
s_add_u32 s3, s50, 40960
v_mfma_f32_16x16x32_bf16 v[168:171], a[8:11], a[160:163], v[168:171]
buffer_load_dwordx4 v[52:55], v144, s[24:27], s3 offen sc1
ds_read_b64_tr_b16 a[40:41], v150 offset:57344
v_mfma_f32_16x16x32_bf16 v[200:203], a[8:11], a[164:167], v[200:203]
buffer_load_dwordx4 a[84:87], v39, s[24:27], s96 offen sc1
ds_read_b64_tr_b16 a[42:43], v150 offset:61440
v_mfma_f32_16x16x32_bf16 v[204:207], a[12:15], a[164:167], v[204:207]
s_add_u32 s3, s57, 4096
ds_read_b64_tr_b16 a[44:45], v151 offset:57344
v_mfma_f32_16x16x32_bf16 v[172:175], a[12:15], a[160:163], v[172:175]
s_waitcnt lgkmcnt(11)
buffer_load_dwordx4 v[56:59], v144, s[24:27], s3 offen sc1
v_mfma_f32_16x16x32_bf16 v[176:179], a[16:19], a[160:163], v[176:179]
s_add_u32 s3, s57, 45056
ds_read_b64_tr_b16 a[46:47], v151 offset:61440
ds_read_b64_tr_b16 a[48:49], v154 offset:57344
v_mfma_f32_16x16x32_bf16 v[208:211], a[16:19], a[164:167], v[208:211]
buffer_load_dwordx4 v[60:63], v144, s[24:27], s3 offen sc1
ds_read_b64_tr_b16 a[50:51], v154 offset:61440
v_mfma_f32_16x16x32_bf16 v[212:215], a[20:23], a[164:167], v[212:215]
s_nop 0
ds_read_b64_tr_b16 a[52:53], v155 offset:57344
v_mfma_f32_16x16x32_bf16 v[180:183], a[20:23], a[160:163], v[180:183]
s_waitcnt lgkmcnt(11)
ds_read_b64_tr_b16 a[54:55], v155 offset:61440
v_mfma_f32_16x16x32_bf16 v[184:187], a[24:27], a[160:163], v[184:187]
ds_read_b64_tr_b16 a[56:57], v156 offset:57344
v_mfma_f32_16x16x32_bf16 v[216:219], a[24:27], a[164:167], v[216:219]
ds_read_b64_tr_b16 a[58:59], v156 offset:61440
v_mfma_f32_16x16x32_bf16 v[220:223], a[28:31], a[164:167], v[220:223]
s_waitcnt lgkmcnt(10)
ds_read_b64_tr_b16 a[60:61], v157 offset:57344
v_mfma_f32_16x16x32_bf16 v[188:191], a[28:31], a[160:163], v[188:191]
s_barrier
ds_read_b64_tr_b16 a[62:63], v157 offset:61440
v_mfma_f32_16x16x32_bf16 v[160:163], a[32:35], a[168:171], v[160:163]
s_add_u32 s93, s49, 12288
ds_read_b64_tr_b16 a[0:1], v132 offset:0
v_mfma_f32_16x16x32_bf16 v[192:195], a[32:35], a[172:175], v[192:195]
buffer_load_dwordx4 a[88:91], v38, s[24:27], s93 offen sc1
v_mfma_f32_16x16x32_bf16 v[196:199], a[36:39], a[172:175], v[196:199]
s_nop 0
ds_read_b64_tr_b16 a[2:3], v132 offset:4096
ds_read_b64_tr_b16 a[4:5], v133 offset:0
v_mfma_f32_16x16x32_bf16 v[164:167], a[36:39], a[168:171], v[164:167]
s_waitcnt lgkmcnt(11)
ds_read_b64_tr_b16 a[6:7], v133 offset:4096
v_mfma_f32_16x16x32_bf16 v[168:171], a[40:43], a[168:171], v[168:171]
ds_read_b64_tr_b16 a[8:9], v134 offset:0
v_mfma_f32_16x16x32_bf16 v[200:203], a[40:43], a[172:175], v[200:203]
buffer_load_dwordx4 a[92:95], v39, s[24:27], s93 offen sc1
v_mfma_f32_16x16x32_bf16 v[204:207], a[44:47], a[172:175], v[204:207]
s_add_u32 s97, s48, 2359296
ds_read_b64_tr_b16 a[10:11], v134 offset:4096
ds_read_b64_tr_b16 a[12:13], v135 offset:0
v_mfma_f32_16x16x32_bf16 v[172:175], a[44:47], a[168:171], v[172:175]
s_waitcnt lgkmcnt(11)
ds_read_b64_tr_b16 a[14:15], v135 offset:4096
s_add_u32 m0, s82, 98304
v_mfma_f32_16x16x32_bf16 v[176:179], a[48:51], a[168:171], v[176:179]
s_nop 0
ds_read_b64_tr_b16 a[16:17], v140 offset:0
v_mfma_f32_16x16x32_bf16 v[208:211], a[48:51], a[172:175], v[208:211]
buffer_load_dwordx4 v34, s[16:19], s97 offen lds
v_mfma_f32_16x16x32_bf16 v[212:215], a[52:55], a[172:175], v[212:215]
s_add_u32 m0, s82, 100352
ds_read_b64_tr_b16 a[18:19], v140 offset:4096
ds_read_b64_tr_b16 a[20:21], v141 offset:0
v_mfma_f32_16x16x32_bf16 v[180:183], a[52:55], a[168:171], v[180:183]
s_waitcnt lgkmcnt(11)
ds_read_b64_tr_b16 a[22:23], v141 offset:4096
v_mfma_f32_16x16x32_bf16 v[184:187], a[56:59], a[168:171], v[184:187]
buffer_load_dwordx4 v35, s[16:19], s97 offen lds
v_mfma_f32_16x16x32_bf16 v[216:219], a[56:59], a[172:175], v[216:219]
s_nop 0
ds_read_b64_tr_b16 a[24:25], v142 offset:0
ds_read_b64_tr_b16 a[26:27], v142 offset:4096
v_mfma_f32_16x16x32_bf16 v[220:223], a[60:63], a[172:175], v[220:223]
s_waitcnt vmcnt(26) lgkmcnt(10)
ds_read_b64_tr_b16 a[28:29], v143 offset:0
v_mfma_f32_16x16x32_bf16 v[188:191], a[60:63], a[168:171], v[188:191]
s_barrier
ds_read_b64_tr_b16 a[30:31], v143 offset:4096
v_mfma_f32_16x16x32_bf16 v[160:163], a[0:3], a[176:179], v[160:163]
s_add_u32 s95, s49, 15360
ds_read_b64_tr_b16 a[32:33], v132 offset:8192
v_mfma_f32_16x16x32_bf16 v[192:195], a[0:3], a[180:183], v[192:195]
buffer_load_dwordx4 a[96:99], v38, s[24:27], s95 offen sc1
v_mfma_f32_16x16x32_bf16 v[196:199], a[4:7], a[180:183], v[196:199]
s_nop 0
ds_read_b64_tr_b16 a[34:35], v132 offset:12288
ds_read_b64_tr_b16 a[36:37], v133 offset:8192
v_mfma_f32_16x16x32_bf16 v[164:167], a[4:7], a[176:179], v[164:167]
s_waitcnt lgkmcnt(11)
ds_read_b64_tr_b16 a[38:39], v133 offset:12288
v_mfma_f32_16x16x32_bf16 v[168:171], a[8:11], a[176:179], v[168:171]
ds_read_b64_tr_b16 a[40:41], v134 offset:8192
v_mfma_f32_16x16x32_bf16 v[200:203], a[8:11], a[180:183], v[200:203]
buffer_load_dwordx4 a[100:103], v39, s[24:27], s95 offen sc1
v_mfma_f32_16x16x32_bf16 v[204:207], a[12:15], a[180:183], v[204:207]
s_add_u32 s94, s48, 2621440
ds_read_b64_tr_b16 a[42:43], v134 offset:12288
ds_read_b64_tr_b16 a[44:45], v135 offset:8192
v_mfma_f32_16x16x32_bf16 v[172:175], a[12:15], a[176:179], v[172:175]
s_waitcnt lgkmcnt(11)
ds_read_b64_tr_b16 a[46:47], v135 offset:12288
s_add_u32 m0, s82, 106496
v_mfma_f32_16x16x32_bf16 v[176:179], a[16:19], a[176:179], v[176:179]
s_nop 0
ds_read_b64_tr_b16 a[48:49], v140 offset:8192
v_mfma_f32_16x16x32_bf16 v[208:211], a[16:19], a[180:183], v[208:211]
buffer_load_dwordx4 v34, s[16:19], s94 offen lds
v_mfma_f32_16x16x32_bf16 v[212:215], a[20:23], a[180:183], v[212:215]
s_add_u32 m0, s82, 108544
ds_read_b64_tr_b16 a[50:51], v140 offset:12288
ds_read_b64_tr_b16 a[52:53], v141 offset:8192
v_mfma_f32_16x16x32_bf16 v[180:183], a[20:23], a[176:179], v[180:183]
s_waitcnt lgkmcnt(11)
ds_read_b64_tr_b16 a[54:55], v141 offset:12288
v_mfma_f32_16x16x32_bf16 v[184:187], a[24:27], a[176:179], v[184:187]
buffer_load_dwordx4 v35, s[16:19], s94 offen lds
v_mfma_f32_16x16x32_bf16 v[216:219], a[24:27], a[180:183], v[216:219]
s_nop 0
ds_read_b64_tr_b16 a[56:57], v142 offset:8192
ds_read_b64_tr_b16 a[58:59], v142 offset:12288
v_mfma_f32_16x16x32_bf16 v[220:223], a[28:31], a[180:183], v[220:223]
s_waitcnt vmcnt(26) lgkmcnt(10)
ds_read_b64_tr_b16 a[60:61], v143 offset:8192
v_mfma_f32_16x16x32_bf16 v[188:191], a[28:31], a[176:179], v[188:191]
s_barrier
ds_read_b64_tr_b16 a[62:63], v143 offset:12288
v_mfma_f32_16x16x32_bf16 v[160:163], a[32:35], a[184:187], v[160:163]
s_add_u32 s97, s49, 19456
ds_read_b64_tr_b16 a[0:1], v132 offset:16384
s_waitcnt vmcnt(8)
v_add_f32 v48, v48, v52
v_mfma_f32_16x16x32_bf16 v[192:195], a[32:35], a[188:191], v[192:195]
buffer_load_dwordx4 a[104:107], v38, s[24:27], s97 offen sc1
ds_read_b64_tr_b16 a[2:3], v132 offset:20480
v_mfma_f32_16x16x32_bf16 v[196:199], a[36:39], a[188:191], v[196:199]
ds_read_b64_tr_b16 a[4:5], v133 offset:16384
v_add_f32 v49, v49, v53
v_add_f32 v50, v50, v54
v_mfma_f32_16x16x32_bf16 v[164:167], a[36:39], a[184:187], v[164:167]
s_waitcnt lgkmcnt(11)
ds_read_b64_tr_b16 a[6:7], v133 offset:20480
v_add_f32 v51, v51, v55
v_add_f32 v56, v56, v60
v_mfma_f32_16x16x32_bf16 v[168:171], a[40:43], a[184:187], v[168:171]
ds_read_b64_tr_b16 a[8:9], v134 offset:16384
v_add_f32 v57, v57, v61
v_add_f32 v58, v58, v62
v_mfma_f32_16x16x32_bf16 v[200:203], a[40:43], a[188:191], v[200:203]
buffer_load_dwordx4 a[108:111], v39, s[24:27], s97 offen sc1
ds_read_b64_tr_b16 a[10:11], v134 offset:20480
v_mfma_f32_16x16x32_bf16 v[204:207], a[44:47], a[188:191], v[204:207]
s_add_u32 s96, s48, 2818048
ds_read_b64_tr_b16 a[12:13], v135 offset:16384
s_add_u32 m0, s82, 114688
v_add_f32 v59, v59, v63
v_mfma_f32_16x16x32_bf16 v[172:175], a[44:47], a[184:187], v[172:175]
s_waitcnt lgkmcnt(11)
ds_read_b64_tr_b16 a[14:15], v135 offset:20480
v_add_f32_dpp v48, v48, v48 row_ror:8 row_mask:0xf bank_mask:0xf
v_add_f32_dpp v49, v49, v49 row_ror:8 row_mask:0xf bank_mask:0xf
v_mfma_f32_16x16x32_bf16 v[176:179], a[48:51], a[184:187], v[176:179]
s_nop 0
ds_read_b64_tr_b16 a[16:17], v140 offset:16384
v_add_f32_dpp v50, v50, v50 row_ror:8 row_mask:0xf bank_mask:0xf
v_add_f32_dpp v51, v51, v51 row_ror:8 row_mask:0xf bank_mask:0xf
v_mfma_f32_16x16x32_bf16 v[208:211], a[48:51], a[188:191], v[208:211]
buffer_load_dwordx4 v34, s[16:19], s96 offen lds
ds_read_b64_tr_b16 a[18:19], v140 offset:20480
v_mfma_f32_16x16x32_bf16 v[212:215], a[52:55], a[188:191], v[212:215]
s_add_u32 m0, s82, 116736
ds_read_b64_tr_b16 a[20:21], v141 offset:16384
v_add_f32_dpp v56, v56, v56 row_ror:8 row_mask:0xf bank_mask:0xf
v_add_f32_dpp v57, v57, v57 row_ror:8 row_mask:0xf bank_mask:0xf
v_mfma_f32_16x16x32_bf16 v[180:183], a[52:55], a[184:187], v[180:183]
s_waitcnt lgkmcnt(11)
ds_read_b64_tr_b16 a[22:23], v141 offset:20480
v_add_f32_dpp v58, v58, v58 row_ror:8 row_mask:0xf bank_mask:0xf
v_add_f32_dpp v59, v59, v59 row_ror:8 row_mask:0xf bank_mask:0xf
v_mfma_f32_16x16x32_bf16 v[184:187], a[56:59], a[184:187], v[184:187]
buffer_load_dwordx4 v35, s[16:19], s96 offen lds
ds_read_b64_tr_b16 a[24:25], v142 offset:16384
v_mfma_f32_16x16x32_bf16 v[216:219], a[56:59], a[188:191], v[216:219]
ds_read_b64_tr_b16 a[26:27], v142 offset:20480
v_mov_b32 v52, v48
v_mov_b32 v53, v49
v_mfma_f32_16x16x32_bf16 v[220:223], a[60:63], a[188:191], v[220:223]
s_waitcnt lgkmcnt(10)
ds_read_b64_tr_b16 a[28:29], v143 offset:16384
v_mov_b32 v54, v50
v_mov_b32 v55, v51
v_mfma_f32_16x16x32_bf16 v[188:191], a[60:63], a[184:187], v[188:191]
s_barrier
ds_read_b64_tr_b16 a[30:31], v143 offset:20480
v_mov_b32 v60, v56
v_mov_b32 v61, v57
Lv16:
v_mfma_f32_16x16x32_bf16 v[160:163], a[0:3], a[64:67], v[160:163]
s_add_u32 s94, s49, 22528
ds_read_b64_tr_b16 a[32:33], v132 offset:24576
v_mov_b32 v62, v58
v_mov_b32 v63, v59
v_mfma_f32_16x16x32_bf16 v[192:195], a[0:3], a[68:71], v[192:195]
buffer_load_dwordx4 a[112:115], v38, s[24:27], s94 offen sc1
ds_read_b64_tr_b16 a[34:35], v132 offset:28672
v_mfma_f32_16x16x32_bf16 v[196:199], a[4:7], a[68:71], v[196:199]
ds_read_b64_tr_b16 a[36:37], v133 offset:24576
v_permlane16_swap_b32 v48, v52
v_permlane16_swap_b32 v49, v53
v_mfma_f32_16x16x32_bf16 v[164:167], a[4:7], a[64:67], v[164:167]
s_waitcnt lgkmcnt(11)
ds_read_b64_tr_b16 a[38:39], v133 offset:28672
v_permlane16_swap_b32 v50, v54
v_permlane16_swap_b32 v51, v55
v_mfma_f32_16x16x32_bf16 v[168:171], a[8:11], a[64:67], v[168:171]
ds_read_b64_tr_b16 a[40:41], v134 offset:24576
v_permlane16_swap_b32 v56, v60
v_permlane16_swap_b32 v57, v61
v_mfma_f32_16x16x32_bf16 v[200:203], a[8:11], a[68:71], v[200:203]
buffer_load_dwordx4 a[116:119], v39, s[24:27], s94 offen sc1
ds_read_b64_tr_b16 a[42:43], v134 offset:28672
v_mfma_f32_16x16x32_bf16 v[204:207], a[12:15], a[68:71], v[204:207]
s_add_u32 s93, s48, 3080192
ds_read_b64_tr_b16 a[44:45], v135 offset:24576
s_add_u32 m0, s82, 122880
v_permlane16_swap_b32 v58, v62
v_mfma_f32_16x16x32_bf16 v[172:175], a[12:15], a[64:67], v[172:175]
s_waitcnt lgkmcnt(11)
ds_read_b64_tr_b16 a[46:47], v135 offset:28672
v_permlane16_swap_b32 v59, v63
v_add_f32 v48, v48, v52
v_mfma_f32_16x16x32_bf16 v[176:179], a[16:19], a[64:67], v[176:179]
ds_read_b64_tr_b16 a[48:49], v140 offset:24576
v_add_f32 v49, v49, v53
v_add_f32 v50, v50, v54
v_mfma_f32_16x16x32_bf16 v[208:211], a[16:19], a[68:71], v[208:211]
buffer_load_dwordx4 v34, s[16:19], s93 offen lds
ds_read_b64_tr_b16 a[50:51], v140 offset:28672
v_mfma_f32_16x16x32_bf16 v[212:215], a[20:23], a[68:71], v[212:215]
s_add_u32 m0, s82, 124928
ds_read_b64_tr_b16 a[52:53], v141 offset:24576
v_add_f32 v51, v51, v55
v_add_f32 v56, v56, v60
v_mfma_f32_16x16x32_bf16 v[180:183], a[20:23], a[64:67], v[180:183]
s_waitcnt lgkmcnt(11)
ds_read_b64_tr_b16 a[54:55], v141 offset:28672
v_add_f32 v57, v57, v61
v_add_f32 v58, v58, v62
v_mfma_f32_16x16x32_bf16 v[184:187], a[24:27], a[64:67], v[184:187]
buffer_load_dwordx4 v35, s[16:19], s93 offen lds
ds_read_b64_tr_b16 a[56:57], v142 offset:24576
v_mfma_f32_16x16x32_bf16 v[216:219], a[24:27], a[68:71], v[216:219]
ds_read_b64_tr_b16 a[58:59], v142 offset:28672
v_add_f32 v59, v59, v63
v_mov_b32 v52, v48
v_mfma_f32_16x16x32_bf16 v[220:223], a[28:31], a[68:71], v[220:223]
s_waitcnt lgkmcnt(10)
ds_read_b64_tr_b16 a[60:61], v143 offset:24576
v_mov_b32 v53, v49
v_mov_b32 v54, v50
v_mfma_f32_16x16x32_bf16 v[188:191], a[28:31], a[64:67], v[188:191]
s_barrier
ds_read_b64_tr_b16 a[62:63], v143 offset:28672
v_mov_b32 v55, v51
v_mov_b32 v60, v56
v_mfma_f32_16x16x32_bf16 v[160:163], a[32:35], a[72:75], v[160:163]
s_add_u32 s96, s49, 26624
ds_read_b64_tr_b16 a[0:1], v132 offset:32768
v_mov_b32 v61, v57
v_mov_b32 v62, v58
v_mfma_f32_16x16x32_bf16 v[192:195], a[32:35], a[76:79], v[192:195]
buffer_load_dwordx4 a[120:123], v38, s[24:27], s96 offen sc1
ds_read_b64_tr_b16 a[2:3], v132 offset:36864
v_mfma_f32_16x16x32_bf16 v[196:199], a[36:39], a[76:79], v[196:199]
ds_read_b64_tr_b16 a[4:5], v133 offset:32768
v_mov_b32 v63, v59
v_permlane32_swap_b32 v48, v52
v_mfma_f32_16x16x32_bf16 v[164:167], a[36:39], a[72:75], v[164:167]
s_waitcnt lgkmcnt(11)
ds_read_b64_tr_b16 a[6:7], v133 offset:36864
v_permlane32_swap_b32 v49, v53
v_permlane32_swap_b32 v50, v54
v_mfma_f32_16x16x32_bf16 v[168:171], a[40:43], a[72:75], v[168:171]
ds_read_b64_tr_b16 a[8:9], v134 offset:32768
v_permlane32_swap_b32 v51, v55
v_permlane32_swap_b32 v56, v60
v_mfma_f32_16x16x32_bf16 v[200:203], a[40:43], a[76:79], v[200:203]
buffer_load_dwordx4 a[124:127], v39, s[24:27], s96 offen sc1
ds_read_b64_tr_b16 a[10:11], v134 offset:36864
v_mfma_f32_16x16x32_bf16 v[204:207], a[44:47], a[76:79], v[204:207]
s_add_u32 s95, s48, 3276800
ds_read_b64_tr_b16 a[12:13], v135 offset:32768
s_add_u32 m0, s82, 0
v_permlane32_swap_b32 v57, v61
v_mfma_f32_16x16x32_bf16 v[172:175], a[44:47], a[72:75], v[172:175]
s_waitcnt lgkmcnt(11)
ds_read_b64_tr_b16 a[14:15], v135 offset:36864
v_permlane32_swap_b32 v58, v62
v_permlane32_swap_b32 v59, v63
v_mfma_f32_16x16x32_bf16 v[176:179], a[48:51], a[72:75], v[176:179]
ds_read_b64_tr_b16 a[16:17], v140 offset:32768
v_add_f32 v48, v48, v52
v_add_f32 v49, v49, v53
v_mfma_f32_16x16x32_bf16 v[208:211], a[48:51], a[76:79], v[208:211]
buffer_load_dwordx4 v34, s[16:19], s95 offen lds
ds_read_b64_tr_b16 a[18:19], v140 offset:36864
v_mfma_f32_16x16x32_bf16 v[212:215], a[52:55], a[76:79], v[212:215]
s_add_u32 m0, s82, 2048
ds_read_b64_tr_b16 a[20:21], v141 offset:32768
v_add_f32 v50, v50, v54
v_add_f32 v51, v51, v55
v_mfma_f32_16x16x32_bf16 v[180:183], a[52:55], a[72:75], v[180:183]
s_waitcnt lgkmcnt(11)
ds_read_b64_tr_b16 a[22:23], v141 offset:36864
v_add_f32 v56, v56, v60
v_add_f32 v57, v57, v61
v_mfma_f32_16x16x32_bf16 v[184:187], a[56:59], a[72:75], v[184:187]
buffer_load_dwordx4 v35, s[16:19], s95 offen lds
ds_read_b64_tr_b16 a[24:25], v142 offset:32768
v_mfma_f32_16x16x32_bf16 v[216:219], a[56:59], a[76:79], v[216:219]
ds_read_b64_tr_b16 a[26:27], v142 offset:36864
v_add_f32 v58, v58, v62
v_add_f32 v59, v59, v63
v_mfma_f32_16x16x32_bf16 v[220:223], a[60:63], a[76:79], v[220:223]
s_waitcnt lgkmcnt(10)
buffer_store_dwordx4 v[48:51], v146, s[24:27], s56 offen sc1
v_mfma_f32_16x16x32_bf16 v[188:191], a[60:63], a[72:75], v[188:191]
s_barrier
ds_read_b64_tr_b16 a[28:29], v143 offset:32768
ds_read_b64_tr_b16 a[30:31], v143 offset:36864
s_add_u32 s3, s57, s55
v_mfma_f32_16x16x32_bf16 v[160:163], a[0:3], a[80:83], v[160:163]
buffer_store_dwordx4 v[56:59], v146, s[24:27], s3 offen sc1
ds_read_b64_tr_b16 a[32:33], v132 offset:40960
v_mfma_f32_16x16x32_bf16 v[192:195], a[0:3], a[84:87], v[192:195]
s_add_u32 s93, s49, 29696
ds_read_b64_tr_b16 a[34:35], v132 offset:45056
v_mfma_f32_16x16x32_bf16 v[196:199], a[4:7], a[84:87], v[196:199]
buffer_load_dwordx4 a[128:131], v38, s[24:27], s93 offen sc1
ds_read_b64_tr_b16 a[36:37], v133 offset:40960
Lpad11:
s_cbranch_execz Lpad15
s_nop 0
v_mfma_f32_16x16x32_bf16 v[164:167], a[4:7], a[80:83], v[164:167]
s_waitcnt lgkmcnt(11)
ds_read_b64_tr_b16 a[38:39], v133 offset:45056
v_mfma_f32_16x16x32_bf16 v[168:171], a[8:11], a[80:83], v[168:171]
ds_read_b64_tr_b16 a[40:41], v134 offset:40960
v_mfma_f32_16x16x32_bf16 v[200:203], a[8:11], a[84:87], v[200:203]
buffer_load_dwordx4 a[132:135], v39, s[24:27], s93 offen sc1
ds_read_b64_tr_b16 a[42:43], v134 offset:45056
v_mfma_f32_16x16x32_bf16 v[204:207], a[12:15], a[84:87], v[204:207]
s_add_u32 s97, s48, 3538944
ds_read_b64_tr_b16 a[44:45], v135 offset:40960
s_add_u32 m0, s82, 8192
v_mfma_f32_16x16x32_bf16 v[172:175], a[12:15], a[80:83], v[172:175]
s_waitcnt lgkmcnt(11)
ds_read_b64_tr_b16 a[46:47], v135 offset:45056
v_mfma_f32_16x16x32_bf16 v[176:179], a[16:19], a[80:83], v[176:179]
ds_read_b64_tr_b16 a[48:49], v140 offset:40960
v_mfma_f32_16x16x32_bf16 v[208:211], a[16:19], a[84:87], v[208:211]
buffer_load_dwordx4 v34, s[16:19], s97 offen lds
ds_read_b64_tr_b16 a[50:51], v140 offset:45056
v_mfma_f32_16x16x32_bf16 v[212:215], a[20:23], a[84:87], v[212:215]
s_add_u32 m0, s82, 10240
ds_read_b64_tr_b16 a[52:53], v141 offset:40960
v_mfma_f32_16x16x32_bf16 v[180:183], a[20:23], a[80:83], v[180:183]
s_waitcnt lgkmcnt(11)
ds_read_b64_tr_b16 a[54:55], v141 offset:45056
v_mfma_f32_16x16x32_bf16 v[184:187], a[24:27], a[80:83], v[184:187]
buffer_load_dwordx4 v35, s[16:19], s97 offen lds
ds_read_b64_tr_b16 a[56:57], v142 offset:40960
v_mfma_f32_16x16x32_bf16 v[216:219], a[24:27], a[84:87], v[216:219]
ds_read_b64_tr_b16 a[58:59], v142 offset:45056
v_mfma_f32_16x16x32_bf16 v[220:223], a[28:31], a[84:87], v[220:223]
s_waitcnt vmcnt(24) lgkmcnt(10)
ds_read_b64_tr_b16 a[60:61], v143 offset:40960
v_mfma_f32_16x16x32_bf16 v[188:191], a[28:31], a[80:83], v[188:191]
s_barrier
ds_read_b64_tr_b16 a[62:63], v143 offset:45056
v_mfma_f32_16x16x32_bf16 v[160:163], a[32:35], a[88:91], v[160:163]
s_add_u32 s95, s49, 33792
ds_read_b64_tr_b16 a[0:1], v132 offset:49152
v_mfma_f32_16x16x32_bf16 v[192:195], a[32:35], a[92:95], v[192:195]
buffer_load_dwordx4 a[136:139], v38, s[24:27], s95 offen sc1
v_mfma_f32_16x16x32_bf16 v[196:199], a[36:39], a[92:95], v[196:199]
s_nop 0
ds_read_b64_tr_b16 a[2:3], v132 offset:53248
ds_read_b64_tr_b16 a[4:5], v133 offset:49152
v_mfma_f32_16x16x32_bf16 v[164:167], a[36:39], a[88:91], v[164:167]
s_waitcnt lgkmcnt(11)
ds_read_b64_tr_b16 a[6:7], v133 offset:53248
v_mfma_f32_16x16x32_bf16 v[168:171], a[40:43], a[88:91], v[168:171]
ds_read_b64_tr_b16 a[8:9], v134 offset:49152
v_mfma_f32_16x16x32_bf16 v[200:203], a[40:43], a[92:95], v[200:203]
buffer_load_dwordx4 a[140:143], v39, s[24:27], s95 offen sc1
v_mfma_f32_16x16x32_bf16 v[204:207], a[44:47], a[92:95], v[204:207]
s_add_u32 s94, s48, 131072
ds_read_b64_tr_b16 a[10:11], v134 offset:53248
ds_read_b64_tr_b16 a[12:13], v135 offset:49152
v_mfma_f32_16x16x32_bf16 v[172:175], a[44:47], a[88:91], v[172:175]
s_waitcnt lgkmcnt(11)
ds_read_b64_tr_b16 a[14:15], v135 offset:53248
s_add_u32 m0, s82, 16384
v_mfma_f32_16x16x32_bf16 v[176:179], a[48:51], a[88:91], v[176:179]
s_nop 0
ds_read_b64_tr_b16 a[16:17], v140 offset:49152
v_mfma_f32_16x16x32_bf16 v[208:211], a[48:51], a[92:95], v[208:211]
buffer_load_dwordx4 v34, s[16:19], s94 offen lds
v_mfma_f32_16x16x32_bf16 v[212:215], a[52:55], a[92:95], v[212:215]
s_add_u32 m0, s82, 18432
ds_read_b64_tr_b16 a[18:19], v140 offset:53248
ds_read_b64_tr_b16 a[20:21], v141 offset:49152
v_mfma_f32_16x16x32_bf16 v[180:183], a[52:55], a[88:91], v[180:183]
s_waitcnt lgkmcnt(11)
ds_read_b64_tr_b16 a[22:23], v141 offset:53248
v_mfma_f32_16x16x32_bf16 v[184:187], a[56:59], a[88:91], v[184:187]
buffer_load_dwordx4 v35, s[16:19], s94 offen lds
v_mfma_f32_16x16x32_bf16 v[216:219], a[56:59], a[92:95], v[216:219]
s_nop 0
ds_read_b64_tr_b16 a[24:25], v142 offset:49152
ds_read_b64_tr_b16 a[26:27], v142 offset:53248
v_mfma_f32_16x16x32_bf16 v[220:223], a[60:63], a[92:95], v[220:223]
s_waitcnt vmcnt(24) lgkmcnt(10)
ds_read_b64_tr_b16 a[28:29], v143 offset:49152
v_mfma_f32_16x16x32_bf16 v[188:191], a[60:63], a[88:91], v[188:191]
s_barrier
ds_read_b64_tr_b16 a[30:31], v143 offset:53248
v_mfma_f32_16x16x32_bf16 v[160:163], a[0:3], a[96:99], v[160:163]
s_add_u32 s97, s49, 36864
ds_read_b64_tr_b16 a[32:33], v132 offset:57344
v_mfma_f32_16x16x32_bf16 v[192:195], a[0:3], a[100:103], v[192:195]
buffer_load_dwordx4 a[144:147], v38, s[24:27], s97 offen sc1
v_mfma_f32_16x16x32_bf16 v[196:199], a[4:7], a[100:103], v[196:199]
s_nop 0
ds_read_b64_tr_b16 a[34:35], v132 offset:61440
ds_read_b64_tr_b16 a[36:37], v133 offset:57344
v_mfma_f32_16x16x32_bf16 v[164:167], a[4:7], a[96:99], v[164:167]
s_waitcnt lgkmcnt(11)
ds_read_b64_tr_b16 a[38:39], v133 offset:61440
v_mfma_f32_16x16x32_bf16 v[168:171], a[8:11], a[96:99], v[168:171]
ds_read_b64_tr_b16 a[40:41], v134 offset:57344
v_mfma_f32_16x16x32_bf16 v[200:203], a[8:11], a[100:103], v[200:203]
buffer_load_dwordx4 a[148:151], v39, s[24:27], s97 offen sc1
v_mfma_f32_16x16x32_bf16 v[204:207], a[12:15], a[100:103], v[204:207]
s_add_u32 s96, s48, 393216
ds_read_b64_tr_b16 a[42:43], v134 offset:61440
ds_read_b64_tr_b16 a[44:45], v135 offset:57344
v_mfma_f32_16x16x32_bf16 v[172:175], a[12:15], a[96:99], v[172:175]
s_waitcnt lgkmcnt(11)
ds_read_b64_tr_b16 a[46:47], v135 offset:61440
s_add_u32 m0, s82, 24576
v_mfma_f32_16x16x32_bf16 v[176:179], a[16:19], a[96:99], v[176:179]
s_nop 0
ds_read_b64_tr_b16 a[48:49], v140 offset:57344
v_mfma_f32_16x16x32_bf16 v[208:211], a[16:19], a[100:103], v[208:211]
buffer_load_dwordx4 v34, s[16:19], s96 offen lds
v_mfma_f32_16x16x32_bf16 v[212:215], a[20:23], a[100:103], v[212:215]
s_add_u32 m0, s82, 26624
ds_read_b64_tr_b16 a[50:51], v140 offset:61440
ds_read_b64_tr_b16 a[52:53], v141 offset:57344
v_mfma_f32_16x16x32_bf16 v[180:183], a[20:23], a[96:99], v[180:183]
s_waitcnt lgkmcnt(11)
ds_read_b64_tr_b16 a[54:55], v141 offset:61440
v_mfma_f32_16x16x32_bf16 v[184:187], a[24:27], a[96:99], v[184:187]
buffer_load_dwordx4 v35, s[16:19], s96 offen lds
v_mfma_f32_16x16x32_bf16 v[216:219], a[24:27], a[100:103], v[216:219]
s_nop 0
ds_read_b64_tr_b16 a[56:57], v142 offset:57344
ds_read_b64_tr_b16 a[58:59], v142 offset:61440
v_mfma_f32_16x16x32_bf16 v[220:223], a[28:31], a[100:103], v[220:223]
s_waitcnt vmcnt(24) lgkmcnt(10)
ds_read_b64_tr_b16 a[60:61], v143 offset:57344
v_mfma_f32_16x16x32_bf16 v[188:191], a[28:31], a[96:99], v[188:191]
s_barrier
ds_read_b64_tr_b16 a[62:63], v143 offset:61440
v_mfma_f32_16x16x32_bf16 v[160:163], a[32:35], a[104:107], v[160:163]
s_add_u32 s94, s49, 40960
ds_read_b64_tr_b16 a[0:1], v148 offset:0
s_waitcnt vmcnt(12)
v_mfma_f32_16x16x32_bf16 v[192:195], a[32:35], a[108:111], v[192:195]
buffer_load_dwordx4 a[152:155], v38, s[24:27], s94 offen sc1
ds_read_b64_tr_b16 a[2:3], v148 offset:4096
v_mfma_f32_16x16x32_bf16 v[196:199], a[36:39], a[108:111], v[196:199]
buffer_store_dword v29, v27, s[24:27], s87 offen sc1
ds_read_b64_tr_b16 a[4:5], v149 offset:0
v_mfma_f32_16x16x32_bf16 v[164:167], a[36:39], a[104:107], v[164:167]
s_waitcnt lgkmcnt(11)
ds_read_b64_tr_b16 a[6:7], v149 offset:4096
v_mfma_f32_16x16x32_bf16 v[168:171], a[40:43], a[104:107], v[168:171]
ds_read_b64_tr_b16 a[8:9], v150 offset:0
v_mfma_f32_16x16x32_bf16 v[200:203], a[40:43], a[108:111], v[200:203]
buffer_load_dwordx4 a[156:159], v39, s[24:27], s94 offen sc1
ds_read_b64_tr_b16 a[10:11], v150 offset:4096
v_mfma_f32_16x16x32_bf16 v[204:207], a[44:47], a[108:111], v[204:207]
s_add_u32 s93, s48, 589824
ds_read_b64_tr_b16 a[12:13], v151 offset:0
s_add_u32 m0, s82, 32768
v_mfma_f32_16x16x32_bf16 v[172:175], a[44:47], a[104:107], v[172:175]
s_waitcnt lgkmcnt(11)
ds_read_b64_tr_b16 a[14:15], v151 offset:4096
v_mfma_f32_16x16x32_bf16 v[176:179], a[48:51], a[104:107], v[176:179]
ds_read_b64_tr_b16 a[16:17], v154 offset:0
v_mfma_f32_16x16x32_bf16 v[208:211], a[48:51], a[108:111], v[208:211]
buffer_load_dwordx4 v34, s[16:19], s93 offen lds
ds_read_b64_tr_b16 a[18:19], v154 offset:4096
v_mfma_f32_16x16x32_bf16 v[212:215], a[52:55], a[108:111], v[212:215]
s_add_u32 m0, s82, 34816
ds_read_b64_tr_b16 a[20:21], v155 offset:0
v_mfma_f32_16x16x32_bf16 v[180:183], a[52:55], a[104:107], v[180:183]
s_waitcnt lgkmcnt(11)
ds_read_b64_tr_b16 a[22:23], v155 offset:4096
v_mfma_f32_16x16x32_bf16 v[184:187], a[56:59], a[104:107], v[184:187]
buffer_load_dwordx4 v35, s[16:19], s93 offen lds
ds_read_b64_tr_b16 a[24:25], v156 offset:0
v_mfma_f32_16x16x32_bf16 v[216:219], a[56:59], a[108:111], v[216:219]
ds_read_b64_tr_b16 a[26:27], v156 offset:4096
v_mfma_f32_16x16x32_bf16 v[220:223], a[60:63], a[108:111], v[220:223]
s_waitcnt lgkmcnt(10)
ds_read_b64_tr_b16 a[28:29], v157 offset:0
v_mfma_f32_16x16x32_bf16 v[188:191], a[60:63], a[104:107], v[188:191]
s_barrier
ds_read_b64_tr_b16 a[30:31], v157 offset:4096
v_mfma_f32_16x16x32_bf16 v[160:163], a[0:3], a[112:115], v[160:163]
s_add_u32 s96, s49, 44032
ds_read_b64_tr_b16 a[32:33], v148 offset:8192
v_mfma_f32_16x16x32_bf16 v[192:195], a[0:3], a[116:119], v[192:195]
buffer_load_dwordx4 a[160:163], v38, s[24:27], s96 offen sc1
v_mfma_f32_16x16x32_bf16 v[196:199], a[4:7], a[116:119], v[196:199]
s_nop 0
ds_read_b64_tr_b16 a[34:35], v148 offset:12288
ds_read_b64_tr_b16 a[36:37], v149 offset:8192
v_mfma_f32_16x16x32_bf16 v[164:167], a[4:7], a[112:115], v[164:167]
s_waitcnt lgkmcnt(11)
ds_read_b64_tr_b16 a[38:39], v149 offset:12288
v_mfma_f32_16x16x32_bf16 v[168:171], a[8:11], a[112:115], v[168:171]
ds_read_b64_tr_b16 a[40:41], v150 offset:8192
v_mfma_f32_16x16x32_bf16 v[200:203], a[8:11], a[116:119], v[200:203]
buffer_load_dwordx4 a[164:167], v39, s[24:27], s96 offen sc1
v_mfma_f32_16x16x32_bf16 v[204:207], a[12:15], a[116:119], v[204:207]
s_add_u32 s95, s48, 851968
ds_read_b64_tr_b16 a[42:43], v150 offset:12288
ds_read_b64_tr_b16 a[44:45], v151 offset:8192
v_mfma_f32_16x16x32_bf16 v[172:175], a[12:15], a[112:115], v[172:175]
s_waitcnt lgkmcnt(11)
ds_read_b64_tr_b16 a[46:47], v151 offset:12288
s_add_u32 m0, s82, 40960
v_mfma_f32_16x16x32_bf16 v[176:179], a[16:19], a[112:115], v[176:179]
s_nop 0
ds_read_b64_tr_b16 a[48:49], v154 offset:8192
v_mfma_f32_16x16x32_bf16 v[208:211], a[16:19], a[116:119], v[208:211]
buffer_load_dwordx4 v34, s[16:19], s95 offen lds
v_mfma_f32_16x16x32_bf16 v[212:215], a[20:23], a[116:119], v[212:215]
s_add_u32 m0, s82, 43008
ds_read_b64_tr_b16 a[50:51], v154 offset:12288
ds_read_b64_tr_b16 a[52:53], v155 offset:8192
v_mfma_f32_16x16x32_bf16 v[180:183], a[20:23], a[112:115], v[180:183]
s_waitcnt lgkmcnt(11)
ds_read_b64_tr_b16 a[54:55], v155 offset:12288
v_mfma_f32_16x16x32_bf16 v[184:187], a[24:27], a[112:115], v[184:187]
buffer_load_dwordx4 v35, s[16:19], s95 offen lds
v_mfma_f32_16x16x32_bf16 v[216:219], a[24:27], a[116:119], v[216:219]
s_nop 0
ds_read_b64_tr_b16 a[56:57], v156 offset:8192
ds_read_b64_tr_b16 a[58:59], v156 offset:12288
v_mfma_f32_16x16x32_bf16 v[220:223], a[28:31], a[116:119], v[220:223]
s_waitcnt lgkmcnt(10)
ds_read_b64_tr_b16 a[60:61], v157 offset:8192
v_mfma_f32_16x16x32_bf16 v[188:191], a[28:31], a[112:115], v[188:191]
s_barrier
ds_read_b64_tr_b16 a[62:63], v157 offset:12288
v_mfma_f32_16x16x32_bf16 v[160:163], a[32:35], a[120:123], v[160:163]
s_add_u32 s93, s49, 48128
ds_read_b64_tr_b16 a[0:1], v148 offset:16384
v_mfma_f32_16x16x32_bf16 v[192:195], a[32:35], a[124:127], v[192:195]
buffer_load_dwordx4 a[168:171], v38, s[24:27], s93 offen sc1
v_mfma_f32_16x16x32_bf16 v[196:199], a[36:39], a[124:127], v[196:199]
s_nop 0
ds_read_b64_tr_b16 a[2:3], v148 offset:20480
ds_read_b64_tr_b16 a[4:5], v149 offset:16384
v_mfma_f32_16x16x32_bf16 v[164:167], a[36:39], a[120:123], v[164:167]
s_waitcnt lgkmcnt(11)
ds_read_b64_tr_b16 a[6:7], v149 offset:20480
v_mfma_f32_16x16x32_bf16 v[168:171], a[40:43], a[120:123], v[168:171]
ds_read_b64_tr_b16 a[8:9], v150 offset:16384
v_mfma_f32_16x16x32_bf16 v[200:203], a[40:43], a[124:127], v[200:203]
buffer_load_dwordx4 a[172:175], v39, s[24:27], s93 offen sc1
v_mfma_f32_16x16x32_bf16 v[204:207], a[44:47], a[124:127], v[204:207]
s_add_u32 s97, s48, 1048576
ds_read_b64_tr_b16 a[10:11], v150 offset:20480
ds_read_b64_tr_b16 a[12:13], v151 offset:16384
v_mfma_f32_16x16x32_bf16 v[172:175], a[44:47], a[120:123], v[172:175]
s_waitcnt lgkmcnt(11)
ds_read_b64_tr_b16 a[14:15], v151 offset:20480
s_add_u32 m0, s82, 49152
v_mfma_f32_16x16x32_bf16 v[176:179], a[48:51], a[120:123], v[176:179]
s_nop 0
ds_read_b64_tr_b16 a[16:17], v154 offset:16384
v_mfma_f32_16x16x32_bf16 v[208:211], a[48:51], a[124:127], v[208:211]
buffer_load_dwordx4 v34, s[16:19], s97 offen lds
v_mfma_f32_16x16x32_bf16 v[212:215], a[52:55], a[124:127], v[212:215]
s_add_u32 m0, s82, 51200
ds_read_b64_tr_b16 a[18:19], v154 offset:20480
ds_read_b64_tr_b16 a[20:21], v155 offset:16384
v_mfma_f32_16x16x32_bf16 v[180:183], a[52:55], a[120:123], v[180:183]
s_waitcnt lgkmcnt(11)
ds_read_b64_tr_b16 a[22:23], v155 offset:20480
v_mfma_f32_16x16x32_bf16 v[184:187], a[56:59], a[120:123], v[184:187]
buffer_load_dwordx4 v35, s[16:19], s97 offen lds
v_mfma_f32_16x16x32_bf16 v[216:219], a[56:59], a[124:127], v[216:219]
s_nop 0
ds_read_b64_tr_b16 a[24:25], v156 offset:16384
ds_read_b64_tr_b16 a[26:27], v156 offset:20480
v_mfma_f32_16x16x32_bf16 v[220:223], a[60:63], a[124:127], v[220:223]
s_waitcnt vmcnt(23) lgkmcnt(10)
ds_read_b64_tr_b16 a[28:29], v157 offset:16384
v_mfma_f32_16x16x32_bf16 v[188:191], a[60:63], a[120:123], v[188:191]
s_barrier
ds_read_b64_tr_b16 a[30:31], v157 offset:20480
Lv24:
v_mfma_f32_16x16x32_bf16 v[160:163], a[0:3], a[128:131], v[160:163]
s_add_u32 s95, s49, 51200
ds_read_b64_tr_b16 a[32:33], v148 offset:24576
v_mfma_f32_16x16x32_bf16 v[192:195], a[0:3], a[132:135], v[192:195]
buffer_load_dwordx4 a[176:179], v38, s[24:27], s95 offen sc1
v_mfma_f32_16x16x32_bf16 v[196:199], a[4:7], a[132:135], v[196:199]
s_nop 0
ds_read_b64_tr_b16 a[34:35], v148 offset:28672
ds_read_b64_tr_b16 a[36:37], v149 offset:24576
v_mfma_f32_16x16x32_bf16 v[164:167], a[4:7], a[128:131], v[164:167]
s_waitcnt lgkmcnt(11)
ds_read_b64_tr_b16 a[38:39], v149 offset:28672
v_mfma_f32_16x16x32_bf16 v[168:171], a[8:11], a[128:131], v[168:171]
ds_read_b64_tr_b16 a[40:41], v150 offset:24576
v_mfma_f32_16x16x32_bf16 v[200:203], a[8:11], a[132:135], v[200:203]
buffer_load_dwordx4 a[180:183], v39, s[24:27], s95 offen sc1
v_mfma_f32_16x16x32_bf16 v[204:207], a[12:15], a[132:135], v[204:207]
s_add_u32 s94, s48, 1310720
ds_read_b64_tr_b16 a[42:43], v150 offset:28672
ds_read_b64_tr_b16 a[44:45], v151 offset:24576
v_mfma_f32_16x16x32_bf16 v[172:175], a[12:15], a[128:131], v[172:175]
s_waitcnt lgkmcnt(11)
ds_read_b64_tr_b16 a[46:47], v151 offset:28672
s_add_u32 m0, s82, 57344
v_mfma_f32_16x16x32_bf16 v[176:179], a[16:19], a[128:131], v[176:179]
s_nop 0
ds_read_b64_tr_b16 a[48:49], v154 offset:24576
v_mfma_f32_16x16x32_bf16 v[208:211], a[16:19], a[132:135], v[208:211]
buffer_load_dwordx4 v34, s[16:19], s94 offen lds
v_mfma_f32_16x16x32_bf16 v[212:215], a[20:23], a[132:135], v[212:215]
s_add_u32 m0, s82, 59392
ds_read_b64_tr_b16 a[50:51], v154 offset:28672
ds_read_b64_tr_b16 a[52:53], v155 offset:24576
v_mfma_f32_16x16x32_bf16 v[180:183], a[20:23], a[128:131], v[180:183]
s_waitcnt lgkmcnt(11)
ds_read_b64_tr_b16 a[54:55], v155 offset:28672
v_mfma_f32_16x16x32_bf16 v[184:187], a[24:27], a[128:131], v[184:187]
buffer_load_dwordx4 v35, s[16:19], s94 offen lds
v_mfma_f32_16x16x32_bf16 v[216:219], a[24:27], a[132:135], v[216:219]
s_nop 0
ds_read_b64_tr_b16 a[56:57], v156 offset:24576
ds_read_b64_tr_b16 a[58:59], v156 offset:28672
v_mfma_f32_16x16x32_bf16 v[220:223], a[28:31], a[132:135], v[220:223]
s_waitcnt vmcnt(23) lgkmcnt(10)
ds_read_b64_tr_b16 a[60:61], v157 offset:24576
v_mfma_f32_16x16x32_bf16 v[188:191], a[28:31], a[128:131], v[188:191]
s_barrier
ds_read_b64_tr_b16 a[62:63], v157 offset:28672
v_mfma_f32_16x16x32_bf16 v[160:163], a[32:35], a[136:139], v[160:163]
s_add_u32 s97, s49, 55296
ds_read_b64_tr_b16 a[0:1], v148 offset:32768
s_mov_b32 s51, 32768000
v_mfma_f32_16x16x32_bf16 v[192:195], a[32:35], a[140:143], v[192:195]
buffer_load_dwordx4 a[184:187], v38, s[24:27], s97 offen sc1
ds_read_b64_tr_b16 a[2:3], v148 offset:36864
v_mfma_f32_16x16x32_bf16 v[196:199], a[36:39], a[140:143], v[196:199]
buffer_load_dword v46, v147, s[24:27], s51 offen sc1
ds_read_b64_tr_b16 a[4:5], v149 offset:32768
v_mfma_f32_16x16x32_bf16 v[164:167], a[36:39], a[136:139], v[164:167]
s_waitcnt lgkmcnt(11)
ds_read_b64_tr_b16 a[6:7], v149 offset:36864
v_mfma_f32_16x16x32_bf16 v[168:171], a[40:43], a[136:139], v[168:171]
s_nop 0
ds_read_b64_tr_b16 a[8:9], v150 offset:32768
v_mfma_f32_16x16x32_bf16 v[200:203], a[40:43], a[140:143], v[200:203]
buffer_load_dwordx4 a[188:191], v39, s[24:27], s97 offen sc1
ds_read_b64_tr_b16 a[10:11], v150 offset:36864
v_mfma_f32_16x16x32_bf16 v[204:207], a[44:47], a[140:143], v[204:207]
s_add_u32 s96, s48, 1507328
ds_read_b64_tr_b16 a[12:13], v151 offset:32768
s_add_u32 m0, s82, 65536
v_mfma_f32_16x16x32_bf16 v[172:175], a[44:47], a[136:139], v[172:175]
s_waitcnt lgkmcnt(11)
ds_read_b64_tr_b16 a[14:15], v151 offset:36864
v_mfma_f32_16x16x32_bf16 v[176:179], a[48:51], a[136:139], v[176:179]
ds_read_b64_tr_b16 a[16:17], v154 offset:32768
v_mfma_f32_16x16x32_bf16 v[208:211], a[48:51], a[140:143], v[208:211]
buffer_load_dwordx4 v34, s[16:19], s96 offen lds
ds_read_b64_tr_b16 a[18:19], v154 offset:36864
v_mfma_f32_16x16x32_bf16 v[212:215], a[52:55], a[140:143], v[212:215]
s_add_u32 m0, s82, 67584
ds_read_b64_tr_b16 a[20:21], v155 offset:32768
v_mfma_f32_16x16x32_bf16 v[180:183], a[52:55], a[136:139], v[180:183]
s_waitcnt lgkmcnt(11)
ds_read_b64_tr_b16 a[22:23], v155 offset:36864
v_mfma_f32_16x16x32_bf16 v[184:187], a[56:59], a[136:139], v[184:187]
buffer_load_dwordx4 v35, s[16:19], s96 offen lds
ds_read_b64_tr_b16 a[24:25], v156 offset:32768
v_mfma_f32_16x16x32_bf16 v[216:219], a[56:59], a[140:143], v[216:219]
ds_read_b64_tr_b16 a[26:27], v156 offset:36864
v_mfma_f32_16x16x32_bf16 v[220:223], a[60:63], a[140:143], v[220:223]
s_waitcnt vmcnt(24) lgkmcnt(10)
ds_read_b64_tr_b16 a[28:29], v157 offset:32768
v_mfma_f32_16x16x32_bf16 v[188:191], a[60:63], a[136:139], v[188:191]
s_barrier
ds_read_b64_tr_b16 a[30:31], v157 offset:36864
v_mfma_f32_16x16x32_bf16 v[160:163], a[0:3], a[144:147], v[160:163]
s_add_u32 s94, s49, 2048
ds_read_b64_tr_b16 a[32:33], v148 offset:40960
v_mfma_f32_16x16x32_bf16 v[192:195], a[0:3], a[148:151], v[192:195]
buffer_load_dwordx4 a[64:67], v38, s[24:27], s94 offen sc1
v_mfma_f32_16x16x32_bf16 v[196:199], a[4:7], a[148:151], v[196:199]
s_nop 0
ds_read_b64_tr_b16 a[34:35], v148 offset:45056
ds_read_b64_tr_b16 a[36:37], v149 offset:40960
v_mfma_f32_16x16x32_bf16 v[164:167], a[4:7], a[144:147], v[164:167]
s_waitcnt lgkmcnt(11)
ds_read_b64_tr_b16 a[38:39], v149 offset:45056
v_mfma_f32_16x16x32_bf16 v[168:171], a[8:11], a[144:147], v[168:171]
ds_read_b64_tr_b16 a[40:41], v150 offset:40960
v_mfma_f32_16x16x32_bf16 v[200:203], a[8:11], a[148:151], v[200:203]
buffer_load_dwordx4 a[68:71], v39, s[24:27], s94 offen sc1
v_mfma_f32_16x16x32_bf16 v[204:207], a[12:15], a[148:151], v[204:207]
s_add_u32 s93, s48, 1769472
ds_read_b64_tr_b16 a[42:43], v150 offset:45056
ds_read_b64_tr_b16 a[44:45], v151 offset:40960
v_mfma_f32_16x16x32_bf16 v[172:175], a[12:15], a[144:147], v[172:175]
s_waitcnt lgkmcnt(11)
ds_read_b64_tr_b16 a[46:47], v151 offset:45056
s_add_u32 m0, s82, 73728
v_mfma_f32_16x16x32_bf16 v[176:179], a[16:19], a[144:147], v[176:179]
s_nop 0
ds_read_b64_tr_b16 a[48:49], v154 offset:40960
v_mfma_f32_16x16x32_bf16 v[208:211], a[16:19], a[148:151], v[208:211]
buffer_load_dwordx4 v34, s[16:19], s93 offen lds
v_mfma_f32_16x16x32_bf16 v[212:215], a[20:23], a[148:151], v[212:215]
s_add_u32 m0, s82, 75776
ds_read_b64_tr_b16 a[50:51], v154 offset:45056
ds_read_b64_tr_b16 a[52:53], v155 offset:40960
v_mfma_f32_16x16x32_bf16 v[180:183], a[20:23], a[144:147], v[180:183]
s_waitcnt lgkmcnt(11)
ds_read_b64_tr_b16 a[54:55], v155 offset:45056
v_mfma_f32_16x16x32_bf16 v[184:187], a[24:27], a[144:147], v[184:187]
buffer_load_dwordx4 v35, s[16:19], s93 offen lds
v_mfma_f32_16x16x32_bf16 v[216:219], a[24:27], a[148:151], v[216:219]
s_nop 0
ds_read_b64_tr_b16 a[56:57], v156 offset:40960
ds_read_b64_tr_b16 a[58:59], v156 offset:45056
v_mfma_f32_16x16x32_bf16 v[220:223], a[28:31], a[148:151], v[220:223]
s_waitcnt vmcnt(23) lgkmcnt(10)
ds_read_b64_tr_b16 a[60:61], v157 offset:40960
v_mfma_f32_16x16x32_bf16 v[188:191], a[28:31], a[144:147], v[188:191]
s_barrier
ds_read_b64_tr_b16 a[62:63], v157 offset:45056
v_mfma_f32_16x16x32_bf16 v[160:163], a[32:35], a[152:155], v[160:163]
s_add_u32 s96, s49, 6144
ds_read_b64_tr_b16 a[0:1], v148 offset:49152
v_mfma_f32_16x16x32_bf16 v[192:195], a[32:35], a[156:159], v[192:195]
buffer_load_dwordx4 a[72:75], v38, s[24:27], s96 offen sc1
v_mfma_f32_16x16x32_bf16 v[196:199], a[36:39], a[156:159], v[196:199]
s_nop 0
ds_read_b64_tr_b16 a[2:3], v148 offset:53248
ds_read_b64_tr_b16 a[4:5], v149 offset:49152
v_mfma_f32_16x16x32_bf16 v[164:167], a[36:39], a[152:155], v[164:167]
s_waitcnt lgkmcnt(11)
ds_read_b64_tr_b16 a[6:7], v149 offset:53248
v_mfma_f32_16x16x32_bf16 v[168:171], a[40:43], a[152:155], v[168:171]
ds_read_b64_tr_b16 a[8:9], v150 offset:49152
v_mfma_f32_16x16x32_bf16 v[200:203], a[40:43], a[156:159], v[200:203]
buffer_load_dwordx4 a[76:79], v39, s[24:27], s96 offen sc1
v_mfma_f32_16x16x32_bf16 v[204:207], a[44:47], a[156:159], v[204:207]
s_add_u32 s95, s48, 1966080
ds_read_b64_tr_b16 a[10:11], v150 offset:53248
ds_read_b64_tr_b16 a[12:13], v151 offset:49152
v_mfma_f32_16x16x32_bf16 v[172:175], a[44:47], a[152:155], v[172:175]
s_waitcnt lgkmcnt(11)
ds_read_b64_tr_b16 a[14:15], v151 offset:53248
s_add_u32 m0, s82, 81920
v_mfma_f32_16x16x32_bf16 v[176:179], a[48:51], a[152:155], v[176:179]
s_nop 0
ds_read_b64_tr_b16 a[16:17], v154 offset:49152
v_mfma_f32_16x16x32_bf16 v[208:211], a[48:51], a[156:159], v[208:211]
buffer_load_dwordx4 v34, s[16:19], s95 offen lds
v_mfma_f32_16x16x32_bf16 v[212:215], a[52:55], a[156:159], v[212:215]
s_add_u32 m0, s82, 83968
ds_read_b64_tr_b16 a[18:19], v154 offset:53248
ds_read_b64_tr_b16 a[20:21], v155 offset:49152
v_mfma_f32_16x16x32_bf16 v[180:183], a[52:55], a[152:155], v[180:183]
s_waitcnt lgkmcnt(11)
ds_read_b64_tr_b16 a[22:23], v155 offset:53248
v_mfma_f32_16x16x32_bf16 v[184:187], a[56:59], a[152:155], v[184:187]
buffer_load_dwordx4 v35, s[16:19], s95 offen lds
v_mfma_f32_16x16x32_bf16 v[216:219], a[56:59], a[156:159], v[216:219]
s_nop 0
ds_read_b64_tr_b16 a[24:25], v156 offset:49152
ds_read_b64_tr_b16 a[26:27], v156 offset:53248
v_mfma_f32_16x16x32_bf16 v[220:223], a[60:63], a[156:159], v[220:223]
s_waitcnt vmcnt(23) lgkmcnt(10)
ds_read_b64_tr_b16 a[28:29], v157 offset:49152
v_mfma_f32_16x16x32_bf16 v[188:191], a[60:63], a[152:155], v[188:191]
s_barrier
ds_read_b64_tr_b16 a[30:31], v157 offset:53248
v_mfma_f32_16x16x32_bf16 v[160:163], a[0:3], a[160:163], v[160:163]
s_add_u32 s97, s49, 9216
ds_read_b64_tr_b16 a[32:33], v148 offset:57344
s_waitcnt vmcnt(11)
v_cmp_gt_u32 vcc, s64, v46
s_nop 3
s_cbranch_vccz Lret5
s_mov_b32 s47, 0
Lslow5_l:
s_sleep 8
buffer_load_dword v46, v147, s[24:27], s51 offen sc1
s_add_u32 s47, s47, 1
s_waitcnt vmcnt(0)
v_cmp_gt_u32 vcc, s64, v46
s_cmp_gt_u32 s47, 0x40000
s_cbranch_scc1 Lret5
s_nop 3
s_cbranch_vccnz Lslow5_l
Lret5:
v_mfma_f32_16x16x32_bf16 v[192:195], a[0:3], a[164:167], v[192:195]
buffer_load_dwordx4 a[80:83], v38, s[24:27], s97 offen sc1
ds_read_b64_tr_b16 a[34:35], v148 offset:61440
v_mfma_f32_16x16x32_bf16 v[196:199], a[4:7], a[164:167], v[196:199]
s_nop 0
ds_read_b64_tr_b16 a[36:37], v149 offset:57344
v_mfma_f32_16x16x32_bf16 v[164:167], a[4:7], a[160:163], v[164:167]
s_waitcnt lgkmcnt(11)
ds_read_b64_tr_b16 a[38:39], v149 offset:61440
v_mfma_f32_16x16x32_bf16 v[168:171], a[8:11], a[160:163], v[168:171]
ds_read_b64_tr_b16 a[40:41], v150 offset:57344
v_mfma_f32_16x16x32_bf16 v[200:203], a[8:11], a[164:167], v[200:203]
buffer_load_dwordx4 a[84:87], v39, s[24:27], s97 offen sc1
ds_read_b64_tr_b16 a[42:43], v150 offset:61440
v_mfma_f32_16x16x32_bf16 v[204:207], a[12:15], a[164:167], v[204:207]
ds_read_b64_tr_b16 a[44:45], v151 offset:57344
v_mfma_f32_16x16x32_bf16 v[172:175], a[12:15], a[160:163], v[172:175]
s_waitcnt lgkmcnt(11)
ds_read_b64_tr_b16 a[46:47], v151 offset:61440
v_mfma_f32_16x16x32_bf16 v[176:179], a[16:19], a[160:163], v[176:179]
ds_read_b64_tr_b16 a[48:49], v154 offset:57344
v_mfma_f32_16x16x32_bf16 v[208:211], a[16:19], a[164:167], v[208:211]
ds_read_b64_tr_b16 a[50:51], v154 offset:61440
v_mfma_f32_16x16x32_bf16 v[212:215], a[20:23], a[164:167], v[212:215]
ds_read_b64_tr_b16 a[52:53], v155 offset:57344
v_mfma_f32_16x16x32_bf16 v[180:183], a[20:23], a[160:163], v[180:183]
s_waitcnt lgkmcnt(11)
ds_read_b64_tr_b16 a[54:55], v155 offset:61440
v_mfma_f32_16x16x32_bf16 v[184:187], a[24:27], a[160:163], v[184:187]
ds_read_b64_tr_b16 a[56:57], v156 offset:57344
v_mfma_f32_16x16x32_bf16 v[216:219], a[24:27], a[164:167], v[216:219]
ds_read_b64_tr_b16 a[58:59], v156 offset:61440
v_mfma_f32_16x16x32_bf16 v[220:223], a[28:31], a[164:167], v[220:223]
s_waitcnt lgkmcnt(10)
ds_read_b64_tr_b16 a[60:61], v157 offset:57344
v_mfma_f32_16x16x32_bf16 v[188:191], a[28:31], a[160:163], v[188:191]
s_barrier
ds_read_b64_tr_b16 a[62:63], v157 offset:61440
v_mfma_f32_16x16x32_bf16 v[160:163], a[32:35], a[168:171], v[160:163]
buffer_load_dwordx4 v[76:79], v1, s[24:27], s54 offen offset:0 sc1
ds_read_b64_tr_b16 a[0:1], v132 offset:0
v_mfma_f32_16x16x32_bf16 v[192:195], a[32:35], a[172:175], v[192:195]
buffer_load_dwordx4 v[80:83], v1, s[24:27], s54 offen offset:1024 sc1
ds_read_b64_tr_b16 a[2:3], v132 offset:4096
v_mfma_f32_16x16x32_bf16 v[196:199], a[36:39], a[172:175], v[196:199]
buffer_load_dwordx4 v[84:87], v1, s[24:27], s54 offen offset:2048 sc1
ds_read_b64_tr_b16 a[4:5], v133 offset:0
v_mfma_f32_16x16x32_bf16 v[164:167], a[36:39], a[168:171], v[164:167]
s_waitcnt lgkmcnt(11)
buffer_load_dwordx4 v[88:91], v1, s[24:27], s54 offen offset:3072 sc1
v_mfma_f32_16x16x32_bf16 v[168:171], a[40:43], a[168:171], v[168:171]
s_add_u32 s94, s49, 13312
ds_read_b64_tr_b16 a[6:7], v133 offset:4096
ds_read_b64_tr_b16 a[8:9], v134 offset:0
v_mfma_f32_16x16x32_bf16 v[200:203], a[40:43], a[172:175], v[200:203]
buffer_load_dwordx4 a[88:91], v38, s[24:27], s94 offen sc1
ds_read_b64_tr_b16 a[10:11], v134 offset:4096
v_mfma_f32_16x16x32_bf16 v[204:207], a[44:47], a[172:175], v[204:207]
buffer_load_dwordx4 a[92:95], v39, s[24:27], s94 offen sc1
ds_read_b64_tr_b16 a[12:13], v135 offset:0
v_mfma_f32_16x16x32_bf16 v[172:175], a[44:47], a[168:171], v[172:175]
s_waitcnt lgkmcnt(11)
buffer_load_dwordx4 v[92:95], v158, s[24:27], s55 offen offset:0 sc1
v_mfma_f32_16x16x32_bf16 v[176:179], a[48:51], a[168:171], v[176:179]
s_add_u32 s93, s48, 2228224
ds_read_b64_tr_b16 a[14:15], v135 offset:4096
ds_read_b64_tr_b16 a[16:17], v140 offset:0
s_add_u32 m0, s82, 90112
v_mfma_f32_16x16x32_bf16 v[208:211], a[48:51], a[172:175], v[208:211]
buffer_load_dwordx4 v34, s[16:19], s93 offen lds
ds_read_b64_tr_b16 a[18:19], v140 offset:4096
v_mfma_f32_16x16x32_bf16 v[212:215], a[52:55], a[172:175], v[212:215]
Lpad12:
s_cbranch_execz Lpadback1
s_nop 0
s_add_u32 m0, s82, 92160
ds_read_b64_tr_b16 a[20:21], v141 offset:0
v_mfma_f32_16x16x32_bf16 v[180:183], a[52:55], a[168:171], v[180:183]
s_waitcnt lgkmcnt(11)
buffer_load_dwordx4 v[96:99], v158, s[24:27], s55 offen offset:64 sc1
v_mfma_f32_16x16x32_bf16 v[184:187], a[56:59], a[168:171], v[184:187]
buffer_load_dwordx4 v35, s[16:19], s93 offen lds
ds_read_b64_tr_b16 a[22:23], v141 offset:4096
v_mfma_f32_16x16x32_bf16 v[216:219], a[56:59], a[172:175], v[216:219]
s_nop 0
ds_read_b64_tr_b16 a[24:25], v142 offset:0
ds_read_b64_tr_b16 a[26:27], v142 offset:4096
v_mfma_f32_16x16x32_bf16 v[220:223], a[60:63], a[172:175], v[220:223]
s_waitcnt lgkmcnt(10)
ds_read_b64_tr_b16 a[28:29], v143 offset:0
v_mfma_f32_16x16x32_bf16 v[188:191], a[60:63], a[168:171], v[188:191]
s_barrier
ds_read_b64_tr_b16 a[30:31], v143 offset:4096
v_mfma_f32_16x16x32_bf16 v[160:163], a[0:3], a[176:179], v[160:163]
s_add_u32 s96, s49, 16384
ds_read_b64_tr_b16 a[32:33], v132 offset:8192
v_mfma_f32_16x16x32_bf16 v[192:195], a[0:3], a[180:183], v[192:195]
buffer_load_dwordx4 a[96:99], v38, s[24:27], s96 offen sc1
v_mfma_f32_16x16x32_bf16 v[196:199], a[4:7], a[180:183], v[196:199]
s_nop 0
ds_read_b64_tr_b16 a[34:35], v132 offset:12288
ds_read_b64_tr_b16 a[36:37], v133 offset:8192
v_mfma_f32_16x16x32_bf16 v[164:167], a[4:7], a[176:179], v[164:167]
s_waitcnt lgkmcnt(11)
ds_read_b64_tr_b16 a[38:39], v133 offset:12288
v_mfma_f32_16x16x32_bf16 v[168:171], a[8:11], a[176:179], v[168:171]
ds_read_b64_tr_b16 a[40:41], v134 offset:8192
v_mfma_f32_16x16x32_bf16 v[200:203], a[8:11], a[180:183], v[200:203]
buffer_load_dwordx4 a[100:103], v39, s[24:27], s96 offen sc1
v_mfma_f32_16x16x32_bf16 v[204:207], a[12:15], a[180:183], v[204:207]
s_add_u32 s95, s48, 2424832
ds_read_b64_tr_b16 a[42:43], v134 offset:12288
ds_read_b64_tr_b16 a[44:45], v135 offset:8192
v_mfma_f32_16x16x32_bf16 v[172:175], a[12:15], a[176:179], v[172:175]
s_waitcnt lgkmcnt(11)
ds_read_b64_tr_b16 a[46:47], v135 offset:12288
s_add_u32 m0, s82, 98304
v_mfma_f32_16x16x32_bf16 v[176:179], a[16:19], a[176:179], v[176:179]
s_nop 0
ds_read_b64_tr_b16 a[48:49], v140 offset:8192
v_mfma_f32_16x16x32_bf16 v[208:211], a[16:19], a[180:183], v[208:211]
buffer_load_dwordx4 v34, s[16:19], s95 offen lds
v_mfma_f32_16x16x32_bf16 v[212:215], a[20:23], a[180:183], v[212:215]
s_add_u32 m0, s82, 100352
ds_read_b64_tr_b16 a[50:51], v140 offset:12288
ds_read_b64_tr_b16 a[52:53], v141 offset:8192
v_mfma_f32_16x16x32_bf16 v[180:183], a[20:23], a[176:179], v[180:183]
s_waitcnt lgkmcnt(11)
ds_read_b64_tr_b16 a[54:55], v141 offset:12288
v_mfma_f32_16x16x32_bf16 v[184:187], a[24:27], a[176:179], v[184:187]
buffer_load_dwordx4 v35, s[16:19], s95 offen lds
v_mfma_f32_16x16x32_bf16 v[216:219], a[24:27], a[180:183], v[216:219]
s_nop 0
ds_read_b64_tr_b16 a[56:57], v142 offset:8192
ds_read_b64_tr_b16 a[58:59], v142 offset:12288
v_mfma_f32_16x16x32_bf16 v[220:223], a[28:31], a[180:183], v[220:223]
s_waitcnt vmcnt(26) lgkmcnt(10)
ds_read_b64_tr_b16 a[60:61], v143 offset:8192
v_mfma_f32_16x16x32_bf16 v[188:191], a[28:31], a[176:179], v[188:191]
s_barrier
ds_read_b64_tr_b16 a[62:63], v143 offset:12288
v_mfma_f32_16x16x32_bf16 v[160:163], a[32:35], a[184:187], v[160:163]
s_add_u32 s93, s49, 20480
ds_read_b64_tr_b16 a[0:1], v132 offset:16384
v_mfma_f32_16x16x32_bf16 v[192:195], a[32:35], a[188:191], v[192:195]
buffer_load_dwordx4 a[104:107], v38, s[24:27], s93 offen sc1
v_mfma_f32_16x16x32_bf16 v[196:199], a[36:39], a[188:191], v[196:199]
s_nop 0
ds_read_b64_tr_b16 a[2:3], v132 offset:20480
ds_read_b64_tr_b16 a[4:5], v133 offset:16384
v_mfma_f32_16x16x32_bf16 v[164:167], a[36:39], a[184:187], v[164:167]
s_waitcnt lgkmcnt(11)
ds_read_b64_tr_b16 a[6:7], v133 offset:20480
v_mfma_f32_16x16x32_bf16 v[168:171], a[40:43], a[184:187], v[168:171]
ds_read_b64_tr_b16 a[8:9], v134 offset:16384
v_mfma_f32_16x16x32_bf16 v[200:203], a[40:43], a[188:191], v[200:203]
buffer_load_dwordx4 a[108:111], v39, s[24:27], s93 offen sc1
v_mfma_f32_16x16x32_bf16 v[204:207], a[44:47], a[188:191], v[204:207]
s_add_u32 s97, s48, 2686976
ds_read_b64_tr_b16 a[10:11], v134 offset:20480
ds_read_b64_tr_b16 a[12:13], v135 offset:16384
v_mfma_f32_16x16x32_bf16 v[172:175], a[44:47], a[184:187], v[172:175]
s_waitcnt lgkmcnt(11)
ds_read_b64_tr_b16 a[14:15], v135 offset:20480
s_add_u32 m0, s82, 106496
v_mfma_f32_16x16x32_bf16 v[176:179], a[48:51], a[184:187], v[176:179]
s_nop 0
ds_read_b64_tr_b16 a[16:17], v140 offset:16384
v_mfma_f32_16x16x32_bf16 v[208:211], a[48:51], a[188:191], v[208:211]
buffer_load_dwordx4 v34, s[16:19], s97 offen lds
v_mfma_f32_16x16x32_bf16 v[212:215], a[52:55], a[188:191], v[212:215]
s_add_u32 m0, s82, 108544
ds_read_b64_tr_b16 a[18:19], v140 offset:20480
ds_read_b64_tr_b16 a[20:21], v141 offset:16384
v_mfma_f32_16x16x32_bf16 v[180:183], a[52:55], a[184:187], v[180:183]
s_waitcnt lgkmcnt(11)
ds_read_b64_tr_b16 a[22:23], v141 offset:20480
v_mfma_f32_16x16x32_bf16 v[184:187], a[56:59], a[184:187], v[184:187]
buffer_load_dwordx4 v35, s[16:19], s97 offen lds
v_mfma_f32_16x16x32_bf16 v[216:219], a[56:59], a[188:191], v[216:219]
s_nop 0
ds_read_b64_tr_b16 a[24:25], v142 offset:16384
ds_read_b64_tr_b16 a[26:27], v142 offset:20480
v_mfma_f32_16x16x32_bf16 v[220:223], a[60:63], a[188:191], v[220:223]
s_waitcnt vmcnt(26) lgkmcnt(10)
ds_read_b64_tr_b16 a[28:29], v143 offset:16384
v_mfma_f32_16x16x32_bf16 v[188:191], a[60:63], a[184:187], v[188:191]
s_barrier
ds_read_b64_tr_b16 a[30:31], v143 offset:20480
Lv32:
v_mfma_f32_16x16x32_bf16 v[160:163], a[0:3], a[64:67], v[160:163]
s_add_u32 s95, s49, 23552
ds_read_b64_tr_b16 a[32:33], v132 offset:24576
s_waitcnt vmcnt(9)
v_sub_f32 v22, 1.0, v22
v_mfma_f32_16x16x32_bf16 v[192:195], a[0:3], a[68:71], v[192:195]
buffer_load_dwordx4 a[112:115], v38, s[24:27], s95 offen sc1
ds_read_b64_tr_b16 a[34:35], v132 offset:28672
v_mfma_f32_16x16x32_bf16 v[196:199], a[4:7], a[68:71], v[196:199]
ds_read_b64_tr_b16 a[36:37], v133 offset:24576
v_sub_f32 v23, 1.0, v23
v_cvt_pk_bf16_f32 v108, v92, v93
v_mfma_f32_16x16x32_bf16 v[164:167], a[4:7], a[64:67], v[164:167]
s_waitcnt lgkmcnt(11)
ds_read_b64_tr_b16 a[38:39], v133 offset:28672
v_cvt_pk_bf16_f32 v109, v94, v95
v_cvt_pk_bf16_f32 v110, v96, v97
v_mfma_f32_16x16x32_bf16 v[168:171], a[8:11], a[64:67], v[168:171]
ds_read_b64_tr_b16 a[40:41], v134 offset:24576
v_cvt_pk_bf16_f32 v111, v98, v99
v_cvt_pk_bf16_f32 v100, v76, v77
v_mfma_f32_16x16x32_bf16 v[200:203], a[8:11], a[68:71], v[200:203]
buffer_load_dwordx4 a[116:119], v39, s[24:27], s95 offen sc1
ds_read_b64_tr_b16 a[42:43], v134 offset:28672
v_mfma_f32_16x16x32_bf16 v[204:207], a[12:15], a[68:71], v[204:207]
s_add_u32 s94, s48, 2883584
ds_read_b64_tr_b16 a[44:45], v135 offset:24576
s_add_u32 m0, s82, 114688
v_cvt_pk_bf16_f32 v101, v78, v79
v_mfma_f32_16x16x32_bf16 v[172:175], a[12:15], a[64:67], v[172:175]
s_waitcnt lgkmcnt(11)
ds_read_b64_tr_b16 a[46:47], v135 offset:28672
v_cvt_pk_bf16_f32 v102, v84, v85
v_cvt_pk_bf16_f32 v103, v86, v87
v_mfma_f32_16x16x32_bf16 v[176:179], a[16:19], a[64:67], v[176:179]
s_nop 0
ds_read_b64_tr_b16 a[48:49], v140 offset:24576
v_cvt_pk_bf16_f32 v104, v80, v81
v_cvt_pk_bf16_f32 v105, v82, v83
v_mfma_f32_16x16x32_bf16 v[208:211], a[16:19], a[68:71], v[208:211]
buffer_load_dwordx4 v34, s[16:19], s94 offen lds
ds_read_b64_tr_b16 a[50:51], v140 offset:28672
v_mfma_f32_16x16x32_bf16 v[212:215], a[20:23], a[68:71], v[212:215]
s_add_u32 m0, s82, 116736
ds_read_b64_tr_b16 a[52:53], v141 offset:24576
v_cvt_pk_bf16_f32 v106, v88, v89
v_cvt_pk_bf16_f32 v107, v90, v91
v_mfma_f32_16x16x32_bf16 v[180:183], a[20:23], a[64:67], v[180:183]
s_waitcnt lgkmcnt(11)
ds_read_b64_tr_b16 a[54:55], v141 offset:28672
v_mfma_f32_16x16x32_bf16 v[184:187], a[24:27], a[64:67], v[184:187]
buffer_load_dwordx4 v35, s[16:19], s94 offen lds
ds_read_b64_tr_b16 a[56:57], v142 offset:24576
v_mfma_f32_16x16x32_bf16 v[48:51], v[108:111], v[224:227], 0
v_mfma_f32_16x16x32_bf16 v[52:55], v[108:111], v[228:231], 0
v_mfma_f32_16x16x32_bf16 v[56:59], v[108:111], v[232:235], 0
v_mfma_f32_16x16x32_bf16 v[60:63], v[108:111], v[236:239], 0
v_mfma_f32_16x16x32_bf16 v[112:115], v[100:103], v[224:227], 0
v_mfma_f32_16x16x32_bf16 v[116:119], v[104:107], v[224:227], 0
v_mfma_f32_16x16x32_bf16 v[120:123], v[100:103], v[228:231], 0
v_mfma_f32_16x16x32_bf16 v[124:127], v[104:107], v[228:231], 0
v_mfma_f32_16x16x32_bf16 v[76:79], v[100:103], v[232:235], 0
v_add_f32 v48, s91, v48
v_rcp_f32 v48, v48
v_mfma_f32_16x16x32_bf16 v[80:83], v[104:107], v[232:235], 0
v_add_f32 v52, s91, v52
v_rcp_f32 v52, v52
v_mfma_f32_16x16x32_bf16 v[84:87], v[100:103], v[236:239], 0
v_add_f32 v56, s91, v56
v_rcp_f32 v56, v56
v_mfma_f32_16x16x32_bf16 v[88:91], v[104:107], v[236:239], 0
v_add_f32 v60, s91, v60
v_rcp_f32 v60, v60
v_mfma_f32_16x16x32_bf16 v[216:219], a[24:27], a[68:71], v[216:219]
ds_read_b64_tr_b16 a[58:59], v142 offset:28672
v_mul_f32 v48, v48, v136
v_mul_f32 v52, v52, v137
v_mfma_f32_16x16x32_bf16 v[220:223], a[28:31], a[68:71], v[220:223]
s_waitcnt lgkmcnt(10)
ds_read_b64_tr_b16 a[60:61], v143 offset:24576
v_mul_f32 v56, v56, v138
v_mul_f32 v60, v60, v139
v_mfma_f32_16x16x32_bf16 v[188:191], a[28:31], a[64:67], v[188:191]
s_barrier
ds_read_b64_tr_b16 a[62:63], v143 offset:28672
v_mul_f32 v112, v112, v48
v_mul_f32 v113, v113, v48
v_mfma_f32_16x16x32_bf16 v[160:163], a[32:35], a[72:75], v[160:163]
s_add_u32 s97, s49, 27648
ds_read_b64_tr_b16 a[0:1], v132 offset:32768
v_mul_f32 v114, v114, v48
v_mul_f32 v115, v115, v48
v_mfma_f32_16x16x32_bf16 v[192:195], a[32:35], a[76:79], v[192:195]
buffer_load_dwordx4 a[120:123], v38, s[24:27], s97 offen sc1
ds_read_b64_tr_b16 a[2:3], v132 offset:36864
v_mfma_f32_16x16x32_bf16 v[196:199], a[36:39], a[76:79], v[196:199]
ds_read_b64_tr_b16 a[4:5], v133 offset:32768
v_mul_f32 v116, v116, v48
v_mul_f32 v117, v117, v48
v_mfma_f32_16x16x32_bf16 v[164:167], a[36:39], a[72:75], v[164:167]
s_waitcnt lgkmcnt(11)
ds_read_b64_tr_b16 a[6:7], v133 offset:36864
v_mul_f32 v118, v118, v48
v_mul_f32 v119, v119, v48
v_mfma_f32_16x16x32_bf16 v[168:171], a[40:43], a[72:75], v[168:171]
ds_read_b64_tr_b16 a[8:9], v134 offset:32768
v_cvt_pk_bf16_f32 v112, v112, v113
v_cvt_pk_bf16_f32 v113, v114, v115
v_mfma_f32_16x16x32_bf16 v[200:203], a[40:43], a[76:79], v[200:203]
buffer_load_dwordx4 a[124:127], v39, s[24:27], s97 offen sc1
ds_read_b64_tr_b16 a[10:11], v134 offset:36864
v_mfma_f32_16x16x32_bf16 v[204:207], a[44:47], a[76:79], v[204:207]
s_add_u32 s96, s48, 3145728
ds_read_b64_tr_b16 a[12:13], v135 offset:32768
s_add_u32 m0, s82, 122880
v_cvt_pk_bf16_f32 v114, v116, v117
v_mfma_f32_16x16x32_bf16 v[172:175], a[44:47], a[72:75], v[172:175]
s_waitcnt lgkmcnt(11)
ds_read_b64_tr_b16 a[14:15], v135 offset:36864
v_cvt_pk_bf16_f32 v115, v118, v119
v_mul_f32 v120, v120, v52
v_mfma_f32_16x16x32_bf16 v[176:179], a[48:51], a[72:75], v[176:179]
s_nop 0
ds_read_b64_tr_b16 a[16:17], v140 offset:32768
v_mul_f32 v121, v121, v52
v_mul_f32 v122, v122, v52
v_mfma_f32_16x16x32_bf16 v[208:211], a[48:51], a[76:79], v[208:211]
buffer_load_dwordx4 v34, s[16:19], s96 offen lds
ds_read_b64_tr_b16 a[18:19], v140 offset:36864
v_mfma_f32_16x16x32_bf16 v[212:215], a[52:55], a[76:79], v[212:215]
s_add_u32 m0, s82, 124928
ds_read_b64_tr_b16 a[20:21], v141 offset:32768
v_mul_f32 v123, v123, v52
v_mul_f32 v124, v124, v52
v_mfma_f32_16x16x32_bf16 v[180:183], a[52:55], a[72:75], v[180:183]
s_waitcnt lgkmcnt(11)
ds_read_b64_tr_b16 a[22:23], v141 offset:36864
v_mul_f32 v125, v125, v52
v_mul_f32 v126, v126, v52
v_mfma_f32_16x16x32_bf16 v[184:187], a[56:59], a[72:75], v[184:187]
buffer_load_dwordx4 v35, s[16:19], s96 offen lds
ds_read_b64_tr_b16 a[24:25], v142 offset:32768
v_mfma_f32_16x16x32_bf16 v[216:219], a[56:59], a[76:79], v[216:219]
ds_read_b64_tr_b16 a[26:27], v142 offset:36864
v_mul_f32 v127, v127, v52
v_cvt_pk_bf16_f32 v120, v120, v121
v_mfma_f32_16x16x32_bf16 v[220:223], a[60:63], a[76:79], v[220:223]
s_waitcnt lgkmcnt(10)
ds_read_b64_tr_b16 a[28:29], v143 offset:32768
v_cvt_pk_bf16_f32 v121, v122, v123
v_cvt_pk_bf16_f32 v122, v124, v125
v_mfma_f32_16x16x32_bf16 v[188:191], a[60:63], a[72:75], v[188:191]
s_barrier
ds_read_b64_tr_b16 a[30:31], v143 offset:36864
v_cvt_pk_bf16_f32 v123, v126, v127
v_mul_f32 v76, v76, v56
v_mfma_f32_16x16x32_bf16 v[160:163], a[0:3], a[80:83], v[160:163]
s_add_u32 s94, s49, 30720
ds_read_b64_tr_b16 a[32:33], v132 offset:40960
v_mul_f32 v77, v77, v56
v_mul_f32 v78, v78, v56
v_mfma_f32_16x16x32_bf16 v[192:195], a[0:3], a[84:87], v[192:195]
buffer_load_dwordx4 a[128:131], v38, s[24:27], s94 offen sc1
ds_read_b64_tr_b16 a[34:35], v132 offset:45056
v_mfma_f32_16x16x32_bf16 v[196:199], a[4:7], a[84:87], v[196:199]
ds_read_b64_tr_b16 a[36:37], v133 offset:40960
v_mul_f32 v79, v79, v56
v_mul_f32 v80, v80, v56
v_mfma_f32_16x16x32_bf16 v[164:167], a[4:7], a[80:83], v[164:167]
s_waitcnt lgkmcnt(11)
ds_read_b64_tr_b16 a[38:39], v133 offset:45056
v_mul_f32 v81, v81, v56
v_mul_f32 v82, v82, v56
v_mfma_f32_16x16x32_bf16 v[168:171], a[8:11], a[80:83], v[168:171]
ds_read_b64_tr_b16 a[40:41], v134 offset:40960
v_mul_f32 v83, v83, v56
v_cvt_pk_bf16_f32 v76, v76, v77
v_mfma_f32_16x16x32_bf16 v[200:203], a[8:11], a[84:87], v[200:203]
buffer_load_dwordx4 a[132:135], v39, s[24:27], s94 offen sc1
ds_read_b64_tr_b16 a[42:43], v134 offset:45056
v_mfma_f32_16x16x32_bf16 v[204:207], a[12:15], a[84:87], v[204:207]
s_add_u32 s93, s48, 3342336
ds_read_b64_tr_b16 a[44:45], v135 offset:40960
s_add_u32 m0, s82, 0
v_cvt_pk_bf16_f32 v77, v78, v79
v_mfma_f32_16x16x32_bf16 v[172:175], a[12:15], a[80:83], v[172:175]
s_waitcnt lgkmcnt(11)
ds_read_b64_tr_b16 a[46:47], v135 offset:45056
v_cvt_pk_bf16_f32 v78, v80, v81
v_cvt_pk_bf16_f32 v79, v82, v83
v_mfma_f32_16x16x32_bf16 v[176:179], a[16:19], a[80:83], v[176:179]
ds_read_b64_tr_b16 a[48:49], v140 offset:40960
v_mul_f32 v84, v84, v60
v_mul_f32 v85, v85, v60
v_mfma_f32_16x16x32_bf16 v[208:211], a[16:19], a[84:87], v[208:211]
buffer_load_dwordx4 v34, s[16:19], s93 offen lds
ds_read_b64_tr_b16 a[50:51], v140 offset:45056
v_mfma_f32_16x16x32_bf16 v[212:215], a[20:23], a[84:87], v[212:215]
s_add_u32 m0, s82, 2048
ds_read_b64_tr_b16 a[52:53], v141 offset:40960
v_mul_f32 v86, v86, v60
v_mul_f32 v87, v87, v60
v_mfma_f32_16x16x32_bf16 v[180:183], a[20:23], a[80:83], v[180:183]
s_waitcnt lgkmcnt(11)
ds_read_b64_tr_b16 a[54:55], v141 offset:45056
v_mul_f32 v88, v88, v60
v_mul_f32 v89, v89, v60
v_mfma_f32_16x16x32_bf16 v[184:187], a[24:27], a[80:83], v[184:187]
buffer_load_dwordx4 v35, s[16:19], s93 offen lds
ds_read_b64_tr_b16 a[56:57], v142 offset:40960
v_mfma_f32_16x16x32_bf16 v[216:219], a[24:27], a[84:87], v[216:219]
ds_read_b64_tr_b16 a[58:59], v142 offset:45056
v_mul_f32 v90, v90, v60
v_mul_f32 v91, v91, v60
v_mfma_f32_16x16x32_bf16 v[220:223], a[28:31], a[84:87], v[220:223]
s_waitcnt lgkmcnt(10)
ds_read_b64_tr_b16 a[60:61], v143 offset:40960
v_cvt_pk_bf16_f32 v84, v84, v85
v_cvt_pk_bf16_f32 v85, v86, v87
v_mfma_f32_16x16x32_bf16 v[188:191], a[28:31], a[80:83], v[188:191]
s_barrier
ds_read_b64_tr_b16 a[62:63], v143 offset:45056
v_cvt_pk_bf16_f32 v86, v88, v89
v_cvt_pk_bf16_f32 v87, v90, v91
v_mfma_f32_16x16x32_bf16 v[160:163], a[32:35], a[88:91], v[160:163]
buffer_store_dwordx4 v[112:115], v36, s[24:27], 0 offen sc1
ds_read_b64_tr_b16 a[0:1], v132 offset:49152
v_mfma_f32_16x16x32_bf16 v[192:195], a[32:35], a[92:95], v[192:195]
buffer_store_dwordx4 v[120:123], v36, s[24:27], s36 offen sc1
ds_read_b64_tr_b16 a[2:3], v132 offset:53248
v_mfma_f32_16x16x32_bf16 v[196:199], a[36:39], a[92:95], v[196:199]
buffer_store_dwordx4 v[76:79], v36, s[24:27], s37 offen sc1
ds_read_b64_tr_b16 a[4:5], v133 offset:49152
v_mfma_f32_16x16x32_bf16 v[164:167], a[36:39], a[88:91], v[164:167]
s_waitcnt lgkmcnt(11)
buffer_store_dwordx4 v[84:87], v36, s[24:27], s38 offen sc1
v_mfma_f32_16x16x32_bf16 v[168:171], a[40:43], a[88:91], v[168:171]
s_add_u32 s95, s49, 34816
ds_read_b64_tr_b16 a[6:7], v133 offset:53248
ds_read_b64_tr_b16 a[8:9], v134 offset:49152
v_mfma_f32_16x16x32_bf16 v[200:203], a[40:43], a[92:95], v[200:203]
buffer_load_dwordx4 a[136:139], v38, s[24:27], s95 offen sc1
ds_read_b64_tr_b16 a[10:11], v134 offset:53248
v_mfma_f32_16x16x32_bf16 v[204:207], a[44:47], a[92:95], v[204:207]
buffer_load_dwordx4 a[140:143], v39, s[24:27], s95 offen sc1
ds_read_b64_tr_b16 a[12:13], v135 offset:49152
v_mfma_f32_16x16x32_bf16 v[172:175], a[44:47], a[88:91], v[172:175]
s_waitcnt lgkmcnt(11)
ds_read_b64_tr_b16 a[14:15], v135 offset:53248
v_mfma_f32_16x16x32_bf16 v[176:179], a[48:51], a[88:91], v[176:179]
ds_read_b64_tr_b16 a[16:17], v140 offset:49152
v_mfma_f32_16x16x32_bf16 v[208:211], a[48:51], a[92:95], v[208:211]
ds_read_b64_tr_b16 a[18:19], v140 offset:53248
v_mfma_f32_16x16x32_bf16 v[212:215], a[52:55], a[92:95], v[212:215]
ds_read_b64_tr_b16 a[20:21], v141 offset:49152
v_mfma_f32_16x16x32_bf16 v[180:183], a[52:55], a[88:91], v[180:183]
s_waitcnt lgkmcnt(11)
ds_read_b64_tr_b16 a[22:23], v141 offset:53248
v_mfma_f32_16x16x32_bf16 v[184:187], a[56:59], a[88:91], v[184:187]
ds_read_b64_tr_b16 a[24:25], v142 offset:49152
v_mfma_f32_16x16x32_bf16 v[216:219], a[56:59], a[92:95], v[216:219]
ds_read_b64_tr_b16 a[26:27], v142 offset:53248
v_mfma_f32_16x16x32_bf16 v[220:223], a[60:63], a[92:95], v[220:223]
s_waitcnt vmcnt(24) lgkmcnt(10)
ds_read_b64_tr_b16 a[28:29], v143 offset:49152
v_mfma_f32_16x16x32_bf16 v[188:191], a[60:63], a[88:91], v[188:191]
s_barrier
ds_read_b64_tr_b16 a[30:31], v143 offset:53248
v_mfma_f32_16x16x32_bf16 v[160:163], a[0:3], a[96:99], v[160:163]
s_add_u32 s97, s49, 37888
ds_read_b64_tr_b16 a[32:33], v132 offset:57344
v_mfma_f32_16x16x32_bf16 v[192:195], a[0:3], a[100:103], v[192:195]
buffer_load_dwordx4 a[144:147], v38, s[24:27], s97 offen sc1
v_mfma_f32_16x16x32_bf16 v[196:199], a[4:7], a[100:103], v[196:199]
s_nop 0
ds_read_b64_tr_b16 a[34:35], v132 offset:61440
ds_read_b64_tr_b16 a[36:37], v133 offset:57344
v_mfma_f32_16x16x32_bf16 v[164:167], a[4:7], a[96:99], v[164:167]
s_waitcnt lgkmcnt(11)
ds_read_b64_tr_b16 a[38:39], v133 offset:61440
v_mfma_f32_16x16x32_bf16 v[168:171], a[8:11], a[96:99], v[168:171]
ds_read_b64_tr_b16 a[40:41], v134 offset:57344
v_mfma_f32_16x16x32_bf16 v[200:203], a[8:11], a[100:103], v[200:203]
buffer_load_dwordx4 a[148:151], v39, s[24:27], s97 offen sc1
v_mfma_f32_16x16x32_bf16 v[204:207], a[12:15], a[100:103], v[204:207]
s_add_u32 s96, s48, 3604480
ds_read_b64_tr_b16 a[42:43], v134 offset:61440
ds_read_b64_tr_b16 a[44:45], v135 offset:57344
v_mfma_f32_16x16x32_bf16 v[172:175], a[12:15], a[96:99], v[172:175]
s_waitcnt lgkmcnt(11)
ds_read_b64_tr_b16 a[46:47], v135 offset:61440
s_add_u32 m0, s82, 8192
v_mfma_f32_16x16x32_bf16 v[176:179], a[16:19], a[96:99], v[176:179]
s_nop 0
ds_read_b64_tr_b16 a[48:49], v140 offset:57344
v_mfma_f32_16x16x32_bf16 v[208:211], a[16:19], a[100:103], v[208:211]
buffer_load_dwordx4 v34, s[16:19], s96 offen lds
v_mfma_f32_16x16x32_bf16 v[212:215], a[20:23], a[100:103], v[212:215]
s_add_u32 m0, s82, 10240
ds_read_b64_tr_b16 a[50:51], v140 offset:61440
ds_read_b64_tr_b16 a[52:53], v141 offset:57344
v_mfma_f32_16x16x32_bf16 v[180:183], a[20:23], a[96:99], v[180:183]
s_waitcnt lgkmcnt(11)
ds_read_b64_tr_b16 a[54:55], v141 offset:61440
v_mfma_f32_16x16x32_bf16 v[184:187], a[24:27], a[96:99], v[184:187]
buffer_load_dwordx4 v35, s[16:19], s96 offen lds
v_mfma_f32_16x16x32_bf16 v[216:219], a[24:27], a[100:103], v[216:219]
s_nop 0
ds_read_b64_tr_b16 a[56:57], v142 offset:57344
ds_read_b64_tr_b16 a[58:59], v142 offset:61440
v_mfma_f32_16x16x32_bf16 v[220:223], a[28:31], a[100:103], v[220:223]
s_waitcnt vmcnt(24) lgkmcnt(10)
ds_read_b64_tr_b16 a[60:61], v143 offset:57344
v_mfma_f32_16x16x32_bf16 v[188:191], a[28:31], a[96:99], v[188:191]
s_barrier
ds_read_b64_tr_b16 a[62:63], v143 offset:61440
v_mfma_f32_16x16x32_bf16 v[160:163], a[32:35], a[104:107], v[160:163]
s_add_u32 s94, s49, 41984
ds_read_b64_tr_b16 a[0:1], v148 offset:0
v_mfma_f32_16x16x32_bf16 v[192:195], a[32:35], a[108:111], v[192:195]
buffer_load_dwordx4 a[152:155], v38, s[24:27], s94 offen sc1
v_mfma_f32_16x16x32_bf16 v[196:199], a[36:39], a[108:111], v[196:199]
s_nop 0
ds_read_b64_tr_b16 a[2:3], v148 offset:4096
ds_read_b64_tr_b16 a[4:5], v149 offset:0
v_mfma_f32_16x16x32_bf16 v[164:167], a[36:39], a[104:107], v[164:167]
s_waitcnt lgkmcnt(11)
ds_read_b64_tr_b16 a[6:7], v149 offset:4096
v_mfma_f32_16x16x32_bf16 v[168:171], a[40:43], a[104:107], v[168:171]
ds_read_b64_tr_b16 a[8:9], v150 offset:0
v_mfma_f32_16x16x32_bf16 v[200:203], a[40:43], a[108:111], v[200:203]
buffer_load_dwordx4 a[156:159], v39, s[24:27], s94 offen sc1
v_mfma_f32_16x16x32_bf16 v[204:207], a[44:47], a[108:111], v[204:207]
s_add_u32 s93, s48, 196608
ds_read_b64_tr_b16 a[10:11], v150 offset:4096
ds_read_b64_tr_b16 a[12:13], v151 offset:0
v_mfma_f32_16x16x32_bf16 v[172:175], a[44:47], a[104:107], v[172:175]
s_waitcnt lgkmcnt(11)
ds_read_b64_tr_b16 a[14:15], v151 offset:4096
s_add_u32 m0, s82, 16384
v_mfma_f32_16x16x32_bf16 v[176:179], a[48:51], a[104:107], v[176:179]
s_nop 0
ds_read_b64_tr_b16 a[16:17], v154 offset:0
v_mfma_f32_16x16x32_bf16 v[208:211], a[48:51], a[108:111], v[208:211]
buffer_load_dwordx4 v34, s[16:19], s93 offen lds
v_mfma_f32_16x16x32_bf16 v[212:215], a[52:55], a[108:111], v[212:215]
s_add_u32 m0, s82, 18432
ds_read_b64_tr_b16 a[18:19], v154 offset:4096
ds_read_b64_tr_b16 a[20:21], v155 offset:0
v_mfma_f32_16x16x32_bf16 v[180:183], a[52:55], a[104:107], v[180:183]
s_waitcnt lgkmcnt(11)
ds_read_b64_tr_b16 a[22:23], v155 offset:4096
v_mfma_f32_16x16x32_bf16 v[184:187], a[56:59], a[104:107], v[184:187]
buffer_load_dwordx4 v35, s[16:19], s93 offen lds
v_mfma_f32_16x16x32_bf16 v[216:219], a[56:59], a[108:111], v[216:219]
s_nop 0
ds_read_b64_tr_b16 a[24:25], v156 offset:0
ds_read_b64_tr_b16 a[26:27], v156 offset:4096
v_mfma_f32_16x16x32_bf16 v[220:223], a[60:63], a[108:111], v[220:223]
s_waitcnt vmcnt(24) lgkmcnt(10)
ds_read_b64_tr_b16 a[28:29], v157 offset:0
v_mfma_f32_16x16x32_bf16 v[188:191], a[60:63], a[104:107], v[188:191]
s_barrier
ds_read_b64_tr_b16 a[30:31], v157 offset:4096
v_mfma_f32_16x16x32_bf16 v[160:163], a[0:3], a[112:115], v[160:163]
s_add_u32 s96, s49, 45056
ds_read_b64_tr_b16 a[32:33], v148 offset:8192
s_waitcnt vmcnt(10)
v_mfma_f32_16x16x32_bf16 v[192:195], a[0:3], a[116:119], v[192:195]
buffer_load_dwordx4 a[160:163], v38, s[24:27], s96 offen sc1
ds_read_b64_tr_b16 a[34:35], v148 offset:12288
v_mfma_f32_16x16x32_bf16 v[196:199], a[4:7], a[116:119], v[196:199]
buffer_store_dword v29, v27, s[24:27], s88 offen sc1
ds_read_b64_tr_b16 a[36:37], v149 offset:8192
v_mfma_f32_16x16x32_bf16 v[164:167], a[4:7], a[112:115], v[164:167]
s_waitcnt lgkmcnt(11)
ds_read_b64_tr_b16 a[38:39], v149 offset:12288
s_mov_b32 s51, 32899072
v_mfma_f32_16x16x32_bf16 v[168:171], a[8:11], a[112:115], v[168:171]
ds_read_b64_tr_b16 a[40:41], v150 offset:8192
v_mfma_f32_16x16x32_bf16 v[200:203], a[8:11], a[116:119], v[200:203]
buffer_load_dwordx4 a[164:167], v39, s[24:27], s96 offen sc1
ds_read_b64_tr_b16 a[42:43], v150 offset:12288
v_mfma_f32_16x16x32_bf16 v[204:207], a[12:15], a[116:119], v[204:207]
s_add_u32 s95, s48, 655360
ds_read_b64_tr_b16 a[44:45], v151 offset:8192
s_add_u32 m0, s82, 24576
v_mfma_f32_16x16x32_bf16 v[172:175], a[12:15], a[112:115], v[172:175]
s_waitcnt lgkmcnt(11)
ds_read_b64_tr_b16 a[46:47], v151 offset:12288
v_mfma_f32_16x16x32_bf16 v[176:179], a[16:19], a[112:115], v[176:179]
ds_read_b64_tr_b16 a[48:49], v154 offset:8192
v_mfma_f32_16x16x32_bf16 v[208:211], a[16:19], a[116:119], v[208:211]
buffer_load_dwordx4 v34, s[16:19], s95 offen lds
ds_read_b64_tr_b16 a[50:51], v154 offset:12288
v_mfma_f32_16x16x32_bf16 v[212:215], a[20:23], a[116:119], v[212:215]
s_add_u32 m0, s82, 26624
ds_read_b64_tr_b16 a[52:53], v155 offset:8192
v_mfma_f32_16x16x32_bf16 v[180:183], a[20:23], a[112:115], v[180:183]
s_waitcnt lgkmcnt(11)
ds_read_b64_tr_b16 a[54:55], v155 offset:12288
v_mfma_f32_16x16x32_bf16 v[184:187], a[24:27], a[112:115], v[184:187]
buffer_load_dwordx4 v35, s[16:19], s95 offen lds
ds_read_b64_tr_b16 a[56:57], v156 offset:8192
v_mfma_f32_16x16x32_bf16 v[216:219], a[24:27], a[116:119], v[216:219]
ds_read_b64_tr_b16 a[58:59], v156 offset:12288
v_mfma_f32_16x16x32_bf16 v[220:223], a[28:31], a[116:119], v[220:223]
s_waitcnt lgkmcnt(10)
ds_read_b64_tr_b16 a[60:61], v157 offset:8192
v_mfma_f32_16x16x32_bf16 v[188:191], a[28:31], a[112:115], v[188:191]
s_barrier
ds_read_b64_tr_b16 a[62:63], v157 offset:12288
v_mfma_f32_16x16x32_bf16 v[160:163], a[32:35], a[120:123], v[160:163]
s_add_u32 s93, s49, 49152
ds_read_b64_tr_b16 a[0:1], v148 offset:16384
v_mfma_f32_16x16x32_bf16 v[192:195], a[32:35], a[124:127], v[192:195]
buffer_load_dwordx4 a[168:171], v38, s[24:27], s93 offen sc1
v_mfma_f32_16x16x32_bf16 v[196:199], a[36:39], a[124:127], v[196:199]
s_nop 0
ds_read_b64_tr_b16 a[2:3], v148 offset:20480
ds_read_b64_tr_b16 a[4:5], v149 offset:16384
v_mfma_f32_16x16x32_bf16 v[164:167], a[36:39], a[120:123], v[164:167]
s_waitcnt lgkmcnt(11)
ds_read_b64_tr_b16 a[6:7], v149 offset:20480
v_mfma_f32_16x16x32_bf16 v[168:171], a[40:43], a[120:123], v[168:171]
ds_read_b64_tr_b16 a[8:9], v150 offset:16384
v_mfma_f32_16x16x32_bf16 v[200:203], a[40:43], a[124:127], v[200:203]
buffer_load_dwordx4 a[172:175], v39, s[24:27], s93 offen sc1
v_mfma_f32_16x16x32_bf16 v[204:207], a[44:47], a[124:127], v[204:207]
s_add_u32 s97, s48, 1114112
ds_read_b64_tr_b16 a[10:11], v150 offset:20480
ds_read_b64_tr_b16 a[12:13], v151 offset:16384
v_mfma_f32_16x16x32_bf16 v[172:175], a[44:47], a[120:123], v[172:175]
s_waitcnt lgkmcnt(11)
ds_read_b64_tr_b16 a[14:15], v151 offset:20480
s_add_u32 m0, s82, 32768
v_mfma_f32_16x16x32_bf16 v[176:179], a[48:51], a[120:123], v[176:179]
s_nop 0
ds_read_b64_tr_b16 a[16:17], v154 offset:16384
v_mfma_f32_16x16x32_bf16 v[208:211], a[48:51], a[124:127], v[208:211]
buffer_load_dwordx4 v34, s[16:19], s97 offen lds
v_mfma_f32_16x16x32_bf16 v[212:215], a[52:55], a[124:127], v[212:215]
s_add_u32 m0, s82, 34816
ds_read_b64_tr_b16 a[18:19], v154 offset:20480
ds_read_b64_tr_b16 a[20:21], v155 offset:16384
v_mfma_f32_16x16x32_bf16 v[180:183], a[52:55], a[120:123], v[180:183]
s_waitcnt lgkmcnt(11)
ds_read_b64_tr_b16 a[22:23], v155 offset:20480
v_mfma_f32_16x16x32_bf16 v[184:187], a[56:59], a[120:123], v[184:187]
buffer_load_dwordx4 v35, s[16:19], s97 offen lds
v_mfma_f32_16x16x32_bf16 v[216:219], a[56:59], a[124:127], v[216:219]
s_nop 0
ds_read_b64_tr_b16 a[24:25], v156 offset:16384
ds_read_b64_tr_b16 a[26:27], v156 offset:20480
v_mfma_f32_16x16x32_bf16 v[220:223], a[60:63], a[124:127], v[220:223]
s_waitcnt lgkmcnt(10)
ds_read_b64_tr_b16 a[28:29], v157 offset:16384
Lpad13:
s_cbranch_execz Lpadback1
s_nop 0
v_mfma_f32_16x16x32_bf16 v[188:191], a[60:63], a[120:123], v[188:191]
s_barrier
ds_read_b64_tr_b16 a[30:31], v157 offset:20480
Lv40:
v_mfma_f32_16x16x32_bf16 v[160:163], a[0:3], a[128:131], v[160:163]
s_add_u32 s95, s49, 52224
ds_read_b64_tr_b16 a[32:33], v148 offset:24576
v_mfma_f32_16x16x32_bf16 v[192:195], a[0:3], a[132:135], v[192:195]
buffer_load_dwordx4 a[176:179], v38, s[24:27], s95 offen sc1
v_mfma_f32_16x16x32_bf16 v[196:199], a[4:7], a[132:135], v[196:199]
s_nop 0
ds_read_b64_tr_b16 a[34:35], v148 offset:28672
ds_read_b64_tr_b16 a[36:37], v149 offset:24576
v_mfma_f32_16x16x32_bf16 v[164:167], a[4:7], a[128:131], v[164:167]
s_waitcnt lgkmcnt(11)
ds_read_b64_tr_b16 a[38:39], v149 offset:28672
v_mfma_f32_16x16x32_bf16 v[168:171], a[8:11], a[128:131], v[168:171]
ds_read_b64_tr_b16 a[40:41], v150 offset:24576
v_mfma_f32_16x16x32_bf16 v[200:203], a[8:11], a[132:135], v[200:203]
buffer_load_dwordx4 a[180:183], v39, s[24:27], s95 offen sc1
v_mfma_f32_16x16x32_bf16 v[204:207], a[12:15], a[132:135], v[204:207]
s_add_u32 s94, s48, 1572864
ds_read_b64_tr_b16 a[42:43], v150 offset:28672
ds_read_b64_tr_b16 a[44:45], v151 offset:24576
v_mfma_f32_16x16x32_bf16 v[172:175], a[12:15], a[128:131], v[172:175]
s_waitcnt lgkmcnt(11)
ds_read_b64_tr_b16 a[46:47], v151 offset:28672
s_add_u32 m0, s82, 40960
v_mfma_f32_16x16x32_bf16 v[176:179], a[16:19], a[128:131], v[176:179]
s_nop 0
ds_read_b64_tr_b16 a[48:49], v154 offset:24576
v_mfma_f32_16x16x32_bf16 v[208:211], a[16:19], a[132:135], v[208:211]
buffer_load_dwordx4 v34, s[16:19], s94 offen lds
v_mfma_f32_16x16x32_bf16 v[212:215], a[20:23], a[132:135], v[212:215]
s_add_u32 m0, s82, 43008
ds_read_b64_tr_b16 a[50:51], v154 offset:28672
ds_read_b64_tr_b16 a[52:53], v155 offset:24576
v_mfma_f32_16x16x32_bf16 v[180:183], a[20:23], a[128:131], v[180:183]
s_waitcnt lgkmcnt(11)
ds_read_b64_tr_b16 a[54:55], v155 offset:28672
v_mfma_f32_16x16x32_bf16 v[184:187], a[24:27], a[128:131], v[184:187]
buffer_load_dwordx4 v35, s[16:19], s94 offen lds
v_mfma_f32_16x16x32_bf16 v[216:219], a[24:27], a[132:135], v[216:219]
s_nop 0
ds_read_b64_tr_b16 a[56:57], v156 offset:24576
ds_read_b64_tr_b16 a[58:59], v156 offset:28672
v_mfma_f32_16x16x32_bf16 v[220:223], a[28:31], a[132:135], v[220:223]
s_waitcnt vmcnt(21) lgkmcnt(10)
ds_read_b64_tr_b16 a[60:61], v157 offset:24576
v_mfma_f32_16x16x32_bf16 v[188:191], a[28:31], a[128:131], v[188:191]
s_barrier
ds_read_b64_tr_b16 a[62:63], v157 offset:28672
v_mfma_f32_16x16x32_bf16 v[160:163], a[32:35], a[136:139], v[160:163]
s_add_u32 s97, s49, 56320
ds_read_b64_tr_b16 a[0:1], v148 offset:32768
v_mfma_f32_16x16x32_bf16 v[192:195], a[32:35], a[140:143], v[192:195]
buffer_load_dwordx4 a[184:187], v38, s[24:27], s97 offen sc1
v_mfma_f32_16x16x32_bf16 v[196:199], a[36:39], a[140:143], v[196:199]
s_nop 0
ds_read_b64_tr_b16 a[2:3], v148 offset:36864
ds_read_b64_tr_b16 a[4:5], v149 offset:32768
v_mfma_f32_16x16x32_bf16 v[164:167], a[36:39], a[136:139], v[164:167]
s_waitcnt lgkmcnt(11)
ds_read_b64_tr_b16 a[6:7], v149 offset:36864
v_mfma_f32_16x16x32_bf16 v[168:171], a[40:43], a[136:139], v[168:171]
ds_read_b64_tr_b16 a[8:9], v150 offset:32768
v_mfma_f32_16x16x32_bf16 v[200:203], a[40:43], a[140:143], v[200:203]
buffer_load_dwordx4 a[188:191], v39, s[24:27], s97 offen sc1
v_mfma_f32_16x16x32_bf16 v[204:207], a[44:47], a[140:143], v[204:207]
s_add_u32 s96, s48, 2031616
ds_read_b64_tr_b16 a[10:11], v150 offset:36864
ds_read_b64_tr_b16 a[12:13], v151 offset:32768
v_mfma_f32_16x16x32_bf16 v[172:175], a[44:47], a[136:139], v[172:175]
s_waitcnt lgkmcnt(11)
ds_read_b64_tr_b16 a[14:15], v151 offset:36864
s_add_u32 m0, s82, 49152
v_mfma_f32_16x16x32_bf16 v[176:179], a[48:51], a[136:139], v[176:179]
s_nop 0
ds_read_b64_tr_b16 a[16:17], v154 offset:32768
v_mfma_f32_16x16x32_bf16 v[208:211], a[48:51], a[140:143], v[208:211]
buffer_load_dwordx4 v34, s[16:19], s96 offen lds
v_mfma_f32_16x16x32_bf16 v[212:215], a[52:55], a[140:143], v[212:215]
s_add_u32 m0, s82, 51200
ds_read_b64_tr_b16 a[18:19], v154 offset:36864
ds_read_b64_tr_b16 a[20:21], v155 offset:32768
v_mfma_f32_16x16x32_bf16 v[180:183], a[52:55], a[136:139], v[180:183]
s_waitcnt lgkmcnt(11)
ds_read_b64_tr_b16 a[22:23], v155 offset:36864
v_mfma_f32_16x16x32_bf16 v[184:187], a[56:59], a[136:139], v[184:187]
buffer_load_dwordx4 v35, s[16:19], s96 offen lds
v_mfma_f32_16x16x32_bf16 v[216:219], a[56:59], a[140:143], v[216:219]
s_nop 0
ds_read_b64_tr_b16 a[24:25], v156 offset:32768
ds_read_b64_tr_b16 a[26:27], v156 offset:36864
v_mfma_f32_16x16x32_bf16 v[220:223], a[60:63], a[140:143], v[220:223]
s_waitcnt vmcnt(23) lgkmcnt(10)
ds_read_b64_tr_b16 a[28:29], v157 offset:32768
v_mfma_f32_16x16x32_bf16 v[188:191], a[60:63], a[136:139], v[188:191]
s_barrier
ds_read_b64_tr_b16 a[30:31], v157 offset:36864
v_mfma_f32_16x16x32_bf16 v[160:163], a[0:3], a[144:147], v[160:163]
s_add_u32 s94, s49, 3072
ds_read_b64_tr_b16 a[32:33], v148 offset:40960
v_mfma_f32_16x16x32_bf16 v[192:195], a[0:3], a[148:151], v[192:195]
buffer_load_dwordx4 a[64:67], v38, s[24:27], s94 offen sc1
v_mfma_f32_16x16x32_bf16 v[196:199], a[4:7], a[148:151], v[196:199]
s_nop 0
ds_read_b64_tr_b16 a[34:35], v148 offset:45056
ds_read_b64_tr_b16 a[36:37], v149 offset:40960
v_mfma_f32_16x16x32_bf16 v[164:167], a[4:7], a[144:147], v[164:167]
s_waitcnt lgkmcnt(11)
ds_read_b64_tr_b16 a[38:39], v149 offset:45056
v_mfma_f32_16x16x32_bf16 v[168:171], a[8:11], a[144:147], v[168:171]
ds_read_b64_tr_b16 a[40:41], v150 offset:40960
v_mfma_f32_16x16x32_bf16 v[200:203], a[8:11], a[148:151], v[200:203]
buffer_load_dwordx4 a[68:71], v39, s[24:27], s94 offen sc1
v_mfma_f32_16x16x32_bf16 v[204:207], a[12:15], a[148:151], v[204:207]
s_add_u32 s93, s48, 2490368
ds_read_b64_tr_b16 a[42:43], v150 offset:45056
ds_read_b64_tr_b16 a[44:45], v151 offset:40960
v_mfma_f32_16x16x32_bf16 v[172:175], a[12:15], a[144:147], v[172:175]
s_waitcnt lgkmcnt(11)
ds_read_b64_tr_b16 a[46:47], v151 offset:45056
s_add_u32 m0, s82, 57344
v_mfma_f32_16x16x32_bf16 v[176:179], a[16:19], a[144:147], v[176:179]
s_nop 0
ds_read_b64_tr_b16 a[48:49], v154 offset:40960
v_mfma_f32_16x16x32_bf16 v[208:211], a[16:19], a[148:151], v[208:211]
buffer_load_dwordx4 v34, s[16:19], s93 offen lds
v_mfma_f32_16x16x32_bf16 v[212:215], a[20:23], a[148:151], v[212:215]
s_add_u32 m0, s82, 59392
ds_read_b64_tr_b16 a[50:51], v154 offset:45056
ds_read_b64_tr_b16 a[52:53], v155 offset:40960
v_mfma_f32_16x16x32_bf16 v[180:183], a[20:23], a[144:147], v[180:183]
s_waitcnt lgkmcnt(11)
ds_read_b64_tr_b16 a[54:55], v155 offset:45056
v_mfma_f32_16x16x32_bf16 v[184:187], a[24:27], a[144:147], v[184:187]
buffer_load_dwordx4 v35, s[16:19], s93 offen lds
v_mfma_f32_16x16x32_bf16 v[216:219], a[24:27], a[148:151], v[216:219]
s_nop 0
ds_read_b64_tr_b16 a[56:57], v156 offset:40960
ds_read_b64_tr_b16 a[58:59], v156 offset:45056
v_mfma_f32_16x16x32_bf16 v[220:223], a[28:31], a[148:151], v[220:223]
s_waitcnt vmcnt(23) lgkmcnt(10)
ds_read_b64_tr_b16 a[60:61], v157 offset:40960
v_mfma_f32_16x16x32_bf16 v[188:191], a[28:31], a[144:147], v[188:191]
s_barrier
ds_read_b64_tr_b16 a[62:63], v157 offset:45056
v_mfma_f32_16x16x32_bf16 v[160:163], a[32:35], a[152:155], v[160:163]
s_add_u32 s96, s49, 10240
ds_read_b64_tr_b16 a[0:1], v148 offset:49152
v_mfma_f32_16x16x32_bf16 v[192:195], a[32:35], a[156:159], v[192:195]
buffer_load_dwordx4 a[72:75], v38, s[24:27], s96 offen sc1
v_mfma_f32_16x16x32_bf16 v[196:199], a[36:39], a[156:159], v[196:199]
s_nop 0
ds_read_b64_tr_b16 a[2:3], v148 offset:53248
ds_read_b64_tr_b16 a[4:5], v149 offset:49152
v_mfma_f32_16x16x32_bf16 v[164:167], a[36:39], a[152:155], v[164:167]
s_waitcnt lgkmcnt(11)
ds_read_b64_tr_b16 a[6:7], v149 offset:53248
v_mfma_f32_16x16x32_bf16 v[168:171], a[40:43], a[152:155], v[168:171]
ds_read_b64_tr_b16 a[8:9], v150 offset:49152
v_mfma_f32_16x16x32_bf16 v[200:203], a[40:43], a[156:159], v[200:203]
buffer_load_dwordx4 a[76:79], v39, s[24:27], s96 offen sc1
v_mfma_f32_16x16x32_bf16 v[204:207], a[44:47], a[156:159], v[204:207]
s_add_u32 s95, s48, 2949120
ds_read_b64_tr_b16 a[10:11], v150 offset:53248
ds_read_b64_tr_b16 a[12:13], v151 offset:49152
v_mfma_f32_16x16x32_bf16 v[172:175], a[44:47], a[152:155], v[172:175]
s_waitcnt lgkmcnt(11)
ds_read_b64_tr_b16 a[14:15], v151 offset:53248
s_add_u32 m0, s82, 65536
v_mfma_f32_16x16x32_bf16 v[176:179], a[48:51], a[152:155], v[176:179]
s_nop 0
ds_read_b64_tr_b16 a[16:17], v154 offset:49152
v_mfma_f32_16x16x32_bf16 v[208:211], a[48:51], a[156:159], v[208:211]
buffer_load_dwordx4 v34, s[16:19], s95 offen lds
v_mfma_f32_16x16x32_bf16 v[212:215], a[52:55], a[156:159], v[212:215]
s_add_u32 m0, s82, 67584
ds_read_b64_tr_b16 a[18:19], v154 offset:53248
ds_read_b64_tr_b16 a[20:21], v155 offset:49152
v_mfma_f32_16x16x32_bf16 v[180:183], a[52:55], a[152:155], v[180:183]
s_waitcnt lgkmcnt(11)
ds_read_b64_tr_b16 a[22:23], v155 offset:53248
v_mfma_f32_16x16x32_bf16 v[184:187], a[56:59], a[152:155], v[184:187]
buffer_load_dwordx4 v35, s[16:19], s95 offen lds
v_mfma_f32_16x16x32_bf16 v[216:219], a[56:59], a[156:159], v[216:219]
s_nop 0
ds_read_b64_tr_b16 a[24:25], v156 offset:49152
ds_read_b64_tr_b16 a[26:27], v156 offset:53248
v_mfma_f32_16x16x32_bf16 v[220:223], a[60:63], a[156:159], v[220:223]
s_waitcnt vmcnt(22) lgkmcnt(10)
ds_read_b64_tr_b16 a[28:29], v157 offset:49152
v_mfma_f32_16x16x32_bf16 v[188:191], a[60:63], a[152:155], v[188:191]
s_barrier
ds_read_b64_tr_b16 a[30:31], v157 offset:53248
v_mfma_f32_16x16x32_bf16 v[160:163], a[0:3], a[160:163], v[160:163]
s_add_u32 s93, s49, 17408
ds_read_b64_tr_b16 a[32:33], v148 offset:57344
v_mfma_f32_16x16x32_bf16 v[192:195], a[0:3], a[164:167], v[192:195]
buffer_load_dwordx4 a[80:83], v38, s[24:27], s93 offen sc1
v_mfma_f32_16x16x32_bf16 v[196:199], a[4:7], a[164:167], v[196:199]
s_nop 0
ds_read_b64_tr_b16 a[34:35], v148 offset:61440
ds_read_b64_tr_b16 a[36:37], v149 offset:57344
v_mfma_f32_16x16x32_bf16 v[164:167], a[4:7], a[160:163], v[164:167]
s_waitcnt lgkmcnt(11)
ds_read_b64_tr_b16 a[38:39], v149 offset:61440
v_mfma_f32_16x16x32_bf16 v[168:171], a[8:11], a[160:163], v[168:171]
ds_read_b64_tr_b16 a[40:41], v150 offset:57344
v_mfma_f32_16x16x32_bf16 v[200:203], a[8:11], a[164:167], v[200:203]
buffer_load_dwordx4 a[84:87], v39, s[24:27], s93 offen sc1
v_mfma_f32_16x16x32_bf16 v[204:207], a[12:15], a[164:167], v[204:207]
s_add_u32 s97, s48, 3407872
ds_read_b64_tr_b16 a[42:43], v150 offset:61440
ds_read_b64_tr_b16 a[44:45], v151 offset:57344
v_mfma_f32_16x16x32_bf16 v[172:175], a[12:15], a[160:163], v[172:175]
s_waitcnt lgkmcnt(11)
ds_read_b64_tr_b16 a[46:47], v151 offset:61440
s_add_u32 m0, s82, 73728
v_mfma_f32_16x16x32_bf16 v[176:179], a[16:19], a[160:163], v[176:179]
s_nop 0
ds_read_b64_tr_b16 a[48:49], v154 offset:57344
v_mfma_f32_16x16x32_bf16 v[208:211], a[16:19], a[164:167], v[208:211]
buffer_load_dwordx4 v34, s[16:19], s97 offen lds
v_mfma_f32_16x16x32_bf16 v[212:215], a[20:23], a[164:167], v[212:215]
s_add_u32 m0, s82, 75776
ds_read_b64_tr_b16 a[50:51], v154 offset:61440
ds_read_b64_tr_b16 a[52:53], v155 offset:57344
v_mfma_f32_16x16x32_bf16 v[180:183], a[20:23], a[160:163], v[180:183]
s_waitcnt lgkmcnt(11)
ds_read_b64_tr_b16 a[54:55], v155 offset:61440
v_mfma_f32_16x16x32_bf16 v[184:187], a[24:27], a[160:163], v[184:187]
buffer_load_dwordx4 v35, s[16:19], s97 offen lds
v_mfma_f32_16x16x32_bf16 v[216:219], a[24:27], a[164:167], v[216:219]
s_nop 0
ds_read_b64_tr_b16 a[56:57], v156 offset:57344
ds_read_b64_tr_b16 a[58:59], v156 offset:61440
v_mfma_f32_16x16x32_bf16 v[220:223], a[28:31], a[164:167], v[220:223]
s_waitcnt vmcnt(22) lgkmcnt(10)
ds_read_b64_tr_b16 a[60:61], v157 offset:57344
v_mfma_f32_16x16x32_bf16 v[188:191], a[28:31], a[160:163], v[188:191]
s_barrier
ds_read_b64_tr_b16 a[62:63], v157 offset:61440
v_mfma_f32_16x16x32_bf16 v[160:163], a[32:35], a[168:171], v[160:163]
s_add_u32 s95, s49, 24576
ds_read_b64_tr_b16 a[0:1], v132 offset:0
v_mfma_f32_16x16x32_bf16 v[192:195], a[32:35], a[172:175], v[192:195]
buffer_load_dwordx4 a[88:91], v38, s[24:27], s95 offen sc1
v_mfma_f32_16x16x32_bf16 v[196:199], a[36:39], a[172:175], v[196:199]
s_nop 0
ds_read_b64_tr_b16 a[2:3], v132 offset:4096
ds_read_b64_tr_b16 a[4:5], v133 offset:0
v_mfma_f32_16x16x32_bf16 v[164:167], a[36:39], a[168:171], v[164:167]
s_waitcnt lgkmcnt(11)
ds_read_b64_tr_b16 a[6:7], v133 offset:4096
v_mfma_f32_16x16x32_bf16 v[168:171], a[40:43], a[168:171], v[168:171]
ds_read_b64_tr_b16 a[8:9], v134 offset:0
v_mfma_f32_16x16x32_bf16 v[200:203], a[40:43], a[172:175], v[200:203]
buffer_load_dwordx4 a[92:95], v39, s[24:27], s95 offen sc1
v_mfma_f32_16x16x32_bf16 v[204:207], a[44:47], a[172:175], v[204:207]
s_add_u32 s94, s70, 0
ds_read_b64_tr_b16 a[10:11], v134 offset:4096
ds_read_b64_tr_b16 a[12:13], v135 offset:0
v_mfma_f32_16x16x32_bf16 v[172:175], a[44:47], a[168:171], v[172:175]
s_waitcnt lgkmcnt(11)
ds_read_b64_tr_b16 a[14:15], v135 offset:4096
s_add_u32 m0, s82, 81920
v_mfma_f32_16x16x32_bf16 v[176:179], a[48:51], a[168:171], v[176:179]
ds_read_b64_tr_b16 a[16:17], v140 offset:0
v_mfma_f32_16x16x32_bf16 v[208:211], a[48:51], a[172:175], v[208:211]
buffer_load_dwordx4 v34, s[20:23], s94 offen lds
v_mfma_f32_16x16x32_bf16 v[212:215], a[52:55], a[172:175], v[212:215]
s_add_u32 m0, s82, 83968
ds_read_b64_tr_b16 a[18:19], v140 offset:4096
ds_read_b64_tr_b16 a[20:21], v141 offset:0
v_mfma_f32_16x16x32_bf16 v[180:183], a[52:55], a[168:171], v[180:183]
s_waitcnt lgkmcnt(11)
ds_read_b64_tr_b16 a[22:23], v141 offset:4096
v_mfma_f32_16x16x32_bf16 v[184:187], a[56:59], a[168:171], v[184:187]
buffer_load_dwordx4 v35, s[20:23], s94 offen lds
v_mfma_f32_16x16x32_bf16 v[216:219], a[56:59], a[172:175], v[216:219]
s_nop 0
ds_read_b64_tr_b16 a[24:25], v142 offset:0
ds_read_b64_tr_b16 a[26:27], v142 offset:4096
v_mfma_f32_16x16x32_bf16 v[220:223], a[60:63], a[172:175], v[220:223]
s_waitcnt vmcnt(22) lgkmcnt(10)
ds_read_b64_tr_b16 a[28:29], v143 offset:0
v_mfma_f32_16x16x32_bf16 v[188:191], a[60:63], a[168:171], v[188:191]
s_barrier
ds_read_b64_tr_b16 a[30:31], v143 offset:4096
v_mfma_f32_16x16x32_bf16 v[160:163], a[0:3], a[176:179], v[160:163]
buffer_load_dword v46, v159, s[24:27], s51 offen sc1
ds_read_b64_tr_b16 a[32:33], v132 offset:8192
v_mfma_f32_16x16x32_bf16 v[192:195], a[0:3], a[180:183], v[192:195]
s_add_u32 s97, s49, 31744
ds_read_b64_tr_b16 a[34:35], v132 offset:12288
v_mfma_f32_16x16x32_bf16 v[196:199], a[4:7], a[180:183], v[196:199]
buffer_load_dwordx4 a[96:99], v38, s[24:27], s97 offen sc1
ds_read_b64_tr_b16 a[36:37], v133 offset:8192
v_mfma_f32_16x16x32_bf16 v[164:167], a[4:7], a[176:179], v[164:167]
s_waitcnt lgkmcnt(11)
ds_read_b64_tr_b16 a[38:39], v133 offset:12288
v_mfma_f32_16x16x32_bf16 v[168:171], a[8:11], a[176:179], v[168:171]
s_nop 0
ds_read_b64_tr_b16 a[40:41], v134 offset:8192
v_mfma_f32_16x16x32_bf16 v[200:203], a[8:11], a[180:183], v[200:203]
buffer_load_dwordx4 a[100:103], v39, s[24:27], s97 offen sc1
ds_read_b64_tr_b16 a[42:43], v134 offset:12288
v_mfma_f32_16x16x32_bf16 v[204:207], a[12:15], a[180:183], v[204:207]
s_add_u32 s96, s70, 65536
ds_read_b64_tr_b16 a[44:45], v135 offset:8192
s_add_u32 m0, s82, 90112
v_mfma_f32_16x16x32_bf16 v[172:175], a[12:15], a[176:179], v[172:175]
s_waitcnt lgkmcnt(11)
ds_read_b64_tr_b16 a[46:47], v135 offset:12288
v_mfma_f32_16x16x32_bf16 v[176:179], a[16:19], a[176:179], v[176:179]
ds_read_b64_tr_b16 a[48:49], v140 offset:8192
v_mfma_f32_16x16x32_bf16 v[208:211], a[16:19], a[180:183], v[208:211]
buffer_load_dwordx4 v34, s[20:23], s96 offen lds
ds_read_b64_tr_b16 a[50:51], v140 offset:12288
v_mfma_f32_16x16x32_bf16 v[212:215], a[20:23], a[180:183], v[212:215]
s_add_u32 m0, s82, 92160
ds_read_b64_tr_b16 a[52:53], v141 offset:8192
v_mfma_f32_16x16x32_bf16 v[180:183], a[20:23], a[176:179], v[180:183]
s_waitcnt lgkmcnt(11)
ds_read_b64_tr_b16 a[54:55], v141 offset:12288
v_mfma_f32_16x16x32_bf16 v[184:187], a[24:27], a[176:179], v[184:187]
buffer_load_dwordx4 v35, s[20:23], s96 offen lds
ds_read_b64_tr_b16 a[56:57], v142 offset:8192
v_mfma_f32_16x16x32_bf16 v[216:219], a[24:27], a[180:183], v[216:219]
ds_read_b64_tr_b16 a[58:59], v142 offset:12288
v_mfma_f32_16x16x32_bf16 v[220:223], a[28:31], a[180:183], v[220:223]
s_waitcnt vmcnt(23) lgkmcnt(10)
ds_read_b64_tr_b16 a[60:61], v143 offset:8192
v_mfma_f32_16x16x32_bf16 v[188:191], a[28:31], a[176:179], v[188:191]
s_barrier
ds_read_b64_tr_b16 a[62:63], v143 offset:12288
v_mfma_f32_16x16x32_bf16 v[160:163], a[32:35], a[184:187], v[160:163]
s_add_u32 s94, s49, 38912
ds_read_b64_tr_b16 a[0:1], v132 offset:16384
v_mfma_f32_16x16x32_bf16 v[192:195], a[32:35], a[188:191], v[192:195]
buffer_load_dwordx4 a[104:107], v38, s[24:27], s94 offen sc1
v_mfma_f32_16x16x32_bf16 v[196:199], a[36:39], a[188:191], v[196:199]
s_nop 0
ds_read_b64_tr_b16 a[2:3], v132 offset:20480
ds_read_b64_tr_b16 a[4:5], v133 offset:16384
v_mfma_f32_16x16x32_bf16 v[164:167], a[36:39], a[184:187], v[164:167]
s_waitcnt lgkmcnt(11)
ds_read_b64_tr_b16 a[6:7], v133 offset:20480
v_mfma_f32_16x16x32_bf16 v[168:171], a[40:43], a[184:187], v[168:171]
ds_read_b64_tr_b16 a[8:9], v134 offset:16384
v_mfma_f32_16x16x32_bf16 v[200:203], a[40:43], a[188:191], v[200:203]
buffer_load_dwordx4 a[108:111], v39, s[24:27], s94 offen sc1
v_mfma_f32_16x16x32_bf16 v[204:207], a[44:47], a[188:191], v[204:207]
s_add_u32 s93, s70, 131072
ds_read_b64_tr_b16 a[10:11], v134 offset:20480
ds_read_b64_tr_b16 a[12:13], v135 offset:16384
v_mfma_f32_16x16x32_bf16 v[172:175], a[44:47], a[184:187], v[172:175]
s_waitcnt lgkmcnt(11)
ds_read_b64_tr_b16 a[14:15], v135 offset:20480
s_add_u32 m0, s82, 98304
v_mfma_f32_16x16x32_bf16 v[176:179], a[48:51], a[184:187], v[176:179]
s_nop 0
ds_read_b64_tr_b16 a[16:17], v140 offset:16384
v_mfma_f32_16x16x32_bf16 v[208:211], a[48:51], a[188:191], v[208:211]
buffer_load_dwordx4 v34, s[20:23], s93 offen lds
v_mfma_f32_16x16x32_bf16 v[212:215], a[52:55], a[188:191], v[212:215]
s_add_u32 m0, s82, 100352
ds_read_b64_tr_b16 a[18:19], v140 offset:20480
ds_read_b64_tr_b16 a[20:21], v141 offset:16384
v_mfma_f32_16x16x32_bf16 v[180:183], a[52:55], a[184:187], v[180:183]
s_waitcnt lgkmcnt(11)
ds_read_b64_tr_b16 a[22:23], v141 offset:20480
v_mfma_f32_16x16x32_bf16 v[184:187], a[56:59], a[184:187], v[184:187]
buffer_load_dwordx4 v35, s[20:23], s93 offen lds
v_mfma_f32_16x16x32_bf16 v[216:219], a[56:59], a[188:191], v[216:219]
s_nop 0
ds_read_b64_tr_b16 a[24:25], v142 offset:16384
ds_read_b64_tr_b16 a[26:27], v142 offset:20480
v_mfma_f32_16x16x32_bf16 v[220:223], a[60:63], a[188:191], v[220:223]
s_waitcnt vmcnt(23) lgkmcnt(10)
ds_read_b64_tr_b16 a[28:29], v143 offset:16384
v_mfma_f32_16x16x32_bf16 v[188:191], a[60:63], a[184:187], v[188:191]
s_barrier
ds_read_b64_tr_b16 a[30:31], v143 offset:20480
Lv48:
v_mfma_f32_16x16x32_bf16 v[160:163], a[0:3], a[64:67], v[160:163]
s_add_u32 s96, s49, 46080
ds_read_b64_tr_b16 a[32:33], v132 offset:24576
s_waitcnt vmcnt(8)
v_cmp_gt_u32 vcc, s64, v46
s_nop 3
s_cbranch_vccz Lret6
s_mov_b32 s47, 0
Lslow6_l:
s_sleep 8
buffer_load_dword v46, v159, s[24:27], s51 offen sc1
s_add_u32 s47, s47, 1
s_waitcnt vmcnt(0)
v_cmp_gt_u32 vcc, s64, v46
s_cmp_gt_u32 s47, 0x40000
s_cbranch_scc1 Lret6
s_nop 3
s_cbranch_vccnz Lslow6_l
Lret6:
v_mfma_f32_16x16x32_bf16 v[192:195], a[0:3], a[68:71], v[192:195]
buffer_load_dwordx4 a[112:115], v38, s[24:27], s96 offen sc1
ds_read_b64_tr_b16 a[34:35], v132 offset:28672
v_mfma_f32_16x16x32_bf16 v[196:199], a[4:7], a[68:71], v[196:199]
ds_read_b64_tr_b16 a[36:37], v133 offset:24576
v_mfma_f32_16x16x32_bf16 v[164:167], a[4:7], a[64:67], v[164:167]
s_waitcnt lgkmcnt(11)
ds_read_b64_tr_b16 a[38:39], v133 offset:28672
v_mfma_f32_16x16x32_bf16 v[168:171], a[8:11], a[64:67], v[168:171]
s_nop 0
ds_read_b64_tr_b16 a[40:41], v134 offset:24576
v_mfma_f32_16x16x32_bf16 v[200:203], a[8:11], a[68:71], v[200:203]
buffer_load_dwordx4 a[116:119], v39, s[24:27], s96 offen sc1
ds_read_b64_tr_b16 a[42:43], v134 offset:28672
v_mfma_f32_16x16x32_bf16 v[204:207], a[12:15], a[68:71], v[204:207]
s_add_u32 s95, s70, 196608
ds_read_b64_tr_b16 a[44:45], v135 offset:24576
s_add_u32 m0, s82, 106496
v_mfma_f32_16x16x32_bf16 v[172:175], a[12:15], a[64:67], v[172:175]
s_waitcnt lgkmcnt(11)
ds_read_b64_tr_b16 a[46:47], v135 offset:28672
v_mfma_f32_16x16x32_bf16 v[176:179], a[16:19], a[64:67], v[176:179]
ds_read_b64_tr_b16 a[48:49], v140 offset:24576
v_mfma_f32_16x16x32_bf16 v[208:211], a[16:19], a[68:71], v[208:211]
buffer_load_dwordx4 v34, s[20:23], s95 offen lds
ds_read_b64_tr_b16 a[50:51], v140 offset:28672
v_mfma_f32_16x16x32_bf16 v[212:215], a[20:23], a[68:71], v[212:215]
s_add_u32 m0, s82, 108544
ds_read_b64_tr_b16 a[52:53], v141 offset:24576
v_mfma_f32_16x16x32_bf16 v[180:183], a[20:23], a[64:67], v[180:183]
s_waitcnt lgkmcnt(11)
ds_read_b64_tr_b16 a[54:55], v141 offset:28672
v_mfma_f32_16x16x32_bf16 v[184:187], a[24:27], a[64:67], v[184:187]
buffer_load_dwordx4 v35, s[20:23], s95 offen lds
ds_read_b64_tr_b16 a[56:57], v142 offset:24576
v_mfma_f32_16x16x32_bf16 v[216:219], a[24:27], a[68:71], v[216:219]
ds_read_b64_tr_b16 a[58:59], v142 offset:28672
v_mfma_f32_16x16x32_bf16 v[220:223], a[28:31], a[68:71], v[220:223]
s_waitcnt lgkmcnt(10)
ds_read_b64_tr_b16 a[60:61], v143 offset:24576
v_mfma_f32_16x16x32_bf16 v[188:191], a[28:31], a[64:67], v[188:191]
s_barrier
ds_read_b64_tr_b16 a[62:63], v143 offset:28672
v_mfma_f32_16x16x32_bf16 v[160:163], a[32:35], a[72:75], v[160:163]
s_add_u32 s93, s49, 53248
ds_read_b64_tr_b16 a[0:1], v132 offset:32768
v_mfma_f32_16x16x32_bf16 v[192:195], a[32:35], a[76:79], v[192:195]
buffer_load_dwordx4 a[120:123], v38, s[24:27], s93 offen sc1
v_mfma_f32_16x16x32_bf16 v[196:199], a[36:39], a[76:79], v[196:199]
s_nop 0
ds_read_b64_tr_b16 a[2:3], v132 offset:36864
ds_read_b64_tr_b16 a[4:5], v133 offset:32768
v_mfma_f32_16x16x32_bf16 v[164:167], a[36:39], a[72:75], v[164:167]
s_waitcnt lgkmcnt(11)
ds_read_b64_tr_b16 a[6:7], v133 offset:36864
v_mfma_f32_16x16x32_bf16 v[168:171], a[40:43], a[72:75], v[168:171]
ds_read_b64_tr_b16 a[8:9], v134 offset:32768
v_mfma_f32_16x16x32_bf16 v[200:203], a[40:43], a[76:79], v[200:203]
buffer_load_dwordx4 a[124:127], v39, s[24:27], s93 offen sc1
v_mfma_f32_16x16x32_bf16 v[204:207], a[44:47], a[76:79], v[204:207]
s_add_u32 s97, s70, 262144
ds_read_b64_tr_b16 a[10:11], v134 offset:36864
ds_read_b64_tr_b16 a[12:13], v135 offset:32768
v_mfma_f32_16x16x32_bf16 v[172:175], a[44:47], a[72:75], v[172:175]
s_waitcnt lgkmcnt(11)
ds_read_b64_tr_b16 a[14:15], v135 offset:36864
s_add_u32 m0, s82, 114688
v_mfma_f32_16x16x32_bf16 v[176:179], a[48:51], a[72:75], v[176:179]
s_nop 0
ds_read_b64_tr_b16 a[16:17], v140 offset:32768
v_mfma_f32_16x16x32_bf16 v[208:211], a[48:51], a[76:79], v[208:211]
buffer_load_dwordx4 v34, s[20:23], s97 offen lds
v_mfma_f32_16x16x32_bf16 v[212:215], a[52:55], a[76:79], v[212:215]
s_add_u32 m0, s82, 116736
ds_read_b64_tr_b16 a[18:19], v140 offset:36864
ds_read_b64_tr_b16 a[20:21], v141 offset:32768
v_mfma_f32_16x16x32_bf16 v[180:183], a[52:55], a[72:75], v[180:183]
s_waitcnt lgkmcnt(11)
ds_read_b64_tr_b16 a[22:23], v141 offset:36864
v_mfma_f32_16x16x32_bf16 v[184:187], a[56:59], a[72:75], v[184:187]
buffer_load_dwordx4 v35, s[20:23], s97 offen lds
v_mfma_f32_16x16x32_bf16 v[216:219], a[56:59], a[76:79], v[216:219]
s_nop 0
ds_read_b64_tr_b16 a[24:25], v142 offset:32768
ds_read_b64_tr_b16 a[26:27], v142 offset:36864
v_mfma_f32_16x16x32_bf16 v[220:223], a[60:63], a[76:79], v[220:223]
s_waitcnt lgkmcnt(10)
ds_read_b64_tr_b16 a[28:29], v143 offset:32768
v_mfma_f32_16x16x32_bf16 v[188:191], a[60:63], a[72:75], v[188:191]
s_barrier
ds_read_b64_tr_b16 a[30:31], v143 offset:36864
v_mfma_f32_16x16x32_bf16 v[160:163], a[0:3], a[80:83], v[160:163]
s_add_u32 s95, s71, 0
ds_read_b64_tr_b16 a[32:33], v132 offset:40960
v_mfma_f32_16x16x32_bf16 v[192:195], a[0:3], a[84:87], v[192:195]
buffer_load_dwordx4 a[128:131], v38, s[24:27], s95 offen sc1
v_mfma_f32_16x16x32_bf16 v[196:199], a[4:7], a[84:87], v[196:199]
s_nop 0
ds_read_b64_tr_b16 a[34:35], v132 offset:45056
ds_read_b64_tr_b16 a[36:37], v133 offset:40960
v_mfma_f32_16x16x32_bf16 v[164:167], a[4:7], a[80:83], v[164:167]
s_waitcnt lgkmcnt(11)
ds_read_b64_tr_b16 a[38:39], v133 offset:45056
v_mfma_f32_16x16x32_bf16 v[168:171], a[8:11], a[80:83], v[168:171]
s_nop 0
ds_read_b64_tr_b16 a[40:41], v134 offset:40960
v_mfma_f32_16x16x32_bf16 v[200:203], a[8:11], a[84:87], v[200:203]
buffer_load_dwordx4 a[132:135], v39, s[24:27], s95 offen sc1
v_mfma_f32_16x16x32_bf16 v[204:207], a[12:15], a[84:87], v[204:207]
s_add_u32 s94, s70, 327680
ds_read_b64_tr_b16 a[42:43], v134 offset:45056
ds_read_b64_tr_b16 a[44:45], v135 offset:40960
v_mfma_f32_16x16x32_bf16 v[172:175], a[12:15], a[80:83], v[172:175]
s_waitcnt lgkmcnt(11)
ds_read_b64_tr_b16 a[46:47], v135 offset:45056
s_add_u32 m0, s82, 122880
v_mfma_f32_16x16x32_bf16 v[176:179], a[16:19], a[80:83], v[176:179]
s_nop 0
ds_read_b64_tr_b16 a[48:49], v140 offset:40960
v_mfma_f32_16x16x32_bf16 v[208:211], a[16:19], a[84:87], v[208:211]
buffer_load_dwordx4 v34, s[20:23], s94 offen lds
v_mfma_f32_16x16x32_bf16 v[212:215], a[20:23], a[84:87], v[212:215]
s_add_u32 m0, s82, 124928
ds_read_b64_tr_b16 a[50:51], v140 offset:45056
ds_read_b64_tr_b16 a[52:53], v141 offset:40960
v_mfma_f32_16x16x32_bf16 v[180:183], a[20:23], a[80:83], v[180:183]
s_waitcnt lgkmcnt(11)
ds_read_b64_tr_b16 a[54:55], v141 offset:45056
v_mfma_f32_16x16x32_bf16 v[184:187], a[24:27], a[80:83], v[184:187]
buffer_load_dwordx4 v35, s[20:23], s94 offen lds
v_mfma_f32_16x16x32_bf16 v[216:219], a[24:27], a[84:87], v[216:219]
s_nop 0
ds_read_b64_tr_b16 a[56:57], v142 offset:40960
ds_read_b64_tr_b16 a[58:59], v142 offset:45056
v_mfma_f32_16x16x32_bf16 v[220:223], a[28:31], a[84:87], v[220:223]
s_waitcnt lgkmcnt(10)
ds_read_b64_tr_b16 a[60:61], v143 offset:40960
v_mfma_f32_16x16x32_bf16 v[188:191], a[28:31], a[80:83], v[188:191]
s_barrier
ds_read_b64_tr_b16 a[62:63], v143 offset:45056
v_mfma_f32_16x16x32_bf16 v[160:163], a[32:35], a[88:91], v[160:163]
s_add_u32 s97, s71, 1024
ds_read_b64_tr_b16 a[0:1], v132 offset:49152
v_mfma_f32_16x16x32_bf16 v[192:195], a[32:35], a[92:95], v[192:195]
buffer_load_dwordx4 a[136:139], v38, s[24:27], s97 offen sc1
v_mfma_f32_16x16x32_bf16 v[196:199], a[36:39], a[92:95], v[196:199]
s_nop 0
ds_read_b64_tr_b16 a[2:3], v132 offset:53248
ds_read_b64_tr_b16 a[4:5], v133 offset:49152
v_mfma_f32_16x16x32_bf16 v[164:167], a[36:39], a[88:91], v[164:167]
s_waitcnt lgkmcnt(11)
ds_read_b64_tr_b16 a[6:7], v133 offset:53248
v_mfma_f32_16x16x32_bf16 v[168:171], a[40:43], a[88:91], v[168:171]
ds_read_b64_tr_b16 a[8:9], v134 offset:49152
v_mfma_f32_16x16x32_bf16 v[200:203], a[40:43], a[92:95], v[200:203]
buffer_load_dwordx4 a[140:143], v39, s[24:27], s97 offen sc1
v_mfma_f32_16x16x32_bf16 v[204:207], a[44:47], a[92:95], v[204:207]
s_add_u32 s96, s70, 393216
ds_read_b64_tr_b16 a[10:11], v134 offset:53248
Lpad14:
s_cbranch_execz Lpadback1
s_nop 0
ds_read_b64_tr_b16 a[12:13], v135 offset:49152
v_mfma_f32_16x16x32_bf16 v[172:175], a[44:47], a[88:91], v[172:175]
s_waitcnt lgkmcnt(11)
ds_read_b64_tr_b16 a[14:15], v135 offset:53248
s_add_u32 m0, s82, 0
v_mfma_f32_16x16x32_bf16 v[176:179], a[48:51], a[88:91], v[176:179]
ds_read_b64_tr_b16 a[16:17], v140 offset:49152
v_mfma_f32_16x16x32_bf16 v[208:211], a[48:51], a[92:95], v[208:211]
buffer_load_dwordx4 v34, s[20:23], s96 offen lds
v_mfma_f32_16x16x32_bf16 v[212:215], a[52:55], a[92:95], v[212:215]
s_add_u32 m0, s82, 2048
ds_read_b64_tr_b16 a[18:19], v140 offset:53248
ds_read_b64_tr_b16 a[20:21], v141 offset:49152
v_mfma_f32_16x16x32_bf16 v[180:183], a[52:55], a[88:91], v[180:183]
s_waitcnt lgkmcnt(11)
ds_read_b64_tr_b16 a[22:23], v141 offset:53248
v_mfma_f32_16x16x32_bf16 v[184:187], a[56:59], a[88:91], v[184:187]
buffer_load_dwordx4 v35, s[20:23], s96 offen lds
v_mfma_f32_16x16x32_bf16 v[216:219], a[56:59], a[92:95], v[216:219]
s_nop 0
ds_read_b64_tr_b16 a[24:25], v142 offset:49152
ds_read_b64_tr_b16 a[26:27], v142 offset:53248
v_mfma_f32_16x16x32_bf16 v[220:223], a[60:63], a[92:95], v[220:223]
s_waitcnt vmcnt(22) lgkmcnt(10)
ds_read_b64_tr_b16 a[28:29], v143 offset:49152
v_mfma_f32_16x16x32_bf16 v[188:191], a[60:63], a[88:91], v[188:191]
s_barrier
ds_read_b64_tr_b16 a[30:31], v143 offset:53248
v_mfma_f32_16x16x32_bf16 v[160:163], a[0:3], a[96:99], v[160:163]
s_add_u32 s94, s71, 2048
ds_read_b64_tr_b16 a[32:33], v132 offset:57344
v_mfma_f32_16x16x32_bf16 v[192:195], a[0:3], a[100:103], v[192:195]
buffer_load_dwordx4 a[144:147], v38, s[24:27], s94 offen sc1
v_mfma_f32_16x16x32_bf16 v[196:199], a[4:7], a[100:103], v[196:199]
s_nop 0
ds_read_b64_tr_b16 a[34:35], v132 offset:61440
ds_read_b64_tr_b16 a[36:37], v133 offset:57344
v_mfma_f32_16x16x32_bf16 v[164:167], a[4:7], a[96:99], v[164:167]
s_waitcnt lgkmcnt(11)
ds_read_b64_tr_b16 a[38:39], v133 offset:61440
v_mfma_f32_16x16x32_bf16 v[168:171], a[8:11], a[96:99], v[168:171]
ds_read_b64_tr_b16 a[40:41], v134 offset:57344
v_mfma_f32_16x16x32_bf16 v[200:203], a[8:11], a[100:103], v[200:203]
buffer_load_dwordx4 a[148:151], v39, s[24:27], s94 offen sc1
v_mfma_f32_16x16x32_bf16 v[204:207], a[12:15], a[100:103], v[204:207]
s_add_u32 s93, s70, 458752
ds_read_b64_tr_b16 a[42:43], v134 offset:61440
ds_read_b64_tr_b16 a[44:45], v135 offset:57344
v_mfma_f32_16x16x32_bf16 v[172:175], a[12:15], a[96:99], v[172:175]
s_waitcnt lgkmcnt(11)
ds_read_b64_tr_b16 a[46:47], v135 offset:61440
s_add_u32 m0, s82, 8192
v_mfma_f32_16x16x32_bf16 v[176:179], a[16:19], a[96:99], v[176:179]
s_nop 0
ds_read_b64_tr_b16 a[48:49], v140 offset:57344
v_mfma_f32_16x16x32_bf16 v[208:211], a[16:19], a[100:103], v[208:211]
buffer_load_dwordx4 v34, s[20:23], s93 offen lds
v_mfma_f32_16x16x32_bf16 v[212:215], a[20:23], a[100:103], v[212:215]
s_add_u32 m0, s82, 10240
ds_read_b64_tr_b16 a[50:51], v140 offset:61440
ds_read_b64_tr_b16 a[52:53], v141 offset:57344
v_mfma_f32_16x16x32_bf16 v[180:183], a[20:23], a[96:99], v[180:183]
s_waitcnt lgkmcnt(11)
ds_read_b64_tr_b16 a[54:55], v141 offset:61440
v_mfma_f32_16x16x32_bf16 v[184:187], a[24:27], a[96:99], v[184:187]
buffer_load_dwordx4 v35, s[20:23], s93 offen lds
v_mfma_f32_16x16x32_bf16 v[216:219], a[24:27], a[100:103], v[216:219]
s_nop 0
ds_read_b64_tr_b16 a[56:57], v142 offset:57344
ds_read_b64_tr_b16 a[58:59], v142 offset:61440
v_mfma_f32_16x16x32_bf16 v[220:223], a[28:31], a[100:103], v[220:223]
s_waitcnt vmcnt(22) lgkmcnt(10)
ds_read_b64_tr_b16 a[60:61], v143 offset:57344
v_mfma_f32_16x16x32_bf16 v[188:191], a[28:31], a[96:99], v[188:191]
s_barrier
ds_read_b64_tr_b16 a[62:63], v143 offset:61440
v_mfma_f32_16x16x32_bf16 v[160:163], a[32:35], a[104:107], v[160:163]
s_add_u32 s96, s71, 3072
ds_read_b64_tr_b16 a[0:1], v148 offset:0
v_mfma_f32_16x16x32_bf16 v[192:195], a[32:35], a[108:111], v[192:195]
buffer_load_dwordx4 a[152:155], v38, s[24:27], s96 offen sc1
v_mfma_f32_16x16x32_bf16 v[196:199], a[36:39], a[108:111], v[196:199]
s_nop 0
ds_read_b64_tr_b16 a[2:3], v148 offset:4096
ds_read_b64_tr_b16 a[4:5], v149 offset:0
v_mfma_f32_16x16x32_bf16 v[164:167], a[36:39], a[104:107], v[164:167]
s_waitcnt lgkmcnt(11)
ds_read_b64_tr_b16 a[6:7], v149 offset:4096
v_mfma_f32_16x16x32_bf16 v[168:171], a[40:43], a[104:107], v[168:171]
ds_read_b64_tr_b16 a[8:9], v150 offset:0
v_mfma_f32_16x16x32_bf16 v[200:203], a[40:43], a[108:111], v[200:203]
buffer_load_dwordx4 a[156:159], v39, s[24:27], s96 offen sc1
v_mfma_f32_16x16x32_bf16 v[204:207], a[44:47], a[108:111], v[204:207]
s_add_u32 s95, s70, 524288
ds_read_b64_tr_b16 a[10:11], v150 offset:4096
ds_read_b64_tr_b16 a[12:13], v151 offset:0
v_mfma_f32_16x16x32_bf16 v[172:175], a[44:47], a[104:107], v[172:175]
s_waitcnt lgkmcnt(11)
ds_read_b64_tr_b16 a[14:15], v151 offset:4096
s_add_u32 m0, s82, 16384
v_mfma_f32_16x16x32_bf16 v[176:179], a[48:51], a[104:107], v[176:179]
s_nop 0
ds_read_b64_tr_b16 a[16:17], v154 offset:0
v_mfma_f32_16x16x32_bf16 v[208:211], a[48:51], a[108:111], v[208:211]
buffer_load_dwordx4 v34, s[20:23], s95 offen lds
v_mfma_f32_16x16x32_bf16 v[212:215], a[52:55], a[108:111], v[212:215]
s_add_u32 m0, s82, 18432
ds_read_b64_tr_b16 a[18:19], v154 offset:4096
ds_read_b64_tr_b16 a[20:21], v155 offset:0
v_mfma_f32_16x16x32_bf16 v[180:183], a[52:55], a[104:107], v[180:183]
s_waitcnt lgkmcnt(11)
ds_read_b64_tr_b16 a[22:23], v155 offset:4096
v_mfma_f32_16x16x32_bf16 v[184:187], a[56:59], a[104:107], v[184:187]
buffer_load_dwordx4 v35, s[20:23], s95 offen lds
v_mfma_f32_16x16x32_bf16 v[216:219], a[56:59], a[108:111], v[216:219]
s_nop 0
ds_read_b64_tr_b16 a[24:25], v156 offset:0
ds_read_b64_tr_b16 a[26:27], v156 offset:4096
v_mfma_f32_16x16x32_bf16 v[220:223], a[60:63], a[108:111], v[220:223]
s_waitcnt vmcnt(22) lgkmcnt(10)
ds_read_b64_tr_b16 a[28:29], v157 offset:0
v_mfma_f32_16x16x32_bf16 v[188:191], a[60:63], a[104:107], v[188:191]
s_barrier
ds_read_b64_tr_b16 a[30:31], v157 offset:4096
v_mfma_f32_16x16x32_bf16 v[160:163], a[0:3], a[112:115], v[160:163]
s_add_u32 s93, s71, 4096
ds_read_b64_tr_b16 a[32:33], v148 offset:8192
v_mfma_f32_16x16x32_bf16 v[192:195], a[0:3], a[116:119], v[192:195]
buffer_load_dwordx4 a[160:163], v38, s[24:27], s93 offen sc1
v_mfma_f32_16x16x32_bf16 v[196:199], a[4:7], a[116:119], v[196:199]
s_nop 0
ds_read_b64_tr_b16 a[34:35], v148 offset:12288
ds_read_b64_tr_b16 a[36:37], v149 offset:8192
v_mfma_f32_16x16x32_bf16 v[164:167], a[4:7], a[112:115], v[164:167]
s_waitcnt lgkmcnt(11)
ds_read_b64_tr_b16 a[38:39], v149 offset:12288
v_mfma_f32_16x16x32_bf16 v[168:171], a[8:11], a[112:115], v[168:171]
ds_read_b64_tr_b16 a[40:41], v150 offset:8192
v_mfma_f32_16x16x32_bf16 v[200:203], a[8:11], a[116:119], v[200:203]
buffer_load_dwordx4 a[164:167], v39, s[24:27], s93 offen sc1
v_mfma_f32_16x16x32_bf16 v[204:207], a[12:15], a[116:119], v[204:207]
s_add_u32 s97, s70, 589824
ds_read_b64_tr_b16 a[42:43], v150 offset:12288
ds_read_b64_tr_b16 a[44:45], v151 offset:8192
v_mfma_f32_16x16x32_bf16 v[172:175], a[12:15], a[112:115], v[172:175]
s_waitcnt lgkmcnt(11)
ds_read_b64_tr_b16 a[46:47], v151 offset:12288
s_add_u32 m0, s82, 24576
v_mfma_f32_16x16x32_bf16 v[176:179], a[16:19], a[112:115], v[176:179]
s_nop 0
ds_read_b64_tr_b16 a[48:49], v154 offset:8192
v_mfma_f32_16x16x32_bf16 v[208:211], a[16:19], a[116:119], v[208:211]
buffer_load_dwordx4 v34, s[20:23], s97 offen lds
v_mfma_f32_16x16x32_bf16 v[212:215], a[20:23], a[116:119], v[212:215]
s_add_u32 m0, s82, 26624
ds_read_b64_tr_b16 a[50:51], v154 offset:12288
ds_read_b64_tr_b16 a[52:53], v155 offset:8192
v_mfma_f32_16x16x32_bf16 v[180:183], a[20:23], a[112:115], v[180:183]
s_waitcnt lgkmcnt(11)
ds_read_b64_tr_b16 a[54:55], v155 offset:12288
v_mfma_f32_16x16x32_bf16 v[184:187], a[24:27], a[112:115], v[184:187]
buffer_load_dwordx4 v35, s[20:23], s97 offen lds
v_mfma_f32_16x16x32_bf16 v[216:219], a[24:27], a[116:119], v[216:219]
s_nop 0
ds_read_b64_tr_b16 a[56:57], v156 offset:8192
ds_read_b64_tr_b16 a[58:59], v156 offset:12288
v_mfma_f32_16x16x32_bf16 v[220:223], a[28:31], a[116:119], v[220:223]
s_waitcnt vmcnt(22) lgkmcnt(10)
ds_read_b64_tr_b16 a[60:61], v157 offset:8192
v_mfma_f32_16x16x32_bf16 v[188:191], a[28:31], a[112:115], v[188:191]
s_barrier
ds_read_b64_tr_b16 a[62:63], v157 offset:12288
v_mfma_f32_16x16x32_bf16 v[160:163], a[32:35], a[120:123], v[160:163]
s_add_u32 s95, s71, 5120
ds_read_b64_tr_b16 a[0:1], v148 offset:16384
v_mfma_f32_16x16x32_bf16 v[192:195], a[32:35], a[124:127], v[192:195]
buffer_load_dwordx4 a[168:171], v38, s[24:27], s95 offen sc1
v_mfma_f32_16x16x32_bf16 v[196:199], a[36:39], a[124:127], v[196:199]
s_nop 0
ds_read_b64_tr_b16 a[2:3], v148 offset:20480
ds_read_b64_tr_b16 a[4:5], v149 offset:16384
v_mfma_f32_16x16x32_bf16 v[164:167], a[36:39], a[120:123], v[164:167]
s_waitcnt lgkmcnt(11)
ds_read_b64_tr_b16 a[6:7], v149 offset:20480
v_mfma_f32_16x16x32_bf16 v[168:171], a[40:43], a[120:123], v[168:171]
ds_read_b64_tr_b16 a[8:9], v150 offset:16384
v_mfma_f32_16x16x32_bf16 v[200:203], a[40:43], a[124:127], v[200:203]
buffer_load_dwordx4 a[172:175], v39, s[24:27], s95 offen sc1
v_mfma_f32_16x16x32_bf16 v[204:207], a[44:47], a[124:127], v[204:207]
s_add_u32 s94, s70, 655360
ds_read_b64_tr_b16 a[10:11], v150 offset:20480
ds_read_b64_tr_b16 a[12:13], v151 offset:16384
v_mfma_f32_16x16x32_bf16 v[172:175], a[44:47], a[120:123], v[172:175]
s_waitcnt lgkmcnt(11)
ds_read_b64_tr_b16 a[14:15], v151 offset:20480
s_add_u32 m0, s82, 32768
v_mfma_f32_16x16x32_bf16 v[176:179], a[48:51], a[120:123], v[176:179]
s_nop 0
ds_read_b64_tr_b16 a[16:17], v154 offset:16384
v_mfma_f32_16x16x32_bf16 v[208:211], a[48:51], a[124:127], v[208:211]
buffer_load_dwordx4 v34, s[20:23], s94 offen lds
v_mfma_f32_16x16x32_bf16 v[212:215], a[52:55], a[124:127], v[212:215]
s_add_u32 m0, s82, 34816
ds_read_b64_tr_b16 a[18:19], v154 offset:20480
ds_read_b64_tr_b16 a[20:21], v155 offset:16384
v_mfma_f32_16x16x32_bf16 v[180:183], a[52:55], a[120:123], v[180:183]
s_waitcnt lgkmcnt(11)
ds_read_b64_tr_b16 a[22:23], v155 offset:20480
v_mfma_f32_16x16x32_bf16 v[184:187], a[56:59], a[120:123], v[184:187]
buffer_load_dwordx4 v35, s[20:23], s94 offen lds
v_mfma_f32_16x16x32_bf16 v[216:219], a[56:59], a[124:127], v[216:219]
s_nop 0
ds_read_b64_tr_b16 a[24:25], v156 offset:16384
ds_read_b64_tr_b16 a[26:27], v156 offset:20480
v_mfma_f32_16x16x32_bf16 v[220:223], a[60:63], a[124:127], v[220:223]
s_waitcnt vmcnt(22) lgkmcnt(10)
ds_read_b64_tr_b16 a[28:29], v157 offset:16384
v_mfma_f32_16x16x32_bf16 v[188:191], a[60:63], a[120:123], v[188:191]
s_barrier
ds_read_b64_tr_b16 a[30:31], v157 offset:20480
v_mov_b32 v2, v22
v_mov_b32 v3, v22
v_mov_b32 v4, v23
v_mov_b32 v5, v23
v_pk_mul_f32 v[160:161], v[160:161], v[2:3]
v_pk_mul_f32 v[162:163], v[162:163], v[2:3]
v_pk_mul_f32 v[192:193], v[192:193], v[4:5]
v_pk_mul_f32 v[194:195], v[194:195], v[4:5]
v_pk_mul_f32 v[164:165], v[164:165], v[2:3]
v_pk_mul_f32 v[166:167], v[166:167], v[2:3]
v_pk_mul_f32 v[196:197], v[196:197], v[4:5]
v_pk_mul_f32 v[198:199], v[198:199], v[4:5]
v_pk_mul_f32 v[168:169], v[168:169], v[2:3]
v_pk_mul_f32 v[170:171], v[170:171], v[2:3]
v_pk_mul_f32 v[200:201], v[200:201], v[4:5]
v_pk_mul_f32 v[202:203], v[202:203], v[4:5]
v_pk_mul_f32 v[172:173], v[172:173], v[2:3]
v_pk_mul_f32 v[174:175], v[174:175], v[2:3]
v_pk_mul_f32 v[204:205], v[204:205], v[4:5]
v_pk_mul_f32 v[206:207], v[206:207], v[4:5]
v_pk_mul_f32 v[176:177], v[176:177], v[2:3]
v_pk_mul_f32 v[178:179], v[178:179], v[2:3]
v_pk_mul_f32 v[208:209], v[208:209], v[4:5]
v_pk_mul_f32 v[210:211], v[210:211], v[4:5]
v_pk_mul_f32 v[180:181], v[180:181], v[2:3]
v_pk_mul_f32 v[182:183], v[182:183], v[2:3]
v_pk_mul_f32 v[212:213], v[212:213], v[4:5]
v_pk_mul_f32 v[214:215], v[214:215], v[4:5]
v_pk_mul_f32 v[184:185], v[184:185], v[2:3]
v_pk_mul_f32 v[186:187], v[186:187], v[2:3]
v_pk_mul_f32 v[216:217], v[216:217], v[4:5]
v_pk_mul_f32 v[218:219], v[218:219], v[4:5]
v_pk_mul_f32 v[188:189], v[188:189], v[2:3]
v_pk_mul_f32 v[190:191], v[190:191], v[2:3]
v_pk_mul_f32 v[220:221], v[220:221], v[4:5]
v_pk_mul_f32 v[222:223], v[222:223], v[4:5]
s_nop 1
Lv56:
v_mfma_f32_16x16x32_bf16 v[160:163], a[0:3], a[128:131], v[160:163]
s_add_u32 s97, s71, 6144
ds_read_b64_tr_b16 a[32:33], v148 offset:24576
v_mfma_f32_16x16x32_bf16 v[192:195], a[0:3], a[132:135], v[192:195]
buffer_load_dwordx4 a[176:179], v38, s[24:27], s97 offen sc1
v_mfma_f32_16x16x32_bf16 v[196:199], a[4:7], a[132:135], v[196:199]
s_nop 0
ds_read_b64_tr_b16 a[34:35], v148 offset:28672
ds_read_b64_tr_b16 a[36:37], v149 offset:24576
v_mfma_f32_16x16x32_bf16 v[164:167], a[4:7], a[128:131], v[164:167]
s_waitcnt lgkmcnt(11)
ds_read_b64_tr_b16 a[38:39], v149 offset:28672
v_mfma_f32_16x16x32_bf16 v[168:171], a[8:11], a[128:131], v[168:171]
s_nop 0
ds_read_b64_tr_b16 a[40:41], v150 offset:24576
v_mfma_f32_16x16x32_bf16 v[200:203], a[8:11], a[132:135], v[200:203]
buffer_load_dwordx4 a[180:183], v39, s[24:27], s97 offen sc1
v_mfma_f32_16x16x32_bf16 v[204:207], a[12:15], a[132:135], v[204:207]
s_add_u32 s96, s70, 720896
ds_read_b64_tr_b16 a[42:43], v150 offset:28672
ds_read_b64_tr_b16 a[44:45], v151 offset:24576
v_mfma_f32_16x16x32_bf16 v[172:175], a[12:15], a[128:131], v[172:175]
s_waitcnt lgkmcnt(11)
ds_read_b64_tr_b16 a[46:47], v151 offset:28672
s_add_u32 m0, s82, 40960
v_mfma_f32_16x16x32_bf16 v[176:179], a[16:19], a[128:131], v[176:179]
s_nop 0
ds_read_b64_tr_b16 a[48:49], v154 offset:24576
v_mfma_f32_16x16x32_bf16 v[208:211], a[16:19], a[132:135], v[208:211]
buffer_load_dwordx4 v34, s[20:23], s96 offen lds
v_mfma_f32_16x16x32_bf16 v[212:215], a[20:23], a[132:135], v[212:215]
s_add_u32 m0, s82, 43008
ds_read_b64_tr_b16 a[50:51], v154 offset:28672
ds_read_b64_tr_b16 a[52:53], v155 offset:24576
v_mfma_f32_16x16x32_bf16 v[180:183], a[20:23], a[128:131], v[180:183]
s_waitcnt lgkmcnt(11)
ds_read_b64_tr_b16 a[54:55], v155 offset:28672
v_mfma_f32_16x16x32_bf16 v[184:187], a[24:27], a[128:131], v[184:187]
buffer_load_dwordx4 v35, s[20:23], s96 offen lds
v_mfma_f32_16x16x32_bf16 v[216:219], a[24:27], a[132:135], v[216:219]
s_nop 0
ds_read_b64_tr_b16 a[56:57], v156 offset:24576
ds_read_b64_tr_b16 a[58:59], v156 offset:28672
v_mfma_f32_16x16x32_bf16 v[220:223], a[28:31], a[132:135], v[220:223]
s_waitcnt vmcnt(22) lgkmcnt(10)
ds_read_b64_tr_b16 a[60:61], v157 offset:24576
v_mfma_f32_16x16x32_bf16 v[188:191], a[28:31], a[128:131], v[188:191]
s_barrier
ds_read_b64_tr_b16 a[62:63], v157 offset:28672
v_mfma_f32_16x16x32_bf16 v[160:163], a[32:35], a[136:139], v[160:163]
s_add_u32 s94, s71, 7168
ds_read_b64_tr_b16 a[0:1], v148 offset:32768
v_mfma_f32_16x16x32_bf16 v[192:195], a[32:35], a[140:143], v[192:195]
buffer_load_dwordx4 a[184:187], v38, s[24:27], s94 offen sc1
v_mfma_f32_16x16x32_bf16 v[196:199], a[36:39], a[140:143], v[196:199]
s_nop 0
ds_read_b64_tr_b16 a[2:3], v148 offset:36864
ds_read_b64_tr_b16 a[4:5], v149 offset:32768
v_mfma_f32_16x16x32_bf16 v[164:167], a[36:39], a[136:139], v[164:167]
s_waitcnt lgkmcnt(11)
ds_read_b64_tr_b16 a[6:7], v149 offset:36864
v_mfma_f32_16x16x32_bf16 v[168:171], a[40:43], a[136:139], v[168:171]
ds_read_b64_tr_b16 a[8:9], v150 offset:32768
v_mfma_f32_16x16x32_bf16 v[200:203], a[40:43], a[140:143], v[200:203]
buffer_load_dwordx4 a[188:191], v39, s[24:27], s94 offen sc1
v_mfma_f32_16x16x32_bf16 v[204:207], a[44:47], a[140:143], v[204:207]
s_add_u32 s93, s70, 786432
ds_read_b64_tr_b16 a[10:11], v150 offset:36864
ds_read_b64_tr_b16 a[12:13], v151 offset:32768
v_mfma_f32_16x16x32_bf16 v[172:175], a[44:47], a[136:139], v[172:175]
s_waitcnt lgkmcnt(11)
ds_read_b64_tr_b16 a[14:15], v151 offset:36864
s_add_u32 m0, s82, 49152
v_mfma_f32_16x16x32_bf16 v[176:179], a[48:51], a[136:139], v[176:179]
s_nop 0
ds_read_b64_tr_b16 a[16:17], v154 offset:32768
v_mfma_f32_16x16x32_bf16 v[208:211], a[48:51], a[140:143], v[208:211]
buffer_load_dwordx4 v34, s[20:23], s93 offen lds
v_mfma_f32_16x16x32_bf16 v[212:215], a[52:55], a[140:143], v[212:215]
s_add_u32 m0, s82, 51200
ds_read_b64_tr_b16 a[18:19], v154 offset:36864
ds_read_b64_tr_b16 a[20:21], v155 offset:32768
v_mfma_f32_16x16x32_bf16 v[180:183], a[52:55], a[136:139], v[180:183]
s_waitcnt lgkmcnt(11)
ds_read_b64_tr_b16 a[22:23], v155 offset:36864
v_mfma_f32_16x16x32_bf16 v[184:187], a[56:59], a[136:139], v[184:187]
buffer_load_dwordx4 v35, s[20:23], s93 offen lds
v_mfma_f32_16x16x32_bf16 v[216:219], a[56:59], a[140:143], v[216:219]
s_nop 0
ds_read_b64_tr_b16 a[24:25], v156 offset:32768
ds_read_b64_tr_b16 a[26:27], v156 offset:36864
v_mfma_f32_16x16x32_bf16 v[220:223], a[60:63], a[140:143], v[220:223]
s_waitcnt vmcnt(22) lgkmcnt(10)
ds_read_b64_tr_b16 a[28:29], v157 offset:32768
v_mfma_f32_16x16x32_bf16 v[188:191], a[60:63], a[136:139], v[188:191]
s_barrier
ds_read_b64_tr_b16 a[30:31], v157 offset:36864
v_mfma_f32_16x16x32_bf16 v[160:163], a[0:3], a[144:147], v[160:163]
s_add_u32 s96, s71, 8192
ds_read_b64_tr_b16 a[32:33], v148 offset:40960
v_mfma_f32_16x16x32_bf16 v[192:195], a[0:3], a[148:151], v[192:195]
buffer_load_dwordx4 a[64:67], v38, s[24:27], s96 offen sc1
v_mfma_f32_16x16x32_bf16 v[196:199], a[4:7], a[148:151], v[196:199]
s_nop 0
ds_read_b64_tr_b16 a[34:35], v148 offset:45056
ds_read_b64_tr_b16 a[36:37], v149 offset:40960
v_mfma_f32_16x16x32_bf16 v[164:167], a[4:7], a[144:147], v[164:167]
s_waitcnt lgkmcnt(11)
ds_read_b64_tr_b16 a[38:39], v149 offset:45056
v_mfma_f32_16x16x32_bf16 v[168:171], a[8:11], a[144:147], v[168:171]
ds_read_b64_tr_b16 a[40:41], v150 offset:40960
v_mfma_f32_16x16x32_bf16 v[200:203], a[8:11], a[148:151], v[200:203]
buffer_load_dwordx4 a[68:71], v39, s[24:27], s96 offen sc1
v_mfma_f32_16x16x32_bf16 v[204:207], a[12:15], a[148:151], v[204:207]
s_add_u32 s95, s70, 851968
ds_read_b64_tr_b16 a[42:43], v150 offset:45056
ds_read_b64_tr_b16 a[44:45], v151 offset:40960
v_mfma_f32_16x16x32_bf16 v[172:175], a[12:15], a[144:147], v[172:175]
s_waitcnt lgkmcnt(11)
ds_read_b64_tr_b16 a[46:47], v151 offset:45056
s_add_u32 m0, s82, 57344
v_mfma_f32_16x16x32_bf16 v[176:179], a[16:19], a[144:147], v[176:179]
s_nop 0
ds_read_b64_tr_b16 a[48:49], v154 offset:40960
v_mfma_f32_16x16x32_bf16 v[208:211], a[16:19], a[148:151], v[208:211]
buffer_load_dwordx4 v34, s[20:23], s95 offen lds
v_mfma_f32_16x16x32_bf16 v[212:215], a[20:23], a[148:151], v[212:215]
s_add_u32 m0, s82, 59392
ds_read_b64_tr_b16 a[50:51], v154 offset:45056
ds_read_b64_tr_b16 a[52:53], v155 offset:40960
v_mfma_f32_16x16x32_bf16 v[180:183], a[20:23], a[144:147], v[180:183]
s_waitcnt lgkmcnt(11)
ds_read_b64_tr_b16 a[54:55], v155 offset:45056
v_mfma_f32_16x16x32_bf16 v[184:187], a[24:27], a[144:147], v[184:187]
buffer_load_dwordx4 v35, s[20:23], s95 offen lds
v_mfma_f32_16x16x32_bf16 v[216:219], a[24:27], a[148:151], v[216:219]
s_nop 0
ds_read_b64_tr_b16 a[56:57], v156 offset:40960
ds_read_b64_tr_b16 a[58:59], v156 offset:45056
v_mfma_f32_16x16x32_bf16 v[220:223], a[28:31], a[148:151], v[220:223]
s_waitcnt vmcnt(22) lgkmcnt(10)
ds_read_b64_tr_b16 a[60:61], v157 offset:40960
v_mfma_f32_16x16x32_bf16 v[188:191], a[28:31], a[144:147], v[188:191]
s_barrier
ds_read_b64_tr_b16 a[62:63], v157 offset:45056
v_mfma_f32_16x16x32_bf16 v[160:163], a[32:35], a[152:155], v[160:163]
s_add_u32 s93, s71, 9216
ds_read_b64_tr_b16 a[0:1], v148 offset:49152
v_mfma_f32_16x16x32_bf16 v[192:195], a[32:35], a[156:159], v[192:195]
buffer_load_dwordx4 a[72:75], v38, s[24:27], s93 offen sc1
v_mfma_f32_16x16x32_bf16 v[196:199], a[36:39], a[156:159], v[196:199]
s_nop 0
ds_read_b64_tr_b16 a[2:3], v148 offset:53248
ds_read_b64_tr_b16 a[4:5], v149 offset:49152
v_mfma_f32_16x16x32_bf16 v[164:167], a[36:39], a[152:155], v[164:167]
s_waitcnt lgkmcnt(11)
ds_read_b64_tr_b16 a[6:7], v149 offset:53248
v_mfma_f32_16x16x32_bf16 v[168:171], a[40:43], a[152:155], v[168:171]
ds_read_b64_tr_b16 a[8:9], v150 offset:49152
v_mfma_f32_16x16x32_bf16 v[200:203], a[40:43], a[156:159], v[200:203]
buffer_load_dwordx4 a[76:79], v39, s[24:27], s93 offen sc1
v_mfma_f32_16x16x32_bf16 v[204:207], a[44:47], a[156:159], v[204:207]
s_add_u32 s97, s70, 917504
ds_read_b64_tr_b16 a[10:11], v150 offset:53248
ds_read_b64_tr_b16 a[12:13], v151 offset:49152
v_mfma_f32_16x16x32_bf16 v[172:175], a[44:47], a[152:155], v[172:175]
s_waitcnt lgkmcnt(11)
ds_read_b64_tr_b16 a[14:15], v151 offset:53248
s_add_u32 m0, s82, 65536
v_mfma_f32_16x16x32_bf16 v[176:179], a[48:51], a[152:155], v[176:179]
s_nop 0
ds_read_b64_tr_b16 a[16:17], v154 offset:49152
v_mfma_f32_16x16x32_bf16 v[208:211], a[48:51], a[156:159], v[208:211]
buffer_load_dwordx4 v34, s[20:23], s97 offen lds
v_mfma_f32_16x16x32_bf16 v[212:215], a[52:55], a[156:159], v[212:215]
s_add_u32 m0, s82, 67584
ds_read_b64_tr_b16 a[18:19], v154 offset:53248
ds_read_b64_tr_b16 a[20:21], v155 offset:49152
v_mfma_f32_16x16x32_bf16 v[180:183], a[52:55], a[152:155], v[180:183]
s_waitcnt lgkmcnt(11)
ds_read_b64_tr_b16 a[22:23], v155 offset:53248
v_mfma_f32_16x16x32_bf16 v[184:187], a[56:59], a[152:155], v[184:187]
buffer_load_dwordx4 v35, s[20:23], s97 offen lds
v_mfma_f32_16x16x32_bf16 v[216:219], a[56:59], a[156:159], v[216:219]
s_nop 0
ds_read_b64_tr_b16 a[24:25], v156 offset:49152
ds_read_b64_tr_b16 a[26:27], v156 offset:53248
v_mfma_f32_16x16x32_bf16 v[220:223], a[60:63], a[156:159], v[220:223]
s_waitcnt vmcnt(12) lgkmcnt(10)
ds_read_b64_tr_b16 a[28:29], v157 offset:49152
v_mfma_f32_16x16x32_bf16 v[188:191], a[60:63], a[152:155], v[188:191]
s_barrier
ds_read_b64_tr_b16 a[30:31], v157 offset:53248
v_mfma_f32_16x16x32_bf16 v[160:163], a[0:3], a[160:163], v[160:163]
s_add_u32 s95, s71, 10240
ds_read_b64_tr_b16 a[32:33], v154 offset:57344
v_mfma_f32_16x16x32_bf16 v[192:195], a[0:3], a[164:167], v[192:195]
buffer_load_dwordx4 a[80:83], v38, s[24:27], s95 offen sc1
v_mfma_f32_16x16x32_bf16 v[196:199], a[4:7], a[164:167], v[196:199]
s_nop 0
ds_read_b64_tr_b16 a[34:35], v154 offset:61440
ds_read_b64_tr_b16 a[36:37], v155 offset:57344
v_mfma_f32_16x16x32_bf16 v[164:167], a[4:7], a[160:163], v[164:167]
s_waitcnt lgkmcnt(11)
ds_read_b64_tr_b16 a[38:39], v155 offset:61440
v_mfma_f32_16x16x32_bf16 v[168:171], a[8:11], a[160:163], v[168:171]
ds_read_b64_tr_b16 a[40:41], v156 offset:57344
v_mfma_f32_16x16x32_bf16 v[200:203], a[8:11], a[164:167], v[200:203]
buffer_load_dwordx4 a[84:87], v39, s[24:27], s95 offen sc1
v_mfma_f32_16x16x32_bf16 v[204:207], a[12:15], a[164:167], v[204:207]
s_add_u32 s94, s70, 983040
ds_read_b64_tr_b16 a[42:43], v156 offset:61440
ds_read_b64_tr_b16 a[44:45], v157 offset:57344
v_mfma_f32_16x16x32_bf16 v[172:175], a[12:15], a[160:163], v[172:175]
s_waitcnt lgkmcnt(11)
ds_read_b64_tr_b16 a[46:47], v157 offset:61440
s_add_u32 m0, s82, 73728
v_mfma_f32_16x16x32_bf16 v[176:179], a[16:19], a[160:163], v[176:179]
s_nop 0
ds_read_b64_tr_b16 a[48:49], v140 offset:0
v_mfma_f32_16x16x32_bf16 v[208:211], a[16:19], a[164:167], v[208:211]
buffer_load_dwordx4 v34, s[20:23], s94 offen lds
v_mfma_f32_16x16x32_bf16 v[212:215], a[20:23], a[164:167], v[212:215]
s_add_u32 m0, s82, 75776
ds_read_b64_tr_b16 a[50:51], v140 offset:4096
ds_read_b64_tr_b16 a[52:53], v141 offset:0
v_mfma_f32_16x16x32_bf16 v[180:183], a[20:23], a[160:163], v[180:183]
s_waitcnt lgkmcnt(11)
ds_read_b64_tr_b16 a[54:55], v141 offset:4096
v_mfma_f32_16x16x32_bf16 v[184:187], a[24:27], a[160:163], v[184:187]
buffer_load_dwordx4 v35, s[20:23], s94 offen lds
v_mfma_f32_16x16x32_bf16 v[216:219], a[24:27], a[164:167], v[216:219]
s_nop 0
ds_read_b64_tr_b16 a[56:57], v142 offset:0
ds_read_b64_tr_b16 a[58:59], v142 offset:4096
v_mfma_f32_16x16x32_bf16 v[220:223], a[28:31], a[164:167], v[220:223]
s_waitcnt lgkmcnt(10)
ds_read_b64_tr_b16 a[60:61], v143 offset:0
v_mfma_f32_16x16x32_bf16 v[188:191], a[28:31], a[160:163], v[188:191]
s_barrier
ds_read_b64_tr_b16 a[62:63], v143 offset:4096
v_mfma_f32_16x16x32_bf16 v[176:179], a[32:35], a[168:171], v[176:179]
s_add_u32 s96, s71, 11264
ds_read_b64_tr_b16 a[0:1], v140 offset:8192
v_mfma_f32_16x16x32_bf16 v[208:211], a[32:35], a[172:175], v[208:211]
buffer_load_dwordx4 a[88:91], v38, s[24:27], s96 offen sc1
ds_read_b64_tr_b16 a[2:3], v140 offset:12288
v_mfma_f32_16x16x32_bf16 v[212:215], a[36:39], a[172:175], v[212:215]
ds_read_b64_tr_b16 a[4:5], v141 offset:8192
v_mfma_f32_16x16x32_bf16 v[180:183], a[36:39], a[168:171], v[180:183]
s_waitcnt lgkmcnt(11)
ds_read_b64_tr_b16 a[6:7], v141 offset:12288
v_mfma_f32_16x16x32_bf16 v[184:187], a[40:43], a[168:171], v[184:187]
buffer_load_dwordx4 a[92:95], v39, s[24:27], s96 offen sc1
ds_read_b64_tr_b16 a[8:9], v142 offset:8192
v_mfma_f32_16x16x32_bf16 v[216:219], a[40:43], a[172:175], v[216:219]
ds_read_b64_tr_b16 a[10:11], v142 offset:12288
v_mfma_f32_16x16x32_bf16 v[220:223], a[44:47], a[172:175], v[220:223]
ds_read_b64_tr_b16 a[12:13], v143 offset:8192
v_mfma_f32_16x16x32_bf16 v[188:191], a[44:47], a[168:171], v[188:191]
s_waitcnt lgkmcnt(11)
ds_read_b64_tr_b16 a[14:15], v143 offset:12288
v_mfma_f32_16x16x32_bf16 v[176:179], a[48:51], a[176:179], v[176:179]
s_add_u32 s97, s71, 12288
ds_read_b64_tr_b16 a[16:17], v140 offset:16384
v_mfma_f32_16x16x32_bf16 v[208:211], a[48:51], a[180:183], v[208:211]
buffer_load_dwordx4 a[96:99], v38, s[24:27], s97 offen sc1
ds_read_b64_tr_b16 a[18:19], v140 offset:20480
v_mfma_f32_16x16x32_bf16 v[212:215], a[52:55], a[180:183], v[212:215]
ds_read_b64_tr_b16 a[20:21], v141 offset:16384
v_mfma_f32_16x16x32_bf16 v[180:183], a[52:55], a[176:179], v[180:183]
s_waitcnt lgkmcnt(11)
ds_read_b64_tr_b16 a[22:23], v141 offset:20480
v_mfma_f32_16x16x32_bf16 v[184:187], a[56:59], a[176:179], v[184:187]
buffer_load_dwordx4 a[100:103], v39, s[24:27], s97 offen sc1
ds_read_b64_tr_b16 a[24:25], v142 offset:16384
v_mfma_f32_16x16x32_bf16 v[216:219], a[56:59], a[180:183], v[216:219]
ds_read_b64_tr_b16 a[26:27], v142 offset:20480
v_mfma_f32_16x16x32_bf16 v[220:223], a[60:63], a[180:183], v[220:223]
ds_read_b64_tr_b16 a[28:29], v143 offset:16384
v_mfma_f32_16x16x32_bf16 v[188:191], a[60:63], a[176:179], v[188:191]
s_waitcnt vmcnt(18) lgkmcnt(11)
ds_read_b64_tr_b16 a[30:31], v143 offset:20480
v_mfma_f32_16x16x32_bf16 v[176:179], a[0:3], a[184:187], v[176:179]
s_add_u32 s93, s71, 13312
ds_read_b64_tr_b16 a[32:33], v140 offset:24576
v_mfma_f32_16x16x32_bf16 v[208:211], a[0:3], a[188:191], v[208:211]
buffer_load_dwordx4 a[104:107], v38, s[24:27], s93 offen sc1
ds_read_b64_tr_b16 a[34:35], v140 offset:28672
v_mfma_f32_16x16x32_bf16 v[212:215], a[4:7], a[188:191], v[212:215]
ds_read_b64_tr_b16 a[36:37], v141 offset:24576
v_mfma_f32_16x16x32_bf16 v[180:183], a[4:7], a[184:187], v[180:183]
s_waitcnt lgkmcnt(11)
ds_read_b64_tr_b16 a[38:39], v141 offset:28672
v_mfma_f32_16x16x32_bf16 v[184:187], a[8:11], a[184:187], v[184:187]
buffer_load_dwordx4 a[108:111], v39, s[24:27], s93 offen sc1
ds_read_b64_tr_b16 a[40:41], v142 offset:24576
v_mfma_f32_16x16x32_bf16 v[216:219], a[8:11], a[188:191], v[216:219]
Lpad15:
s_cbranch_execz Lpadback1
s_nop 0
ds_read_b64_tr_b16 a[42:43], v142 offset:28672
v_mfma_f32_16x16x32_bf16 v[220:223], a[12:15], a[188:191], v[220:223]
ds_read_b64_tr_b16 a[44:45], v143 offset:24576
v_mfma_f32_16x16x32_bf16 v[188:191], a[12:15], a[184:187], v[188:191]
s_waitcnt vmcnt(16) lgkmcnt(11)
ds_read_b64_tr_b16 a[46:47], v143 offset:28672
v_mfma_f32_16x16x32_bf16 v[176:179], a[16:19], a[64:67], v[176:179]
s_add_u32 s94, s71, 14336
ds_read_b64_tr_b16 a[48:49], v140 offset:32768
v_mfma_f32_16x16x32_bf16 v[208:211], a[16:19], a[68:71], v[208:211]
buffer_load_dwordx4 a[112:115], v38, s[24:27], s94 offen sc1
ds_read_b64_tr_b16 a[50:51], v140 offset:36864
v_mfma_f32_16x16x32_bf16 v[212:215], a[20:23], a[68:71], v[212:215]
ds_read_b64_tr_b16 a[52:53], v141 offset:32768
v_mfma_f32_16x16x32_bf16 v[180:183], a[20:23], a[64:67], v[180:183]
s_waitcnt lgkmcnt(11)
ds_read_b64_tr_b16 a[54:55], v141 offset:36864
v_mfma_f32_16x16x32_bf16 v[184:187], a[24:27], a[64:67], v[184:187]
buffer_load_dwordx4 a[116:119], v39, s[24:27], s94 offen sc1
ds_read_b64_tr_b16 a[56:57], v142 offset:32768
v_mfma_f32_16x16x32_bf16 v[216:219], a[24:27], a[68:71], v[216:219]
ds_read_b64_tr_b16 a[58:59], v142 offset:36864
v_mfma_f32_16x16x32_bf16 v[220:223], a[28:31], a[68:71], v[220:223]
ds_read_b64_tr_b16 a[60:61], v143 offset:32768
v_mfma_f32_16x16x32_bf16 v[188:191], a[28:31], a[64:67], v[188:191]
s_waitcnt vmcnt(14) lgkmcnt(11)
ds_read_b64_tr_b16 a[62:63], v143 offset:36864
v_mfma_f32_16x16x32_bf16 v[176:179], a[32:35], a[72:75], v[176:179]
s_add_u32 s95, s71, 15360
ds_read_b64_tr_b16 a[0:1], v140 offset:40960
v_mfma_f32_16x16x32_bf16 v[208:211], a[32:35], a[76:79], v[208:211]
buffer_load_dwordx4 a[120:123], v38, s[24:27], s95 offen sc1
ds_read_b64_tr_b16 a[2:3], v140 offset:45056
v_mfma_f32_16x16x32_bf16 v[212:215], a[36:39], a[76:79], v[212:215]
ds_read_b64_tr_b16 a[4:5], v141 offset:40960
v_mfma_f32_16x16x32_bf16 v[180:183], a[36:39], a[72:75], v[180:183]
s_waitcnt lgkmcnt(11)
ds_read_b64_tr_b16 a[6:7], v141 offset:45056
v_mfma_f32_16x16x32_bf16 v[184:187], a[40:43], a[72:75], v[184:187]
buffer_load_dwordx4 a[124:127], v39, s[24:27], s95 offen sc1
ds_read_b64_tr_b16 a[8:9], v142 offset:40960
v_mfma_f32_16x16x32_bf16 v[216:219], a[40:43], a[76:79], v[216:219]
ds_read_b64_tr_b16 a[10:11], v142 offset:45056
v_mfma_f32_16x16x32_bf16 v[220:223], a[44:47], a[76:79], v[220:223]
s_waitcnt vmcnt(12) lgkmcnt(10)
ds_read_b64_tr_b16 a[12:13], v143 offset:40960
v_mfma_f32_16x16x32_bf16 v[188:191], a[44:47], a[72:75], v[188:191]
s_barrier
ds_read_b64_tr_b16 a[14:15], v143 offset:45056
v_mfma_f32_16x16x32_bf16 v[176:179], a[48:51], a[80:83], v[176:179]
ds_read_b64_tr_b16 a[16:17], v140 offset:49152
v_mfma_f32_16x16x32_bf16 v[208:211], a[48:51], a[84:87], v[208:211]
ds_read_b64_tr_b16 a[18:19], v140 offset:53248
v_mfma_f32_16x16x32_bf16 v[212:215], a[52:55], a[84:87], v[212:215]
ds_read_b64_tr_b16 a[20:21], v141 offset:49152
v_mfma_f32_16x16x32_bf16 v[180:183], a[52:55], a[80:83], v[180:183]
s_waitcnt lgkmcnt(11)
ds_read_b64_tr_b16 a[22:23], v141 offset:53248
v_mfma_f32_16x16x32_bf16 v[184:187], a[56:59], a[80:83], v[184:187]
ds_read_b64_tr_b16 a[24:25], v142 offset:49152
v_mfma_f32_16x16x32_bf16 v[216:219], a[56:59], a[84:87], v[216:219]
ds_read_b64_tr_b16 a[26:27], v142 offset:53248
v_mfma_f32_16x16x32_bf16 v[220:223], a[60:63], a[84:87], v[220:223]
s_waitcnt vmcnt(8) lgkmcnt(10)
ds_read_b64_tr_b16 a[28:29], v143 offset:49152
v_mfma_f32_16x16x32_bf16 v[188:191], a[60:63], a[80:83], v[188:191]
s_barrier
ds_read_b64_tr_b16 a[30:31], v143 offset:53248
v_mfma_f32_16x16x32_bf16 v[176:179], a[0:3], a[88:91], v[176:179]
ds_read_b64_tr_b16 a[32:33], v140 offset:57344
v_mfma_f32_16x16x32_bf16 v[208:211], a[0:3], a[92:95], v[208:211]
ds_read_b64_tr_b16 a[34:35], v140 offset:61440
v_mfma_f32_16x16x32_bf16 v[212:215], a[4:7], a[92:95], v[212:215]
ds_read_b64_tr_b16 a[36:37], v141 offset:57344
v_mfma_f32_16x16x32_bf16 v[180:183], a[4:7], a[88:91], v[180:183]
s_waitcnt lgkmcnt(11)
ds_read_b64_tr_b16 a[38:39], v141 offset:61440
v_mfma_f32_16x16x32_bf16 v[184:187], a[8:11], a[88:91], v[184:187]
ds_read_b64_tr_b16 a[40:41], v142 offset:57344
v_mfma_f32_16x16x32_bf16 v[216:219], a[8:11], a[92:95], v[216:219]
ds_read_b64_tr_b16 a[42:43], v142 offset:61440
v_mfma_f32_16x16x32_bf16 v[220:223], a[12:15], a[92:95], v[220:223]
s_waitcnt vmcnt(6) lgkmcnt(10)
ds_read_b64_tr_b16 a[44:45], v143 offset:57344
v_mfma_f32_16x16x32_bf16 v[188:191], a[12:15], a[88:91], v[188:191]
s_barrier
ds_read_b64_tr_b16 a[46:47], v143 offset:61440
v_mfma_f32_16x16x32_bf16 v[176:179], a[16:19], a[96:99], v[176:179]
ds_read_b64_tr_b16 a[48:49], v154 offset:0
v_mfma_f32_16x16x32_bf16 v[208:211], a[16:19], a[100:103], v[208:211]
ds_read_b64_tr_b16 a[50:51], v154 offset:4096
v_mfma_f32_16x16x32_bf16 v[212:215], a[20:23], a[100:103], v[212:215]
ds_read_b64_tr_b16 a[52:53], v155 offset:0
v_mfma_f32_16x16x32_bf16 v[180:183], a[20:23], a[96:99], v[180:183]
s_waitcnt lgkmcnt(11)
ds_read_b64_tr_b16 a[54:55], v155 offset:4096
v_mfma_f32_16x16x32_bf16 v[184:187], a[24:27], a[96:99], v[184:187]
ds_read_b64_tr_b16 a[56:57], v156 offset:0
v_mfma_f32_16x16x32_bf16 v[216:219], a[24:27], a[100:103], v[216:219]
ds_read_b64_tr_b16 a[58:59], v156 offset:4096
v_mfma_f32_16x16x32_bf16 v[220:223], a[28:31], a[100:103], v[220:223]
s_waitcnt vmcnt(4) lgkmcnt(10)
ds_read_b64_tr_b16 a[60:61], v157 offset:0
v_mfma_f32_16x16x32_bf16 v[188:191], a[28:31], a[96:99], v[188:191]
s_barrier
ds_read_b64_tr_b16 a[62:63], v157 offset:4096
v_mfma_f32_16x16x32_bf16 v[176:179], a[32:35], a[104:107], v[176:179]
ds_read_b64_tr_b16 a[0:1], v154 offset:8192
v_mfma_f32_16x16x32_bf16 v[208:211], a[32:35], a[108:111], v[208:211]
ds_read_b64_tr_b16 a[2:3], v154 offset:12288
v_mfma_f32_16x16x32_bf16 v[212:215], a[36:39], a[108:111], v[212:215]
ds_read_b64_tr_b16 a[4:5], v155 offset:8192
v_mfma_f32_16x16x32_bf16 v[180:183], a[36:39], a[104:107], v[180:183]
s_waitcnt lgkmcnt(11)
ds_read_b64_tr_b16 a[6:7], v155 offset:12288
v_mfma_f32_16x16x32_bf16 v[184:187], a[40:43], a[104:107], v[184:187]
ds_read_b64_tr_b16 a[8:9], v156 offset:8192
v_mfma_f32_16x16x32_bf16 v[216:219], a[40:43], a[108:111], v[216:219]
ds_read_b64_tr_b16 a[10:11], v156 offset:12288
v_mfma_f32_16x16x32_bf16 v[220:223], a[44:47], a[108:111], v[220:223]
ds_read_b64_tr_b16 a[12:13], v157 offset:8192
v_mfma_f32_16x16x32_bf16 v[188:191], a[44:47], a[104:107], v[188:191]
s_waitcnt vmcnt(2) lgkmcnt(11)
ds_read_b64_tr_b16 a[14:15], v157 offset:12288
v_mfma_f32_16x16x32_bf16 v[176:179], a[48:51], a[112:115], v[176:179]
ds_read_b64_tr_b16 a[16:17], v148 offset:57344
v_mfma_f32_16x16x32_bf16 v[208:211], a[48:51], a[116:119], v[208:211]
ds_read_b64_tr_b16 a[18:19], v148 offset:61440
v_mfma_f32_16x16x32_bf16 v[212:215], a[52:55], a[116:119], v[212:215]
ds_read_b64_tr_b16 a[20:21], v149 offset:57344
v_mfma_f32_16x16x32_bf16 v[180:183], a[52:55], a[112:115], v[180:183]
s_waitcnt lgkmcnt(11)
ds_read_b64_tr_b16 a[22:23], v149 offset:61440
v_mfma_f32_16x16x32_bf16 v[184:187], a[56:59], a[112:115], v[184:187]
ds_read_b64_tr_b16 a[24:25], v150 offset:57344
v_mfma_f32_16x16x32_bf16 v[216:219], a[56:59], a[116:119], v[216:219]
ds_read_b64_tr_b16 a[26:27], v150 offset:61440
v_mfma_f32_16x16x32_bf16 v[220:223], a[60:63], a[116:119], v[220:223]
ds_read_b64_tr_b16 a[28:29], v151 offset:57344
v_mfma_f32_16x16x32_bf16 v[188:191], a[60:63], a[112:115], v[188:191]
s_waitcnt vmcnt(0) lgkmcnt(11)
ds_read_b64_tr_b16 a[30:31], v151 offset:61440
v_mfma_f32_16x16x32_bf16 v[176:179], a[0:3], a[120:123], v[176:179]
ds_read_b64_tr_b16 a[32:33], v132 offset:0
v_mfma_f32_16x16x32_bf16 v[208:211], a[0:3], a[124:127], v[208:211]
ds_read_b64_tr_b16 a[34:35], v132 offset:4096
v_mfma_f32_16x16x32_bf16 v[212:215], a[4:7], a[124:127], v[212:215]
ds_read_b64_tr_b16 a[36:37], v133 offset:0
v_mfma_f32_16x16x32_bf16 v[180:183], a[4:7], a[120:123], v[180:183]
s_waitcnt lgkmcnt(11)
ds_read_b64_tr_b16 a[38:39], v133 offset:4096
v_mfma_f32_16x16x32_bf16 v[184:187], a[8:11], a[120:123], v[184:187]
ds_read_b64_tr_b16 a[40:41], v134 offset:0
v_mfma_f32_16x16x32_bf16 v[216:219], a[8:11], a[124:127], v[216:219]
ds_read_b64_tr_b16 a[42:43], v134 offset:4096
v_mfma_f32_16x16x32_bf16 v[220:223], a[12:15], a[124:127], v[220:223]
ds_read_b64_tr_b16 a[44:45], v135 offset:0
v_mfma_f32_16x16x32_bf16 v[188:191], a[12:15], a[120:123], v[188:191]
s_waitcnt lgkmcnt(11)
ds_read_b64_tr_b16 a[46:47], v135 offset:4096
v_mfma_f32_16x16x32_bf16 v[160:163], a[16:19], a[168:171], v[160:163]
ds_read_b64_tr_b16 a[48:49], v132 offset:8192
v_cvt_pk_bf16_f32 v176, v176, v177
v_cvt_pk_bf16_f32 v177, v178, v179
v_mfma_f32_16x16x32_bf16 v[192:195], a[16:19], a[172:175], v[192:195]
ds_read_b64_tr_b16 a[50:51], v132 offset:12288
v_cvt_pk_bf16_f32 v178, v180, v181
v_cvt_pk_bf16_f32 v179, v182, v183
v_mfma_f32_16x16x32_bf16 v[196:199], a[20:23], a[172:175], v[196:199]
buffer_store_dwordx4 v[176:179], v1, s[24:27], s58 offen offset:0 sc1
ds_read_b64_tr_b16 a[52:53], v133 offset:8192
v_mfma_f32_16x16x32_bf16 v[164:167], a[20:23], a[168:171], v[164:167]
s_waitcnt lgkmcnt(11)
ds_read_b64_tr_b16 a[54:55], v133 offset:12288
v_cvt_pk_bf16_f32 v184, v184, v185
v_cvt_pk_bf16_f32 v185, v186, v187
v_mfma_f32_16x16x32_bf16 v[168:171], a[24:27], a[168:171], v[168:171]
ds_read_b64_tr_b16 a[56:57], v134 offset:8192
v_cvt_pk_bf16_f32 v186, v188, v189
v_cvt_pk_bf16_f32 v187, v190, v191
v_mfma_f32_16x16x32_bf16 v[200:203], a[24:27], a[172:175], v[200:203]
buffer_store_dwordx4 v[184:187], v1, s[24:27], s58 offen offset:1024 sc1
ds_read_b64_tr_b16 a[58:59], v134 offset:12288
v_mfma_f32_16x16x32_bf16 v[204:207], a[28:31], a[172:175], v[204:207]
ds_read_b64_tr_b16 a[60:61], v135 offset:8192
v_cvt_pk_bf16_f32 v208, v208, v209
v_cvt_pk_bf16_f32 v209, v210, v211
v_mfma_f32_16x16x32_bf16 v[172:175], a[28:31], a[168:171], v[172:175]
s_waitcnt lgkmcnt(11)
ds_read_b64_tr_b16 a[62:63], v135 offset:12288
v_cvt_pk_bf16_f32 v210, v212, v213
v_cvt_pk_bf16_f32 v211, v214, v215
v_mfma_f32_16x16x32_bf16 v[160:163], a[32:35], a[176:179], v[160:163]
buffer_store_dwordx4 v[208:211], v1, s[24:27], s58 offen offset:2048 sc1
ds_read_b64_tr_b16 a[0:1], v132 offset:16384
v_mfma_f32_16x16x32_bf16 v[192:195], a[32:35], a[180:183], v[192:195]
ds_read_b64_tr_b16 a[2:3], v132 offset:20480
v_cvt_pk_bf16_f32 v216, v216, v217
v_cvt_pk_bf16_f32 v217, v218, v219
v_mfma_f32_16x16x32_bf16 v[196:199], a[36:39], a[180:183], v[196:199]
ds_read_b64_tr_b16 a[4:5], v133 offset:16384
v_cvt_pk_bf16_f32 v218, v220, v221
v_cvt_pk_bf16_f32 v219, v222, v223
v_mfma_f32_16x16x32_bf16 v[164:167], a[36:39], a[176:179], v[164:167]
s_waitcnt lgkmcnt(11)
buffer_store_dwordx4 v[216:219], v1, s[24:27], s58 offen offset:3072 sc1
v_mfma_f32_16x16x32_bf16 v[168:171], a[40:43], a[176:179], v[168:171]
s_nop 0
ds_read_b64_tr_b16 a[6:7], v133 offset:20480
ds_read_b64_tr_b16 a[8:9], v134 offset:16384
v_mfma_f32_16x16x32_bf16 v[200:203], a[40:43], a[180:183], v[200:203]
ds_read_b64_tr_b16 a[10:11], v134 offset:20480
v_mfma_f32_16x16x32_bf16 v[204:207], a[44:47], a[180:183], v[204:207]
ds_read_b64_tr_b16 a[12:13], v135 offset:16384
v_mfma_f32_16x16x32_bf16 v[172:175], a[44:47], a[176:179], v[172:175]
s_waitcnt lgkmcnt(11)
ds_read_b64_tr_b16 a[14:15], v135 offset:20480
v_mfma_f32_16x16x32_bf16 v[160:163], a[48:51], a[184:187], v[160:163]
ds_read_b64_tr_b16 a[16:17], v132 offset:24576
v_mfma_f32_16x16x32_bf16 v[192:195], a[48:51], a[188:191], v[192:195]
ds_read_b64_tr_b16 a[18:19], v132 offset:28672
v_mfma_f32_16x16x32_bf16 v[196:199], a[52:55], a[188:191], v[196:199]
ds_read_b64_tr_b16 a[20:21], v133 offset:24576
v_mfma_f32_16x16x32_bf16 v[164:167], a[52:55], a[184:187], v[164:167]
s_waitcnt lgkmcnt(11)
ds_read_b64_tr_b16 a[22:23], v133 offset:28672
v_mfma_f32_16x16x32_bf16 v[168:171], a[56:59], a[184:187], v[168:171]
ds_read_b64_tr_b16 a[24:25], v134 offset:24576
v_mfma_f32_16x16x32_bf16 v[200:203], a[56:59], a[188:191], v[200:203]
ds_read_b64_tr_b16 a[26:27], v134 offset:28672
v_mfma_f32_16x16x32_bf16 v[204:207], a[60:63], a[188:191], v[204:207]
ds_read_b64_tr_b16 a[28:29], v135 offset:24576
v_mfma_f32_16x16x32_bf16 v[172:175], a[60:63], a[184:187], v[172:175]
s_waitcnt lgkmcnt(11)
ds_read_b64_tr_b16 a[30:31], v135 offset:28672
v_mfma_f32_16x16x32_bf16 v[160:163], a[0:3], a[64:67], v[160:163]
ds_read_b64_tr_b16 a[32:33], v132 offset:32768
v_mfma_f32_16x16x32_bf16 v[192:195], a[0:3], a[68:71], v[192:195]
ds_read_b64_tr_b16 a[34:35], v132 offset:36864
v_mfma_f32_16x16x32_bf16 v[196:199], a[4:7], a[68:71], v[196:199]
ds_read_b64_tr_b16 a[36:37], v133 offset:32768
v_mfma_f32_16x16x32_bf16 v[164:167], a[4:7], a[64:67], v[164:167]
s_waitcnt lgkmcnt(11)
ds_read_b64_tr_b16 a[38:39], v133 offset:36864
v_mfma_f32_16x16x32_bf16 v[168:171], a[8:11], a[64:67], v[168:171]
ds_read_b64_tr_b16 a[40:41], v134 offset:32768
v_mfma_f32_16x16x32_bf16 v[200:203], a[8:11], a[68:71], v[200:203]
ds_read_b64_tr_b16 a[42:43], v134 offset:36864
v_mfma_f32_16x16x32_bf16 v[204:207], a[12:15], a[68:71], v[204:207]
ds_read_b64_tr_b16 a[44:45], v135 offset:32768
v_mfma_f32_16x16x32_bf16 v[172:175], a[12:15], a[64:67], v[172:175]
s_waitcnt lgkmcnt(11)
ds_read_b64_tr_b16 a[46:47], v135 offset:36864
v_mfma_f32_16x16x32_bf16 v[160:163], a[16:19], a[72:75], v[160:163]
ds_read_b64_tr_b16 a[48:49], v132 offset:40960
v_mfma_f32_16x16x32_bf16 v[192:195], a[16:19], a[76:79], v[192:195]
ds_read_b64_tr_b16 a[50:51], v132 offset:45056
v_mfma_f32_16x16x32_bf16 v[196:199], a[20:23], a[76:79], v[196:199]
ds_read_b64_tr_b16 a[52:53], v133 offset:40960
v_mfma_f32_16x16x32_bf16 v[164:167], a[20:23], a[72:75], v[164:167]
s_waitcnt lgkmcnt(11)
ds_read_b64_tr_b16 a[54:55], v133 offset:45056
v_mfma_f32_16x16x32_bf16 v[168:171], a[24:27], a[72:75], v[168:171]
ds_read_b64_tr_b16 a[56:57], v134 offset:40960
v_mfma_f32_16x16x32_bf16 v[200:203], a[24:27], a[76:79], v[200:203]
ds_read_b64_tr_b16 a[58:59], v134 offset:45056
v_mfma_f32_16x16x32_bf16 v[204:207], a[28:31], a[76:79], v[204:207]
ds_read_b64_tr_b16 a[60:61], v135 offset:40960
v_mfma_f32_16x16x32_bf16 v[172:175], a[28:31], a[72:75], v[172:175]
s_waitcnt lgkmcnt(11)
ds_read_b64_tr_b16 a[62:63], v135 offset:45056
v_mfma_f32_16x16x32_bf16 v[160:163], a[32:35], a[80:83], v[160:163]
ds_read_b64_tr_b16 a[0:1], v132 offset:49152
v_mfma_f32_16x16x32_bf16 v[192:195], a[32:35], a[84:87], v[192:195]
ds_read_b64_tr_b16 a[2:3], v132 offset:53248
v_mfma_f32_16x16x32_bf16 v[196:199], a[36:39], a[84:87], v[196:199]
ds_read_b64_tr_b16 a[4:5], v133 offset:49152
v_mfma_f32_16x16x32_bf16 v[164:167], a[36:39], a[80:83], v[164:167]
s_waitcnt lgkmcnt(11)
ds_read_b64_tr_b16 a[6:7], v133 offset:53248
v_mfma_f32_16x16x32_bf16 v[168:171], a[40:43], a[80:83], v[168:171]
ds_read_b64_tr_b16 a[8:9], v134 offset:49152
v_mfma_f32_16x16x32_bf16 v[200:203], a[40:43], a[84:87], v[200:203]
ds_read_b64_tr_b16 a[10:11], v134 offset:53248
v_mfma_f32_16x16x32_bf16 v[204:207], a[44:47], a[84:87], v[204:207]
ds_read_b64_tr_b16 a[12:13], v135 offset:49152
v_mfma_f32_16x16x32_bf16 v[172:175], a[44:47], a[80:83], v[172:175]
s_waitcnt lgkmcnt(11)
ds_read_b64_tr_b16 a[14:15], v135 offset:53248
v_mfma_f32_16x16x32_bf16 v[160:163], a[48:51], a[88:91], v[160:163]
ds_read_b64_tr_b16 a[16:17], v132 offset:57344
v_mfma_f32_16x16x32_bf16 v[192:195], a[48:51], a[92:95], v[192:195]
ds_read_b64_tr_b16 a[18:19], v132 offset:61440
v_mfma_f32_16x16x32_bf16 v[196:199], a[52:55], a[92:95], v[196:199]
ds_read_b64_tr_b16 a[20:21], v133 offset:57344
v_mfma_f32_16x16x32_bf16 v[164:167], a[52:55], a[88:91], v[164:167]
s_waitcnt lgkmcnt(11)
ds_read_b64_tr_b16 a[22:23], v133 offset:61440
v_mfma_f32_16x16x32_bf16 v[168:171], a[56:59], a[88:91], v[168:171]
ds_read_b64_tr_b16 a[24:25], v134 offset:57344
v_mfma_f32_16x16x32_bf16 v[200:203], a[56:59], a[92:95], v[200:203]
ds_read_b64_tr_b16 a[26:27], v134 offset:61440
v_mfma_f32_16x16x32_bf16 v[204:207], a[60:63], a[92:95], v[204:207]
ds_read_b64_tr_b16 a[28:29], v135 offset:57344
v_mfma_f32_16x16x32_bf16 v[172:175], a[60:63], a[88:91], v[172:175]
s_waitcnt lgkmcnt(11)
ds_read_b64_tr_b16 a[30:31], v135 offset:61440
v_mfma_f32_16x16x32_bf16 v[160:163], a[0:3], a[96:99], v[160:163]
ds_read_b64_tr_b16 a[32:33], v148 offset:0
v_mfma_f32_16x16x32_bf16 v[192:195], a[0:3], a[100:103], v[192:195]
ds_read_b64_tr_b16 a[34:35], v148 offset:4096
v_mfma_f32_16x16x32_bf16 v[196:199], a[4:7], a[100:103], v[196:199]
ds_read_b64_tr_b16 a[36:37], v149 offset:0
v_mfma_f32_16x16x32_bf16 v[164:167], a[4:7], a[96:99], v[164:167]
s_waitcnt lgkmcnt(11)
ds_read_b64_tr_b16 a[38:39], v149 offset:4096
v_mfma_f32_16x16x32_bf16 v[168:171], a[8:11], a[96:99], v[168:171]
ds_read_b64_tr_b16 a[40:41], v150 offset:0
v_mfma_f32_16x16x32_bf16 v[200:203], a[8:11], a[100:103], v[200:203]
ds_read_b64_tr_b16 a[42:43], v150 offset:4096
v_mfma_f32_16x16x32_bf16 v[204:207], a[12:15], a[100:103], v[204:207]
ds_read_b64_tr_b16 a[44:45], v151 offset:0
v_mfma_f32_16x16x32_bf16 v[172:175], a[12:15], a[96:99], v[172:175]
s_waitcnt lgkmcnt(11)
ds_read_b64_tr_b16 a[46:47], v151 offset:4096
v_mfma_f32_16x16x32_bf16 v[160:163], a[16:19], a[104:107], v[160:163]
ds_read_b64_tr_b16 a[48:49], v148 offset:8192
v_mfma_f32_16x16x32_bf16 v[192:195], a[16:19], a[108:111], v[192:195]
ds_read_b64_tr_b16 a[50:51], v148 offset:12288
v_mfma_f32_16x16x32_bf16 v[196:199], a[20:23], a[108:111], v[196:199]
ds_read_b64_tr_b16 a[52:53], v149 offset:8192
v_mfma_f32_16x16x32_bf16 v[164:167], a[20:23], a[104:107], v[164:167]
s_waitcnt lgkmcnt(11)
ds_read_b64_tr_b16 a[54:55], v149 offset:12288
v_mfma_f32_16x16x32_bf16 v[168:171], a[24:27], a[104:107], v[168:171]
ds_read_b64_tr_b16 a[56:57], v150 offset:8192
v_mfma_f32_16x16x32_bf16 v[200:203], a[24:27], a[108:111], v[200:203]
ds_read_b64_tr_b16 a[58:59], v150 offset:12288
v_mfma_f32_16x16x32_bf16 v[204:207], a[28:31], a[108:111], v[204:207]
ds_read_b64_tr_b16 a[60:61], v151 offset:8192
v_mfma_f32_16x16x32_bf16 v[172:175], a[28:31], a[104:107], v[172:175]
s_waitcnt lgkmcnt(11)
ds_read_b64_tr_b16 a[62:63], v151 offset:12288
v_mfma_f32_16x16x32_bf16 v[160:163], a[32:35], a[112:115], v[160:163]
v_mfma_f32_16x16x32_bf16 v[192:195], a[32:35], a[116:119], v[192:195]
v_mfma_f32_16x16x32_bf16 v[196:199], a[36:39], a[116:119], v[196:199]
v_mfma_f32_16x16x32_bf16 v[164:167], a[36:39], a[112:115], v[164:167]
s_waitcnt lgkmcnt(8)
v_mfma_f32_16x16x32_bf16 v[168:171], a[40:43], a[112:115], v[168:171]
v_mfma_f32_16x16x32_bf16 v[200:203], a[40:43], a[116:119], v[200:203]
v_mfma_f32_16x16x32_bf16 v[204:207], a[44:47], a[116:119], v[204:207]
v_mfma_f32_16x16x32_bf16 v[172:175], a[44:47], a[112:115], v[172:175]
s_waitcnt lgkmcnt(4)
v_mfma_f32_16x16x32_bf16 v[160:163], a[48:51], a[120:123], v[160:163]
v_mfma_f32_16x16x32_bf16 v[192:195], a[48:51], a[124:127], v[192:195]
v_mfma_f32_16x16x32_bf16 v[196:199], a[52:55], a[124:127], v[196:199]
v_mfma_f32_16x16x32_bf16 v[164:167], a[52:55], a[120:123], v[164:167]
s_waitcnt lgkmcnt(0)
v_mfma_f32_16x16x32_bf16 v[168:171], a[56:59], a[120:123], v[168:171]
v_mfma_f32_16x16x32_bf16 v[200:203], a[56:59], a[124:127], v[200:203]
v_mfma_f32_16x16x32_bf16 v[204:207], a[60:63], a[124:127], v[204:207]
v_mfma_f32_16x16x32_bf16 v[172:175], a[60:63], a[120:123], v[172:175]
s_waitcnt vmcnt(0)
buffer_load_dwordx4 v[80:83], v1, s[24:27], s59 offen offset:0 sc1
buffer_load_dwordx4 v[84:87], v1, s[24:27], s59 offen offset:1024 sc1
buffer_load_dwordx4 v[88:91], v1, s[24:27], s59 offen offset:2048 sc1
buffer_load_dwordx4 v[92:95], v1, s[24:27], s59 offen offset:3072 sc1
s_mov_b32 s50, 32768
s_waitcnt vmcnt(0)
v_max3_u32 v44, v80, v81, v82
v_max3_u32 v44, v44, v83, v84
v_max3_u32 v44, v44, v85, v86
v_max3_u32 v44, v44, v87, v88
v_max3_u32 v44, v44, v89, v90
v_max3_u32 v44, v44, v91, v92
v_max3_u32 v44, v44, v93, v94
v_max_u32 v44, v44, v95
v_cmp_eq_u32 vcc, -1, v44
s_nop 3
s_cbranch_vccz LretX
s_mov_b32 s47, 0
LslowX_l:
s_sleep 4
buffer_load_dwordx4 v[80:83], v1, s[24:27], s59 offen offset:0 sc1
buffer_load_dwordx4 v[84:87], v1, s[24:27], s59 offen offset:1024 sc1
buffer_load_dwordx4 v[88:91], v1, s[24:27], s59 offen offset:2048 sc1
buffer_load_dwordx4 v[92:95], v1, s[24:27], s59 offen offset:3072 sc1
s_add_u32 s47, s47, 1
s_waitcnt vmcnt(0)
v_max3_u32 v44, v80, v81, v82
v_max3_u32 v44, v44, v83, v84
v_max3_u32 v44, v44, v85, v86
v_max3_u32 v44, v44, v87, v88
v_max3_u32 v44, v44, v89, v90
v_max3_u32 v44, v44, v91, v92
v_max3_u32 v44, v44, v93, v94
v_max_u32 v44, v44, v95
v_cmp_eq_u32 vcc, -1, v44
s_cmp_gt_u32 s47, 0x40000
s_cbranch_scc1 LretX
s_nop 3
s_cbranch_vccnz LslowX_l
LretX:
v_lshlrev_b32 v48, 16, v80
v_and_b32 v49, 0xffff0000, v80
v_lshlrev_b32 v50, 16, v81
v_and_b32 v51, 0xffff0000, v81
v_lshlrev_b32 v52, 16, v82
v_and_b32 v53, 0xffff0000, v82
v_lshlrev_b32 v54, 16, v83
v_and_b32 v55, 0xffff0000, v83
v_pk_add_f32 v[160:161], v[160:161], v[48:49]
v_pk_add_f32 v[162:163], v[162:163], v[50:51]
v_pk_add_f32 v[164:165], v[164:165], v[52:53]
v_pk_add_f32 v[166:167], v[166:167], v[54:55]
v_cvt_pk_bf16_f32 v160, v160, v161
v_cvt_pk_bf16_f32 v161, v162, v163
v_cvt_pk_bf16_f32 v162, v164, v165
v_cvt_pk_bf16_f32 v163, v166, v167
s_nop 0
v_permlane16_swap_b32 v160, v162
v_permlane16_swap_b32 v161, v163
buffer_store_dwordx4 v[160:163], v13, s[28:31], 0 offen offset:0
v_lshlrev_b32 v48, 16, v84
v_and_b32 v49, 0xffff0000, v84
v_lshlrev_b32 v50, 16, v85
v_and_b32 v51, 0xffff0000, v85
v_lshlrev_b32 v52, 16, v86
v_and_b32 v53, 0xffff0000, v86
v_lshlrev_b32 v54, 16, v87
v_and_b32 v55, 0xffff0000, v87
v_pk_add_f32 v[168:169], v[168:169], v[48:49]
v_pk_add_f32 v[170:171], v[170:171], v[50:51]
v_pk_add_f32 v[172:173], v[172:173], v[52:53]
v_pk_add_f32 v[174:175], v[174:175], v[54:55]
v_cvt_pk_bf16_f32 v168, v168, v169
v_cvt_pk_bf16_f32 v169, v170, v171
v_cvt_pk_bf16_f32 v170, v172, v173
v_cvt_pk_bf16_f32 v171, v174, v175
s_nop 0
v_permlane16_swap_b32 v168, v170
v_permlane16_swap_b32 v169, v171
buffer_store_dwordx4 v[168:171], v13, s[28:31], 0 offen offset:64
v_lshlrev_b32 v48, 16, v88
v_and_b32 v49, 0xffff0000, v88
v_lshlrev_b32 v50, 16, v89
v_and_b32 v51, 0xffff0000, v89
v_lshlrev_b32 v52, 16, v90
v_and_b32 v53, 0xffff0000, v90
v_lshlrev_b32 v54, 16, v91
v_and_b32 v55, 0xffff0000, v91
v_pk_add_f32 v[192:193], v[192:193], v[48:49]
v_pk_add_f32 v[194:195], v[194:195], v[50:51]
v_pk_add_f32 v[196:197], v[196:197], v[52:53]
v_pk_add_f32 v[198:199], v[198:199], v[54:55]
v_cvt_pk_bf16_f32 v192, v192, v193
v_cvt_pk_bf16_f32 v193, v194, v195
v_cvt_pk_bf16_f32 v194, v196, v197
v_cvt_pk_bf16_f32 v195, v198, v199
s_nop 0
v_permlane16_swap_b32 v192, v194
v_permlane16_swap_b32 v193, v195
buffer_store_dwordx4 v[192:195], v13, s[28:31], s50 offen offset:0
v_lshlrev_b32 v48, 16, v92
v_and_b32 v49, 0xffff0000, v92
v_lshlrev_b32 v50, 16, v93
v_and_b32 v51, 0xffff0000, v93
v_lshlrev_b32 v52, 16, v94
v_and_b32 v53, 0xffff0000, v94
v_lshlrev_b32 v54, 16, v95
v_and_b32 v55, 0xffff0000, v95
v_pk_add_f32 v[200:201], v[200:201], v[48:49]
v_pk_add_f32 v[202:203], v[202:203], v[50:51]
v_pk_add_f32 v[204:205], v[204:205], v[52:53]
v_pk_add_f32 v[206:207], v[206:207], v[54:55]
v_cvt_pk_bf16_f32 v200, v200, v201
v_cvt_pk_bf16_f32 v201, v202, v203
v_cvt_pk_bf16_f32 v202, v204, v205
v_cvt_pk_bf16_f32 v203, v206, v207
s_nop 0
v_permlane16_swap_b32 v200, v202
v_permlane16_swap_b32 v201, v203
buffer_store_dwordx4 v[200:203], v13, s[28:31], s50 offen offset:64
Lend:
s_endpgm
Lcode_end:
.section .rodata,"a"
.p2align 6
.amdhsa_kernel gated_mix__linear_attn_block__dense_activation_gelu__prompt_kernel
  .amdhsa_next_free_vgpr 512
  .amdhsa_next_free_sgpr 102
  .amdhsa_accum_offset 256
  .amdhsa_group_segment_fixed_size 0
  .amdhsa_kernarg_size 96
  .amdhsa_user_sgpr_count 2
  .amdhsa_user_sgpr_kernarg_segment_ptr 1
  .amdhsa_system_sgpr_workgroup_id_x 1
.end_amdhsa_kernel
```
